```python
import torch

def _softmax(x, axis=-1):
    return torch.softmax(x, dim=axis)
def _gelu(x):
    return torch.nn.functional.gelu(x, approximate="tanh")
def _silu(x):
    return torch.nn.functional.silu(x)
def _sigmoid(x):
    return torch.sigmoid(x)
def _layernorm(x, axis=-1, eps=1e-5):
    m = x.mean(dim=axis, keepdim=True)
    v = x.var(dim=axis, keepdim=True, unbiased=False)
    return (x - m) / torch.sqrt(v + eps)
def _scatter_add(tgt, idx, src, axis=0):
    return tgt.clone().index_add_(axis, idx, src)
def _segment_sum(src, seg, n):
    out = torch.zeros((n,) + src.shape[1:], dtype=src.dtype)
    return out.index_add_(0, seg, src)
def _pad(x, pw):
    flat = tuple(v for pair in reversed(pw) for v in pair)
    return torch.nn.functional.pad(x, flat)

kernel_name = 'standalone__detection_seg_fpn_lateral__vision'

def setup_inputs():

    _w = (lambda a: (lambda t: t.to(torch.bfloat16) if t.is_floating_point() else t)(torch.as_tensor(a)))
    H = W = (224 // 2) * 2
    C = 192
    k = 3
    return {
        "c_fine": _w((lambda *s: torch.randn(*s, dtype=torch.bfloat16) * 0.05)(1, H, W, C)),
        "p_coarse": _w((lambda *s: torch.randn(*s, dtype=torch.bfloat16) * 0.05)(1, H // 2, W // 2, C)),
        "w_lat": _w((lambda *s: torch.randn(*s, dtype=torch.bfloat16) * 0.05)(C, C)),
        "w_out": _w((lambda *s: torch.randn(*s, dtype=torch.bfloat16) * 0.05)(k, k, C, C)),
    }

def reference(c_fine, p_coarse, w_lat, w_out):
    B, H, W, C = c_fine.shape
    k = 3
    lat = torch.einsum("bhwc,cd->bhwd", c_fine, w_lat)
    up = (lambda x, n, axis: torch.repeat_interleave(x, n, dim=axis))((lambda x, n, axis: torch.repeat_interleave(x, n, dim=axis))(p_coarse, 2, axis=1), 2, axis=2)
    m = lat + up
    pad = k // 2
    mp = _pad(m, ((0, 0), (pad, pad), (pad, pad), (0, 0)))
    o = None
    for di in range(k):
        for dj in range(k):
            t = torch.einsum("bhwc,cd->bhwd", mp[:, di:di + H, dj:dj + W, :], w_out[di, dj])
            o = t if o is None else o + t
    return o
```

```asm
; @launch grid=(256,1,1) block=(256,1,1) lds=163840
.amdgcn_target "amdgcn-amd-amdhsa--gfx950"
.text
.globl standalone__detection_seg_fpn_lateral__vision_kernel
.p2align 8
.type standalone__detection_seg_fpn_lateral__vision_kernel,@function
standalone__detection_seg_fpn_lateral__vision_kernel:
    s_getpc_b64 s[98:99]
L_pc:
    s_cmp_ge_u32 s2, 256
    s_cbranch_scc1 L_end
    v_mul_u32_u24 v250, 128, v0
    v_min_u32 v251, L_end-L_pc, v250
    global_load_dword v251, v251, s[98:99]
    s_load_dwordx8 s[40:47], s[0:1], 0
    s_load_dwordx4 s[48:51], s[0:1], 32
    s_load_dwordx2 s[100:101], s[0:1], 48
    v_lshrrev_b32 v35, 6, v0
    v_and_b32 v32, 63, v0
    v_readfirstlane_b32 s28, v35
    v_and_b32 v33, 15, v0
    v_lshrrev_b32 v34, 4, v32
    s_and_b32 s35, s2, 7
    s_lshl_b32 s35, s35, 5
    s_lshr_b32 s39, s2, 3
    s_add_u32 s35, s35, s39
    s_lshr_b32 s29, s35, 4
    s_and_b32 s30, s35, 15
    v_mov_b32 v63, 0x40000000
    v_mov_b32 v13, 0x40000000
    v_mov_b32 v240, v63
    v_mov_b32 v241, v63
    v_mov_b32 v242, v63
    s_cmp_ge_u32 s28, 2
    s_cbranch_scc1 L_w23
    s_cmp_ge_u32 s2, 144
    s_cbranch_scc1 L_cw
    s_lshr_b32 s31, s2, 1
    s_and_b32 s33, s2, 1
    s_lshl_b32 s33, s33, 1
    s_add_u32 s33, s33, s28
    s_mul_i32 s60, s31, 43691
    s_lshr_b32 s60, s60, 19
    s_mul_i32 s61, s60, 12
    s_sub_u32 s61, s31, s61
    s_mul_i32 s62, s61, 21846
    s_lshr_b32 s62, s62, 16
    s_mul_i32 s63, s62, 3
    s_sub_u32 s63, s61, s63
    v_lshrrev_b32 v36, 2, v32
    v_and_b32 v37, 3, v32
    v_lshrrev_b32 v38, 2, v36
    v_and_b32 v39, 3, v36
    v_lshl_add_u32 v38, v38, 3, v39
    s_lshl_b32 s31, s63, 2
    v_add_u32 v38, s31, v38
    v_add_u32 v39, 32, v36
    s_cmp_eq_u32 s63, 2
    s_cselect_b64 vcc, -1, 0
    v_cndmask_b32 v38, v38, v39, vcc
    s_mul_i32 s31, s62, 96
    s_mul_i32 s32, s33, 3072
    s_add_u32 s31, s31, s32
    v_lshlrev_b32 v38, 1, v38
    v_mul_u32_u24 v39, 768, v37
    v_add3_u32 v62, v38, v39, s31
    s_mul_i32 s34, s60, 12288
    s_waitcnt lgkmcnt(0)
    s_mov_b32 s24, s46
    s_mov_b32 s25, s47
    s_mov_b32 s26, 663552
    s_mov_b32 s27, 0x00020000
    buffer_load_ushort v160, v62, s[24:27], s34 offen offset:0
    s_lshl_b32 s31, s61, 10
    s_lshl_b32 s32, s33, 8
    buffer_load_ushort v161, v62, s[24:27], s34 offen offset:384
    s_add_u32 s34, s34, 73728
    s_add_u32 s31, s31, s32
    v_lshlrev_b32 v38, 2, v32
    buffer_load_ushort v162, v62, s[24:27], s34 offen offset:0
    v_add_u32 v63, s31, v38
    s_lshr_b32 s31, s60, 1
    buffer_load_ushort v163, v62, s[24:27], s34 offen offset:384
    s_add_u32 s34, s34, 73728
    s_lshl_b32 s31, s31, 3
    s_and_b32 s32, s60, 1
    buffer_load_ushort v164, v62, s[24:27], s34 offen offset:0
    s_lshl_b32 s32, s32, 1
    s_add_u32 s31, s31, s32
    buffer_load_ushort v165, v62, s[24:27], s34 offen offset:384
    s_add_u32 s34, s34, 73728
    s_mul_i32 s38, s31, 12416
    s_lshr_b32 s32, s2, 3
    buffer_load_ushort v166, v62, s[24:27], s34 offen offset:0
    s_add_u32 s32, s32, s2
    s_and_b32 s32, s32, 7
    buffer_load_ushort v167, v62, s[24:27], s34 offen offset:384
    s_add_u32 s34, s34, 73728
    s_mul_i32 s31, s32, 32
    v_cmp_eq_u32 vcc, 0, v0
    buffer_load_ushort v168, v62, s[24:27], s34 offen offset:0
    v_mov_b32 v38, 0x40000000
    v_mov_b32 v39, s31
    buffer_load_ushort v169, v62, s[24:27], s34 offen offset:384
    s_add_u32 s34, s34, 73728
    v_cndmask_b32 v13, v38, v39, vcc
    buffer_load_ushort v170, v62, s[24:27], s34 offen offset:0
    buffer_load_ushort v171, v62, s[24:27], s34 offen offset:384
    s_add_u32 s34, s34, 73728
    buffer_load_ushort v172, v62, s[24:27], s34 offen offset:0
    buffer_load_ushort v173, v62, s[24:27], s34 offen offset:384
    s_add_u32 s34, s34, 73728
    buffer_load_ushort v174, v62, s[24:27], s34 offen offset:0
    buffer_load_ushort v175, v62, s[24:27], s34 offen offset:384
    s_add_u32 s34, s34, 73728
    buffer_load_ushort v176, v62, s[24:27], s34 offen offset:0
    buffer_load_ushort v177, v62, s[24:27], s34 offen offset:384
    s_branch L_cw
L_w23:
    s_cmp_eq_u32 s28, 3
    s_cbranch_scc1 L_w3
    v_mul_u32_u24 v36, 2731, v32
    v_lshrrev_b32 v36, 16, v36
    v_mul_u32_u24 v37, 24, v36
    v_sub_u32 v37, v32, v37
    v_and_b32 v38, 3, v36
    v_lshlrev_b32 v38, 2, v38
    v_sub_u32 v37, v37, v38
    v_add_u32 v38, 24, v37
    v_min_u32 v37, v37, v38
    v_mul_u32_u24 v38, 384, v36
    v_lshl_add_u32 v240, v37, 4, v38
    v_add_u32 v35, 64, v32
    v_mul_u32_u24 v36, 2731, v35
    v_lshrrev_b32 v36, 16, v36
    v_mul_u32_u24 v37, 24, v36
    v_sub_u32 v37, v35, v37
    v_and_b32 v38, 3, v36
    v_lshlrev_b32 v38, 2, v38
    v_sub_u32 v37, v37, v38
    v_add_u32 v38, 24, v37
    v_min_u32 v37, v37, v38
    v_mul_u32_u24 v38, 384, v36
    v_lshl_add_u32 v241, v37, 4, v38
    v_subrev_u32 v241, 1024, v241
    v_add_u32 v35, 128, v32
    v_mul_u32_u24 v36, 2731, v35
    v_lshrrev_b32 v36, 16, v36
    v_mul_u32_u24 v37, 24, v36
    v_sub_u32 v37, v35, v37
    v_and_b32 v38, 3, v36
    v_lshlrev_b32 v38, 2, v38
    v_sub_u32 v37, v37, v38
    v_add_u32 v38, 24, v37
    v_min_u32 v37, v37, v38
    v_mul_u32_u24 v38, 384, v36
    v_lshl_add_u32 v242, v37, 4, v38
    v_subrev_u32 v242, 2048, v242
    s_waitcnt lgkmcnt(0)
    s_mov_b32 s12, s44
    s_mov_b32 s13, s45
    s_mov_b32 s14, 73728
    s_mov_b32 s15, 0x00020000
    s_mov_b32 m0, 76800
    s_mov_b32 s33, 0
    buffer_load_dwordx4 v240, s[12:15], s33 offen offset:0 lds
    s_mov_b32 m0, 76800
    s_mov_b32 s33, 0
    buffer_load_dwordx4 v241, s[12:15], s33 offen offset:1024 lds
    s_mov_b32 m0, 76800
    s_mov_b32 s33, 0
    buffer_load_dwordx4 v242, s[12:15], s33 offen offset:2048 lds
    s_mov_b32 m0, 79872
    s_mov_b32 s33, 3072
    buffer_load_dwordx4 v240, s[12:15], s33 offen offset:0 lds
    s_mov_b32 m0, 79872
    s_mov_b32 s33, 3072
    buffer_load_dwordx4 v241, s[12:15], s33 offen offset:1024 lds
    s_mov_b32 m0, 79872
    s_mov_b32 s33, 3072
    buffer_load_dwordx4 v242, s[12:15], s33 offen offset:2048 lds
    s_mov_b32 m0, 82944
    s_mov_b32 s33, 6144
    buffer_load_dwordx4 v240, s[12:15], s33 offen offset:0 lds
    s_mov_b32 m0, 82944
    s_mov_b32 s33, 6144
    buffer_load_dwordx4 v241, s[12:15], s33 offen offset:1024 lds
    s_mov_b32 m0, 82944
    s_mov_b32 s33, 6144
    buffer_load_dwordx4 v242, s[12:15], s33 offen offset:2048 lds
    s_mov_b32 m0, 86016
    s_mov_b32 s33, 9216
    buffer_load_dwordx4 v240, s[12:15], s33 offen offset:0 lds
    s_mov_b32 m0, 86016
    s_mov_b32 s33, 9216
    buffer_load_dwordx4 v241, s[12:15], s33 offen offset:1024 lds
    s_mov_b32 m0, 86016
    s_mov_b32 s33, 9216
    buffer_load_dwordx4 v242, s[12:15], s33 offen offset:2048 lds
    s_mov_b32 m0, 89088
    s_mov_b32 s33, 12288
    buffer_load_dwordx4 v240, s[12:15], s33 offen offset:0 lds
    s_mov_b32 m0, 89088
    s_mov_b32 s33, 12288
    buffer_load_dwordx4 v241, s[12:15], s33 offen offset:1024 lds
    s_mov_b32 m0, 89088
    s_mov_b32 s33, 12288
    buffer_load_dwordx4 v242, s[12:15], s33 offen offset:2048 lds
    s_mov_b32 m0, 92160
    s_mov_b32 s33, 15360
    buffer_load_dwordx4 v240, s[12:15], s33 offen offset:0 lds
    s_mov_b32 m0, 92160
    s_mov_b32 s33, 15360
    buffer_load_dwordx4 v241, s[12:15], s33 offen offset:1024 lds
    s_mov_b32 m0, 92160
    s_mov_b32 s33, 15360
    buffer_load_dwordx4 v242, s[12:15], s33 offen offset:2048 lds
    s_mov_b32 m0, 95232
    s_mov_b32 s33, 18432
    buffer_load_dwordx4 v240, s[12:15], s33 offen offset:0 lds
    s_mov_b32 m0, 95232
    s_mov_b32 s33, 18432
    buffer_load_dwordx4 v241, s[12:15], s33 offen offset:1024 lds
    s_mov_b32 m0, 95232
    s_mov_b32 s33, 18432
    buffer_load_dwordx4 v242, s[12:15], s33 offen offset:2048 lds
    s_mov_b32 m0, 98304
    s_mov_b32 s33, 21504
    buffer_load_dwordx4 v240, s[12:15], s33 offen offset:0 lds
    s_mov_b32 m0, 98304
    s_mov_b32 s33, 21504
    buffer_load_dwordx4 v241, s[12:15], s33 offen offset:1024 lds
    s_mov_b32 m0, 98304
    s_mov_b32 s33, 21504
    buffer_load_dwordx4 v242, s[12:15], s33 offen offset:2048 lds
L_cw:
    s_waitcnt lgkmcnt(0)
    s_mov_b32 s8, s42
    s_mov_b32 s9, s43
    s_mov_b32 s10, 4816896
    s_mov_b32 s11, 0x00020000
    s_mov_b32 s4, s40
    s_mov_b32 s5, s41
    s_mov_b32 s6, 19267584
    s_mov_b32 s7, 0x00020000
    s_mov_b32 s12, s44
    s_mov_b32 s13, s45
    s_mov_b32 s14, 73728
    s_mov_b32 s15, 0x00020000
    v_cmp_lt_u32 vcc, 24, v32
    v_subrev_u32 v35, 25, v32
    s_mul_i32 s37, s29, 14
    v_cndmask_b32 v35, v32, v35, vcc
    v_lshlrev_b32 v35, 4, v35
    v_add_u32 v36, 384, v35
    v_cndmask_b32 v57, v35, v36, vcc
    v_mov_b32 v37, 0x40000000
    v_cndmask_b32 v58, v37, v35, vcc
    v_cndmask_b32 v59, v35, v37, vcc
    v_lshlrev_b32 v244, 4, v32
    v_cmp_gt_u32 vcc, 24, v32
    v_subrev_u32 v35, 384, v244
    s_mul_i32 s37, s37, 224
    v_cndmask_b32 v245, v35, v37, vcc
    v_cmp_gt_u32 vcc, 30, v32
    s_mul_i32 s32, s30, 14
    s_add_u32 s37, s37, s32
    v_cndmask_b32 v246, v37, v244, vcc
    s_cmp_eq_u32 s30, 0
    s_cselect_b64 vcc, -1, 0
    s_cselect_b32 s53, 384, 0
    v_cndmask_b32 v58, v57, v58, vcc
    v_cndmask_b32 v245, v244, v245, vcc
    s_cmp_eq_u32 s30, 15
    s_cselect_b64 vcc, -1, 0
    s_sub_u32 s37, s37, 225
    v_cndmask_b32 v59, v57, v59, vcc
    v_cndmask_b32 v246, v244, v246, vcc
    s_mul_i32 s37, s37, 384
    s_mul_i32 s55, s29, 784
    s_mul_i32 s32, s30, 7
    s_add_u32 s55, s55, s32
    s_sub_u32 s55, s55, 113
    s_mul_i32 s55, s55, 384
    s_cmp_eq_u32 s29, 0
    s_cselect_b32 s3, 0x40000000, s37
    s_cselect_b32 s36, 0x40000000, s55
    s_mov_b32 s98, 0xfeffffff
    s_mov_b32 s99, 0x1ffff
    s_mov_b32 s0, -1
    s_mov_b32 s1, 0x3fffff
    v_cndmask_b32 v57, v37, v57, s[98:99]
    v_cndmask_b32 v58, v37, v58, s[98:99]
    v_cndmask_b32 v59, v37, v59, s[98:99]
    s_branch L_all
L_w3:
    v_cmp_lt_u32 vcc, 24, v32
    v_subrev_u32 v35, 25, v32
    s_mul_i32 s37, s29, 14
    v_cndmask_b32 v35, v32, v35, vcc
    v_lshlrev_b32 v35, 4, v35
    v_add_u32 v36, 384, v35
    v_cndmask_b32 v57, v35, v36, vcc
    v_mov_b32 v37, 0x40000000
    v_cndmask_b32 v58, v37, v35, vcc
    v_cndmask_b32 v59, v35, v37, vcc
    v_lshlrev_b32 v244, 4, v32
    v_cmp_gt_u32 vcc, 24, v32
    v_subrev_u32 v35, 384, v244
    s_mul_i32 s37, s37, 224
    v_cndmask_b32 v245, v35, v37, vcc
    v_cmp_gt_u32 vcc, 30, v32
    s_mul_i32 s32, s30, 14
    s_add_u32 s37, s37, s32
    v_cndmask_b32 v246, v37, v244, vcc
    s_cmp_eq_u32 s30, 0
    s_cselect_b64 vcc, -1, 0
    s_cselect_b32 s53, 384, 0
    v_cndmask_b32 v58, v57, v58, vcc
    v_cndmask_b32 v245, v244, v245, vcc
    s_cmp_eq_u32 s30, 15
    s_cselect_b64 vcc, -1, 0
    s_sub_u32 s37, s37, 225
    v_cndmask_b32 v59, v57, v59, vcc
    v_cndmask_b32 v246, v244, v246, vcc
    s_mul_i32 s37, s37, 384
    s_mul_i32 s55, s29, 784
    s_mul_i32 s32, s30, 7
    s_add_u32 s55, s55, s32
    s_sub_u32 s55, s55, 113
    s_mul_i32 s55, s55, 384
    s_cmp_eq_u32 s29, 0
    s_cselect_b32 s3, 0x40000000, s37
    s_cselect_b32 s36, 0x40000000, s55
    s_mov_b32 s98, 0xfeffffff
    s_mov_b32 s99, 0x1ffff
    s_mov_b32 s0, -1
    s_mov_b32 s1, 0x3fffff
    v_cndmask_b32 v57, v37, v57, s[98:99]
    v_cndmask_b32 v58, v37, v58, s[98:99]
    v_cndmask_b32 v59, v37, v59, s[98:99]
    s_waitcnt lgkmcnt(0)
    s_mov_b32 s8, s42
    s_mov_b32 s9, s43
    s_mov_b32 s10, 4816896
    s_mov_b32 s11, 0x00020000
    s_mov_b32 s4, s40
    s_mov_b32 s5, s41
    s_mov_b32 s6, 19267584
    s_mov_b32 s7, 0x00020000
    s_mov_b32 s12, s44
    s_mov_b32 s13, s45
    s_mov_b32 s14, 73728
    s_mov_b32 s15, 0x00020000
    s_mov_b64 exec, s[0:1]
    s_mov_b32 m0, 102400
    s_add_u32 s52, s36, s53
    buffer_load_dwordx4 v245, s[8:11], s52 offen nt lds
    s_mov_b32 m0, 103264
    s_add_u32 s52, s36, 864
    buffer_load_dwordx4 v244, s[8:11], s52 offen nt lds
    s_mov_b32 m0, 104128
    s_add_u32 s52, s36, 1728
    buffer_load_dwordx4 v244, s[8:11], s52 offen nt lds
    s_mov_b32 m0, 104992
    s_add_u32 s52, s36, 2592
    buffer_load_dwordx4 v246, s[8:11], s52 offen nt lds
    s_mov_b32 m0, 105856
    s_add_u32 s52, s55, s53
    s_add_u32 s52, s52, 43008
    buffer_load_dwordx4 v245, s[8:11], s52 offen nt lds
    s_mov_b32 m0, 106720
    s_add_u32 s52, s55, 43872
    buffer_load_dwordx4 v244, s[8:11], s52 offen nt lds
    s_mov_b32 m0, 107584
    s_add_u32 s52, s55, 44736
    buffer_load_dwordx4 v244, s[8:11], s52 offen nt lds
    s_mov_b32 m0, 108448
    s_add_u32 s52, s55, 45600
    buffer_load_dwordx4 v246, s[8:11], s52 offen nt lds
    s_mov_b32 m0, 109312
    s_add_u32 s52, s55, s53
    s_add_u32 s52, s52, 86016
    buffer_load_dwordx4 v245, s[8:11], s52 offen nt lds
    s_mov_b32 m0, 110176
    s_add_u32 s52, s55, 86880
    buffer_load_dwordx4 v244, s[8:11], s52 offen nt lds
    s_mov_b32 m0, 111040
    s_add_u32 s52, s55, 87744
    buffer_load_dwordx4 v244, s[8:11], s52 offen nt lds
    s_mov_b32 m0, 111904
    s_add_u32 s52, s55, 88608
    buffer_load_dwordx4 v246, s[8:11], s52 offen nt lds
    s_mov_b64 exec, s[98:99]
    s_mov_b32 m0, 0
    s_add_u32 s52, s3, s53
    buffer_load_dwordx4 v58, s[4:7], s52 offen nt lds
    s_mov_b32 m0, 800
    s_add_u32 s52, s3, 768
    buffer_load_dwordx4 v57, s[4:7], s52 offen nt lds
    s_mov_b32 m0, 1600
    s_add_u32 s52, s3, 1536
    buffer_load_dwordx4 v57, s[4:7], s52 offen nt lds
    s_mov_b32 m0, 2400
    s_add_u32 s52, s3, 2304
    buffer_load_dwordx4 v57, s[4:7], s52 offen nt lds
    s_mov_b32 m0, 3200
    s_add_u32 s52, s3, 3072
    buffer_load_dwordx4 v57, s[4:7], s52 offen nt lds
    s_mov_b32 m0, 4000
    s_add_u32 s52, s3, 3840
    buffer_load_dwordx4 v57, s[4:7], s52 offen nt lds
    s_mov_b32 m0, 4800
    s_add_u32 s52, s3, 4608
    buffer_load_dwordx4 v57, s[4:7], s52 offen nt lds
    s_mov_b32 m0, 5600
    s_add_u32 s52, s3, 5376
    buffer_load_dwordx4 v59, s[4:7], s52 offen nt lds
    s_mov_b32 m0, 6400
    s_add_u32 s52, s37, s53
    s_add_u32 s52, s52, 86016
    buffer_load_dwordx4 v58, s[4:7], s52 offen nt lds
    s_mov_b32 m0, 7200
    s_add_u32 s52, s37, 86784
    buffer_load_dwordx4 v57, s[4:7], s52 offen nt lds
    s_mov_b32 m0, 8000
    s_add_u32 s52, s37, 87552
    buffer_load_dwordx4 v57, s[4:7], s52 offen nt lds
    s_mov_b32 m0, 8800
    s_add_u32 s52, s37, 88320
    buffer_load_dwordx4 v57, s[4:7], s52 offen nt lds
    s_mov_b32 m0, 9600
    s_add_u32 s52, s37, 89088
    buffer_load_dwordx4 v57, s[4:7], s52 offen nt lds
    s_mov_b32 m0, 10400
    s_add_u32 s52, s37, 89856
    buffer_load_dwordx4 v57, s[4:7], s52 offen nt lds
    s_mov_b32 m0, 11200
    s_add_u32 s52, s37, 90624
    buffer_load_dwordx4 v57, s[4:7], s52 offen nt lds
    s_mov_b32 m0, 12000
    s_add_u32 s52, s37, 91392
    buffer_load_dwordx4 v59, s[4:7], s52 offen nt lds
    s_mov_b32 m0, 12800
    s_add_u32 s52, s37, s53
    s_add_u32 s52, s52, 172032
    buffer_load_dwordx4 v58, s[4:7], s52 offen nt lds
    s_mov_b32 m0, 13600
    s_add_u32 s52, s37, 172800
    buffer_load_dwordx4 v57, s[4:7], s52 offen nt lds
    s_mov_b32 m0, 14400
    s_add_u32 s52, s37, 173568
    buffer_load_dwordx4 v57, s[4:7], s52 offen nt lds
    s_mov_b32 m0, 15200
    s_add_u32 s52, s37, 174336
    buffer_load_dwordx4 v57, s[4:7], s52 offen nt lds
    s_mov_b32 m0, 16000
    s_add_u32 s52, s37, 175104
    buffer_load_dwordx4 v57, s[4:7], s52 offen nt lds
    s_mov_b32 m0, 16800
    s_add_u32 s52, s37, 175872
    buffer_load_dwordx4 v57, s[4:7], s52 offen nt lds
    s_mov_b32 m0, 17600
    s_add_u32 s52, s37, 176640
    buffer_load_dwordx4 v57, s[4:7], s52 offen nt lds
    s_mov_b32 m0, 18400
    s_add_u32 s52, s37, 177408
    buffer_load_dwordx4 v59, s[4:7], s52 offen nt lds
    s_mov_b32 m0, 19200
    s_add_u32 s52, s37, s53
    s_add_u32 s52, s52, 258048
    buffer_load_dwordx4 v58, s[4:7], s52 offen nt lds
    s_mov_b32 m0, 20000
    s_add_u32 s52, s37, 258816
    buffer_load_dwordx4 v57, s[4:7], s52 offen nt lds
    s_mov_b32 m0, 20800
    s_add_u32 s52, s37, 259584
    buffer_load_dwordx4 v57, s[4:7], s52 offen nt lds
    s_mov_b32 m0, 21600
    s_add_u32 s52, s37, 260352
    buffer_load_dwordx4 v57, s[4:7], s52 offen nt lds
    s_mov_b32 m0, 22400
    s_add_u32 s52, s37, 261120
    buffer_load_dwordx4 v57, s[4:7], s52 offen nt lds
    s_mov_b32 m0, 23200
    s_add_u32 s52, s37, 261888
    buffer_load_dwordx4 v57, s[4:7], s52 offen nt lds
    s_mov_b32 m0, 24000
    s_add_u32 s52, s37, 262656
    buffer_load_dwordx4 v57, s[4:7], s52 offen nt lds
    s_mov_b32 m0, 24800
    s_add_u32 s52, s37, 263424
    buffer_load_dwordx4 v59, s[4:7], s52 offen nt lds
    s_mov_b64 exec, -1
    v_mul_u32_u24 v36, 2731, v32
    v_lshrrev_b32 v36, 16, v36
    v_mul_u32_u24 v37, 24, v36
    v_sub_u32 v37, v32, v37
    v_and_b32 v38, 3, v36
    v_lshlrev_b32 v38, 2, v38
    v_sub_u32 v37, v37, v38
    v_add_u32 v38, 24, v37
    v_min_u32 v37, v37, v38
    v_mul_u32_u24 v38, 384, v36
    v_lshl_add_u32 v240, v37, 4, v38
    v_add_u32 v35, 64, v32
    v_mul_u32_u24 v36, 2731, v35
    v_lshrrev_b32 v36, 16, v36
    v_mul_u32_u24 v37, 24, v36
    v_sub_u32 v37, v35, v37
    v_and_b32 v38, 3, v36
    v_lshlrev_b32 v38, 2, v38
    v_sub_u32 v37, v37, v38
    v_add_u32 v38, 24, v37
    v_min_u32 v37, v37, v38
    v_mul_u32_u24 v38, 384, v36
    v_lshl_add_u32 v241, v37, 4, v38
    v_subrev_u32 v241, 1024, v241
    v_add_u32 v35, 128, v32
    v_mul_u32_u24 v36, 2731, v35
    v_lshrrev_b32 v36, 16, v36
    v_mul_u32_u24 v37, 24, v36
    v_sub_u32 v37, v35, v37
    v_and_b32 v38, 3, v36
    v_lshlrev_b32 v38, 2, v38
    v_sub_u32 v37, v37, v38
    v_add_u32 v38, 24, v37
    v_min_u32 v37, v37, v38
    v_mul_u32_u24 v38, 384, v36
    v_lshl_add_u32 v242, v37, 4, v38
    v_subrev_u32 v242, 2048, v242
L_all:
    s_mov_b32 s16, s100
    s_mov_b32 s17, s101
    s_mov_b32 s18, 1191936
    s_mov_b32 s19, 0x00020000
    s_mov_b32 s20, s48
    s_mov_b32 s21, s49
    s_mov_b32 s22, 19267584
    s_mov_b32 s23, 0x00020000
    s_mov_b32 s56, s50
    s_mov_b32 s57, s51
    s_mov_b32 s58, 256
    s_mov_b32 s59, 0x00020000
    s_mul_i32 s24, s28, 1536
    s_add_u32 s24, s24, s37
    s_mul_i32 s26, s28, 1600
    s_mul_i32 s27, s28, 864
    s_add_u32 s25, s55, s27
    s_cmp_eq_u32 s28, 0
    s_cselect_b32 s41, s53, 0
    s_cselect_b64 vcc, -1, 0
    s_add_u32 s25, s25, s41
    s_add_u32 s3, s24, s41
    v_cndmask_b32 v31, v244, v245, vcc
    v_cndmask_b32 v58, v57, v58, vcc
    s_cmp_eq_u32 s28, 3
    s_cselect_b64 vcc, -1, 0
    v_add_u32 v35, s26, v244
    v_cndmask_b32 v31, v31, v246, vcc
    v_cndmask_b32 v59, v57, v59, vcc
    v_mov_b32 v36, 0x30000
    v_add_u32 v37, 51200, v35
    v_add_u32 v38, 131072, v35
    v_cndmask_b32 v55, v36, v37, s[98:99]
    v_cndmask_b32 v56, v36, v38, s[98:99]
    v_mul_u32_u24 v35, 400, v33
    v_lshl_add_u32 v45, v34, 4, v35
    v_add_u32 v46, 51200, v45
    v_add_u32 v30, 131072, v45
    s_mul_i32 s42, s28, 96
    v_add_u32 v47, s42, v45
    v_add_u32 v48, 51200, v47
    v_add_u32 v35, s42, v35
    v_lshlrev_b32 v37, 3, v34
    v_add3_u32 v49, v35, v37, 64
    v_add_u32 v50, 51200, v49
    v_add_u32 v38, 1, v33
    v_lshrrev_b32 v38, 1, v38
    v_mul_u32_u24 v38, 384, v38
    s_add_u32 s42, s42, 102400
    v_add_u32 v38, s42, v38
    v_lshl_add_u32 v60, v34, 4, v38
    v_add3_u32 v61, v38, v37, 64
    v_lshrrev_b32 v35, 2, v33
    v_and_b32 v36, 3, v33
    v_lshl_add_u32 v41, v34, 3, v35
    v_mul_u32_u24 v41, 384, v41
    v_add_u32 v41, 51200, v41
    s_mul_i32 s41, s28, 6
    v_lshl_add_u32 v42, v35, 2, s41
    v_add_u32 v43, v42, v36
    v_subrev_u32 v44, 24, v43
    v_min_u32 v43, v43, v44
    v_lshl_add_u32 v51, v43, 4, v41
    v_lshrrev_b32 v43, 1, v36
    v_add3_u32 v43, v42, v43, 4
    v_subrev_u32 v44, 24, v43
    v_min_u32 v43, v43, v44
    v_lshl_add_u32 v43, v43, 4, v41
    v_and_b32 v44, 1, v36
    v_lshl_add_u32 v52, v44, 3, v43
    v_add_u32 v53, 79872, v51
    v_add_u32 v54, 79872, v52
    v_lshrrev_b32 v35, 2, v33
    v_and_b32 v36, 3, v33
    v_lshrrev_b32 v37, 1, v34
    v_and_b32 v38, 1, v34
    v_lshlrev_b32 v39, 3, v36
    v_lshl_add_u32 v41, v38, 2, v35
    v_mul_u32_u24 v41, 400, v41
    v_mul_u32_u24 v42, 6400, v37
    v_add3_u32 v41, v41, v42, v39
    s_lshl_b32 s42, s28, 5
    s_add_u32 s42, s42, 6400
    v_add_u32 v4, s42, v41
    v_add_u32 v5, 51200, v4
    v_sub_u32 v11, 6400, v42
    v_and_b32 v41, 7, v33
    v_xor_b32 v42, v34, v41
    v_lshlrev_b32 v42, 4, v42
    v_lshl_add_u32 v42, v33, 7, v42
    v_add_u32 v1, 102400, v42
    v_xor_b32 v2, 64, v1
    v_cmp_gt_u32 vcc, 8, v33
    v_mov_b32 v44, 0x30000
    s_nop 0
    v_cndmask_b32 v14, v44, v1, vcc
    v_cndmask_b32 v15, v44, v2, vcc
    s_lshl_b32 s42, s28, 1
    v_add_u32 v42, s42, v37
    v_xor_b32 v42, v42, v41
    v_lshlrev_b32 v42, 4, v42
    v_lshl_add_u32 v42, v41, 7, v42
    v_lshl_add_u32 v42, v38, 3, v42
    v_lshrrev_b32 v43, 3, v33
    v_mul_u32_u24 v44, 7168, v43
    v_add_u32 v42, v42, v44
    v_add_u32 v3, 102400, v42
    v_mul_u32_u24 v42, 12800, v43
    v_mul_u32_u24 v44, 784, v41
    s_mul_i32 s42, s28, 96
    v_add3_u32 v42, v42, v44, s42
    v_lshl_add_u32 v7, v34, 4, v42
    v_lshl_add_u32 v8, v34, 3, v42
    v_add_u32 v8, 64, v8
    v_lshlrev_b32 v42, 4, v32
    s_mul_i32 s42, s28, 784
    v_add_u32 v9, s42, v42
    s_mul_i32 s41, s29, 1204224
    s_mul_i32 s42, s30, 5376
    s_add_u32 s41, s41, s42
    s_mul_i32 s42, s28, 768
    s_add_u32 s41, s41, s42
    v_add_u32 v10, s41, v42
    v_cmp_gt_u32 vcc, 48, v32
    v_mov_b32 v44, 0x40000000
    s_nop 0
    v_cndmask_b32 v10, v44, v10, vcc
    s_cmp_eq_u32 s28, 3
    s_mov_b32 s44, 12416
    s_mov_b32 s45, 3072
    s_cmp_eq_u32 s28, 3
    s_cselect_b32 s45, 0x40000000, s45
    v_lshlrev_b32 v35, 4, v32
    s_mul_i32 s42, s28, 3072
    v_add_u32 v6, s42, v35
    v_lshlrev_b32 v42, 2, v38
    v_lshlrev_b32 v44, 1, v41
    v_sub_u32 v42, v42, v44
    v_cmp_eq_u32 vcc, 7, v41
    v_add_u32 v44, 64, v42
    s_nop 0
    v_cndmask_b32 v42, v42, v44, vcc
    v_cmp_eq_u32 s[60:61], 1, v43
    v_mov_b32 v24, 0x0
    v_mov_b32 v28, 0x1
    v_cndmask_b32 v24, v24, v28, s[60:61]
    v_mov_b32 v25, 0x3f80
    v_mov_b32 v28, 0x3f80
    v_cndmask_b32 v25, v25, v28, s[60:61]
    v_mov_b32 v26, 0x2
    v_mov_b32 v28, 0x2
    v_cndmask_b32 v26, v26, v28, s[60:61]
    v_mov_b32 v27, 0xbf80
    v_mov_b32 v28, 0x3f80
    v_cndmask_b32 v27, v27, v28, s[60:61]
    v_add_u32 v44, 0, v42
    v_cmp_eq_u32 vcc, v44, v24
    v_cmp_eq_u32 s[62:63], v44, v26
    s_nop 0
    v_cndmask_b32 v35, 0, v25, vcc
    v_cndmask_b32 v35, v35, v27, s[62:63]
    v_add_u32 v44, 1, v42
    v_cmp_eq_u32 vcc, v44, v24
    v_cmp_eq_u32 s[62:63], v44, v26
    s_nop 0
    v_cndmask_b32 v36, 0, v25, vcc
    v_cndmask_b32 v36, v36, v27, s[62:63]
    v_lshl_or_b32 v16, v36, 16, v35
    v_add_u32 v44, 2, v42
    v_cmp_eq_u32 vcc, v44, v24
    v_cmp_eq_u32 s[62:63], v44, v26
    s_nop 0
    v_cndmask_b32 v35, 0, v25, vcc
    v_cndmask_b32 v35, v35, v27, s[62:63]
    v_add_u32 v44, 3, v42
    v_cmp_eq_u32 vcc, v44, v24
    v_cmp_eq_u32 s[62:63], v44, v26
    s_nop 0
    v_cndmask_b32 v36, 0, v25, vcc
    v_cndmask_b32 v36, v36, v27, s[62:63]
    v_lshl_or_b32 v17, v36, 16, v35
    v_add_u32 v44, 8, v42
    v_cmp_eq_u32 vcc, v44, v24
    v_cmp_eq_u32 s[62:63], v44, v26
    s_nop 0
    v_cndmask_b32 v35, 0, v25, vcc
    v_cndmask_b32 v35, v35, v27, s[62:63]
    v_add_u32 v44, 9, v42
    v_cmp_eq_u32 vcc, v44, v24
    v_cmp_eq_u32 s[62:63], v44, v26
    s_nop 0
    v_cndmask_b32 v36, 0, v25, vcc
    v_cndmask_b32 v36, v36, v27, s[62:63]
    v_lshl_or_b32 v18, v36, 16, v35
    v_add_u32 v44, 10, v42
    v_cmp_eq_u32 vcc, v44, v24
    v_cmp_eq_u32 s[62:63], v44, v26
    s_nop 0
    v_cndmask_b32 v35, 0, v25, vcc
    v_cndmask_b32 v35, v35, v27, s[62:63]
    v_add_u32 v44, 11, v42
    v_cmp_eq_u32 vcc, v44, v24
    v_cmp_eq_u32 s[62:63], v44, v26
    s_nop 0
    v_cndmask_b32 v36, 0, v25, vcc
    v_cndmask_b32 v36, v36, v27, s[62:63]
    v_lshl_or_b32 v19, v36, 16, v35
    v_mov_b32 v24, 0x1
    v_mov_b32 v28, 0x1
    v_cndmask_b32 v24, v24, v28, s[60:61]
    v_mov_b32 v25, 0xbf80
    v_mov_b32 v28, 0x3f80
    v_cndmask_b32 v25, v25, v28, s[60:61]
    v_mov_b32 v26, 0x2
    v_mov_b32 v28, 0x3
    v_cndmask_b32 v26, v26, v28, s[60:61]
    v_mov_b32 v27, 0x3f80
    v_mov_b32 v28, 0xbf80
    v_cndmask_b32 v27, v27, v28, s[60:61]
    v_add_u32 v44, 0, v42
    v_cmp_eq_u32 vcc, v44, v24
    v_cmp_eq_u32 s[62:63], v44, v26
    s_nop 0
    v_cndmask_b32 v35, 0, v25, vcc
    v_cndmask_b32 v35, v35, v27, s[62:63]
    v_add_u32 v44, 1, v42
    v_cmp_eq_u32 vcc, v44, v24
    v_cmp_eq_u32 s[62:63], v44, v26
    s_nop 0
    v_cndmask_b32 v36, 0, v25, vcc
    v_cndmask_b32 v36, v36, v27, s[62:63]
    v_lshl_or_b32 v20, v36, 16, v35
    v_add_u32 v44, 2, v42
    v_cmp_eq_u32 vcc, v44, v24
    v_cmp_eq_u32 s[62:63], v44, v26
    s_nop 0
    v_cndmask_b32 v35, 0, v25, vcc
    v_cndmask_b32 v35, v35, v27, s[62:63]
    v_add_u32 v44, 3, v42
    v_cmp_eq_u32 vcc, v44, v24
    v_cmp_eq_u32 s[62:63], v44, v26
    s_nop 0
    v_cndmask_b32 v36, 0, v25, vcc
    v_cndmask_b32 v36, v36, v27, s[62:63]
    v_lshl_or_b32 v21, v36, 16, v35
    v_add_u32 v44, 8, v42
    v_cmp_eq_u32 vcc, v44, v24
    v_cmp_eq_u32 s[62:63], v44, v26
    s_nop 0
    v_cndmask_b32 v35, 0, v25, vcc
    v_cndmask_b32 v35, v35, v27, s[62:63]
    v_add_u32 v44, 9, v42
    v_cmp_eq_u32 vcc, v44, v24
    v_cmp_eq_u32 s[62:63], v44, v26
    s_nop 0
    v_cndmask_b32 v36, 0, v25, vcc
    v_cndmask_b32 v36, v36, v27, s[62:63]
    v_lshl_or_b32 v22, v36, 16, v35
    v_add_u32 v44, 10, v42
    v_cmp_eq_u32 vcc, v44, v24
    v_cmp_eq_u32 s[62:63], v44, v26
    s_nop 0
    v_cndmask_b32 v35, 0, v25, vcc
    v_cndmask_b32 v35, v35, v27, s[62:63]
    v_add_u32 v44, 11, v42
    v_cmp_eq_u32 vcc, v44, v24
    v_cmp_eq_u32 s[62:63], v44, v26
    s_nop 0
    v_cndmask_b32 v36, 0, v25, vcc
    v_cndmask_b32 v36, v36, v27, s[62:63]
    v_lshl_or_b32 v23, v36, 16, v35
    v_cmp_ne_u32 vcc, 0, v11
    v_mov_b32 v35, 0x80008000
    s_nop 0
    v_cndmask_b32 v35, 0, v35, vcc
    v_xor_b32 v36, v16, v35
    v_accvgpr_write_b32 a240, v36
    v_xor_b32 v37, v17, v35
    v_accvgpr_write_b32 a241, v37
    v_xor_b32 v36, v18, v35
    v_accvgpr_write_b32 a242, v36
    v_xor_b32 v37, v19, v35
    v_accvgpr_write_b32 a243, v37
    v_xor_b32 v36, v20, v35
    v_accvgpr_write_b32 a244, v36
    v_xor_b32 v37, v21, v35
    v_accvgpr_write_b32 a245, v37
    v_xor_b32 v36, v22, v35
    v_accvgpr_write_b32 a246, v36
    v_xor_b32 v37, v23, v35
    v_accvgpr_write_b32 a247, v37
    s_mov_b32 s31, 0xffff0000
    v_subrev_u32 v40, 192, v0
    v_lshlrev_b32 v40, 2, v40
    s_cmp_ge_u32 s28, 2
    s_cbranch_scc1 L_bw
    s_cmp_ge_u32 s2, 144
    s_cbranch_scc1 L_bw0
    s_waitcnt vmcnt(0)
    v_lshlrev_b32 v160, 16, v160
    v_lshlrev_b32 v161, 16, v161
    v_lshlrev_b32 v162, 16, v162
    v_lshlrev_b32 v163, 16, v163
    v_lshlrev_b32 v164, 16, v164
    v_lshlrev_b32 v165, 16, v165
    v_lshlrev_b32 v166, 16, v166
    v_lshlrev_b32 v167, 16, v167
    v_lshlrev_b32 v168, 16, v168
    v_lshlrev_b32 v169, 16, v169
    v_lshlrev_b32 v170, 16, v170
    v_lshlrev_b32 v171, 16, v171
    v_lshlrev_b32 v172, 16, v172
    v_lshlrev_b32 v173, 16, v173
    v_lshlrev_b32 v174, 16, v174
    v_lshlrev_b32 v175, 16, v175
    v_lshlrev_b32 v176, 16, v176
    v_lshlrev_b32 v177, 16, v177
    v_pk_add_f32 v[190:191], v[160:161], v[172:173]
    v_pk_add_f32 v[192:193], v[162:163], v[174:175]
    v_pk_add_f32 v[194:195], v[164:165], v[176:177]
    v_cvt_pk_bf16_f32 v214, -v160, -v161
    s_add_u32 s52, s38, 645632
    buffer_store_dword v214, v63, s[16:19], s52 offen sc0 sc1
    v_pk_mul_f32 v[190:191], v[190:191], 0.5 op_sel_hi:[1,0]
    v_pk_mul_f32 v[192:193], v[192:193], 0.5 op_sel_hi:[1,0]
    v_pk_mul_f32 v[194:195], v[194:195], 0.5 op_sel_hi:[1,0]
    v_cvt_pk_bf16_f32 v217, -v164, -v165
    s_add_u32 s52, s38, 658048
    buffer_store_dword v217, v63, s[16:19], s52 offen sc0 sc1
    v_pk_fma_f32 v[178:179], v[166:167], 0.5, v[190:191] op_sel_hi:[1,0,1]
    v_pk_fma_f32 v[180:181], v[168:169], 0.5, v[192:193] op_sel_hi:[1,0,1]
    v_pk_fma_f32 v[182:183], v[170:171], 0.5, v[194:195] op_sel_hi:[1,0,1]
    v_cvt_pk_bf16_f32 v226, v172, v173
    s_add_u32 s52, s38, 943616
    buffer_store_dword v226, v63, s[16:19], s52 offen sc0 sc1
    v_pk_fma_f32 v[184:185], v[166:167], -0.5, v[190:191] op_sel_hi:[1,0,1]
    v_pk_fma_f32 v[186:187], v[168:169], -0.5, v[192:193] op_sel_hi:[1,0,1]
    v_pk_fma_f32 v[188:189], v[170:171], -0.5, v[194:195] op_sel_hi:[1,0,1]
    v_cvt_pk_bf16_f32 v229, v176, v177
    s_add_u32 s52, s38, 956032
    buffer_store_dword v229, v63, s[16:19], s52 offen sc0 sc1
    v_pk_add_f32 v[190:191], v[160:161], v[164:165]
    v_pk_add_f32 v[192:193], v[178:179], v[182:183]
    v_pk_add_f32 v[194:195], v[184:185], v[188:189]
    v_pk_add_f32 v[196:197], v[172:173], v[176:177]
    v_cvt_pk_bf16_f32 v218, v178, v179
    s_add_u32 s52, s38, 49664
    buffer_store_dword v218, v63, s[16:19], s52 offen sc0 sc1
    v_pk_mul_f32 v[190:191], v[190:191], 0.5 op_sel_hi:[1,0]
    v_pk_mul_f32 v[192:193], v[192:193], 0.5 op_sel_hi:[1,0]
    v_pk_mul_f32 v[194:195], v[194:195], 0.5 op_sel_hi:[1,0]
    v_pk_mul_f32 v[196:197], v[196:197], 0.5 op_sel_hi:[1,0]
    v_cvt_pk_bf16_f32 v221, v182, v183
    s_add_u32 s52, s38, 62080
    buffer_store_dword v221, v63, s[16:19], s52 offen sc0 sc1
    v_pk_fma_f32 v[198:199], v[162:163], 0.5, v[190:191] op_sel_hi:[1,0,1]
    v_pk_fma_f32 v[202:203], v[180:181], 0.5, v[192:193] op_sel_hi:[1,0,1]
    v_pk_fma_f32 v[206:207], v[186:187], 0.5, v[194:195] op_sel_hi:[1,0,1]
    v_pk_fma_f32 v[210:211], v[174:175], 0.5, v[196:197] op_sel_hi:[1,0,1]
    v_cvt_pk_bf16_f32 v222, v184, v185
    s_add_u32 s52, s38, 347648
    buffer_store_dword v222, v63, s[16:19], s52 offen sc0 sc1
    v_pk_fma_f32 v[200:201], v[162:163], -0.5, v[190:191] op_sel_hi:[1,0,1]
    v_pk_fma_f32 v[204:205], v[180:181], -0.5, v[192:193] op_sel_hi:[1,0,1]
    v_pk_fma_f32 v[208:209], v[186:187], -0.5, v[194:195] op_sel_hi:[1,0,1]
    v_pk_fma_f32 v[212:213], v[174:175], -0.5, v[196:197] op_sel_hi:[1,0,1]
    v_cvt_pk_bf16_f32 v225, v188, v189
    s_add_u32 s52, s38, 360064
    buffer_store_dword v225, v63, s[16:19], s52 offen sc0 sc1
    v_cvt_pk_bf16_f32 v215, -v198, -v199
    s_add_u32 s52, s38, 595968
    buffer_store_dword v215, v63, s[16:19], s52 offen sc0 sc1
    v_cvt_pk_bf16_f32 v216, -v200, -v201
    s_add_u32 s52, s38, 608384
    buffer_store_dword v216, v63, s[16:19], s52 offen sc0 sc1
    v_cvt_pk_bf16_f32 v219, v202, v203
    s_add_u32 s52, s38, 0
    buffer_store_dword v219, v63, s[16:19], s52 offen sc0 sc1
    v_cvt_pk_bf16_f32 v220, v204, v205
    s_add_u32 s52, s38, 12416
    buffer_store_dword v220, v63, s[16:19], s52 offen sc0 sc1
    v_cvt_pk_bf16_f32 v223, v206, v207
    s_add_u32 s52, s38, 297984
    buffer_store_dword v223, v63, s[16:19], s52 offen sc0 sc1
    v_cvt_pk_bf16_f32 v224, v208, v209
    s_add_u32 s52, s38, 310400
    buffer_store_dword v224, v63, s[16:19], s52 offen sc0 sc1
    v_cvt_pk_bf16_f32 v227, v210, v211
    s_add_u32 s52, s38, 893952
    buffer_store_dword v227, v63, s[16:19], s52 offen sc0 sc1
    v_cvt_pk_bf16_f32 v228, v212, v213
    s_add_u32 s52, s38, 906368
    buffer_store_dword v228, v63, s[16:19], s52 offen sc0 sc1
    s_branch L_bw0
L_bw:
    s_cmp_eq_u32 s28, 3
    s_cbranch_scc1 L_bw3
    s_mov_b32 m0, 51200
    s_mov_b32 s33, 24576
    buffer_load_dwordx4 v240, s[12:15], s33 offen offset:0 lds
    s_mov_b32 m0, 51200
    s_mov_b32 s33, 24576
    buffer_load_dwordx4 v241, s[12:15], s33 offen offset:1024 lds
    s_mov_b32 m0, 51200
    s_mov_b32 s33, 24576
    buffer_load_dwordx4 v242, s[12:15], s33 offen offset:2048 lds
    s_mov_b32 m0, 54272
    s_mov_b32 s33, 27648
    buffer_load_dwordx4 v240, s[12:15], s33 offen offset:0 lds
    s_mov_b32 m0, 54272
    s_mov_b32 s33, 27648
    buffer_load_dwordx4 v241, s[12:15], s33 offen offset:1024 lds
    s_mov_b32 m0, 54272
    s_mov_b32 s33, 27648
    buffer_load_dwordx4 v242, s[12:15], s33 offen offset:2048 lds
    s_mov_b32 m0, 57344
    s_mov_b32 s33, 30720
    buffer_load_dwordx4 v240, s[12:15], s33 offen offset:0 lds
    s_mov_b32 m0, 57344
    s_mov_b32 s33, 30720
    buffer_load_dwordx4 v241, s[12:15], s33 offen offset:1024 lds
    s_mov_b32 m0, 57344
    s_mov_b32 s33, 30720
    buffer_load_dwordx4 v242, s[12:15], s33 offen offset:2048 lds
    s_mov_b32 m0, 60416
    s_mov_b32 s33, 33792
    buffer_load_dwordx4 v240, s[12:15], s33 offen offset:0 lds
    s_mov_b32 m0, 60416
    s_mov_b32 s33, 33792
    buffer_load_dwordx4 v241, s[12:15], s33 offen offset:1024 lds
    s_mov_b32 m0, 60416
    s_mov_b32 s33, 33792
    buffer_load_dwordx4 v242, s[12:15], s33 offen offset:2048 lds
    s_mov_b32 m0, 63488
    s_mov_b32 s33, 36864
    buffer_load_dwordx4 v240, s[12:15], s33 offen offset:0 lds
    s_mov_b32 m0, 63488
    s_mov_b32 s33, 36864
    buffer_load_dwordx4 v241, s[12:15], s33 offen offset:1024 lds
    s_mov_b32 m0, 63488
    s_mov_b32 s33, 36864
    buffer_load_dwordx4 v242, s[12:15], s33 offen offset:2048 lds
    s_mov_b32 m0, 66560
    s_mov_b32 s33, 39936
    buffer_load_dwordx4 v240, s[12:15], s33 offen offset:0 lds
    s_mov_b32 m0, 66560
    s_mov_b32 s33, 39936
    buffer_load_dwordx4 v241, s[12:15], s33 offen offset:1024 lds
    s_mov_b32 m0, 66560
    s_mov_b32 s33, 39936
    buffer_load_dwordx4 v242, s[12:15], s33 offen offset:2048 lds
    s_mov_b32 m0, 69632
    s_mov_b32 s33, 43008
    buffer_load_dwordx4 v240, s[12:15], s33 offen offset:0 lds
    s_mov_b32 m0, 69632
    s_mov_b32 s33, 43008
    buffer_load_dwordx4 v241, s[12:15], s33 offen offset:1024 lds
    s_mov_b32 m0, 69632
    s_mov_b32 s33, 43008
    buffer_load_dwordx4 v242, s[12:15], s33 offen offset:2048 lds
    s_mov_b32 m0, 72704
    s_mov_b32 s33, 46080
    buffer_load_dwordx4 v240, s[12:15], s33 offen offset:0 lds
    s_mov_b32 m0, 72704
    s_mov_b32 s33, 46080
    buffer_load_dwordx4 v241, s[12:15], s33 offen offset:1024 lds
    s_mov_b32 m0, 72704
    s_mov_b32 s33, 46080
    buffer_load_dwordx4 v242, s[12:15], s33 offen offset:2048 lds
    s_branch L_bw4
L_bw3:
    s_mov_b32 m0, 131072
    s_mov_b32 s33, 49152
    buffer_load_dwordx4 v240, s[12:15], s33 offen offset:0 lds
    s_mov_b32 m0, 131072
    s_mov_b32 s33, 49152
    buffer_load_dwordx4 v241, s[12:15], s33 offen offset:1024 lds
    s_mov_b32 m0, 131072
    s_mov_b32 s33, 49152
    buffer_load_dwordx4 v242, s[12:15], s33 offen offset:2048 lds
    s_mov_b32 m0, 134144
    s_mov_b32 s33, 52224
    buffer_load_dwordx4 v240, s[12:15], s33 offen offset:0 lds
    s_mov_b32 m0, 134144
    s_mov_b32 s33, 52224
    buffer_load_dwordx4 v241, s[12:15], s33 offen offset:1024 lds
    s_mov_b32 m0, 134144
    s_mov_b32 s33, 52224
    buffer_load_dwordx4 v242, s[12:15], s33 offen offset:2048 lds
    s_mov_b32 m0, 137216
    s_mov_b32 s33, 55296
    buffer_load_dwordx4 v240, s[12:15], s33 offen offset:0 lds
    s_mov_b32 m0, 137216
    s_mov_b32 s33, 55296
    buffer_load_dwordx4 v241, s[12:15], s33 offen offset:1024 lds
    s_mov_b32 m0, 137216
    s_mov_b32 s33, 55296
    buffer_load_dwordx4 v242, s[12:15], s33 offen offset:2048 lds
    s_mov_b32 m0, 140288
    s_mov_b32 s33, 58368
    buffer_load_dwordx4 v240, s[12:15], s33 offen offset:0 lds
    s_mov_b32 m0, 140288
    s_mov_b32 s33, 58368
    buffer_load_dwordx4 v241, s[12:15], s33 offen offset:1024 lds
    s_mov_b32 m0, 140288
    s_mov_b32 s33, 58368
    buffer_load_dwordx4 v242, s[12:15], s33 offen offset:2048 lds
    s_mov_b32 m0, 143360
    s_mov_b32 s33, 61440
    buffer_load_dwordx4 v240, s[12:15], s33 offen offset:0 lds
    s_mov_b32 m0, 143360
    s_mov_b32 s33, 61440
    buffer_load_dwordx4 v241, s[12:15], s33 offen offset:1024 lds
    s_mov_b32 m0, 143360
    s_mov_b32 s33, 61440
    buffer_load_dwordx4 v242, s[12:15], s33 offen offset:2048 lds
    s_mov_b32 m0, 146432
    s_mov_b32 s33, 64512
    buffer_load_dwordx4 v240, s[12:15], s33 offen offset:0 lds
    s_mov_b32 m0, 146432
    s_mov_b32 s33, 64512
    buffer_load_dwordx4 v241, s[12:15], s33 offen offset:1024 lds
    s_mov_b32 m0, 146432
    s_mov_b32 s33, 64512
    buffer_load_dwordx4 v242, s[12:15], s33 offen offset:2048 lds
    s_mov_b32 m0, 149504
    s_mov_b32 s33, 67584
    buffer_load_dwordx4 v240, s[12:15], s33 offen offset:0 lds
    s_mov_b32 m0, 149504
    s_mov_b32 s33, 67584
    buffer_load_dwordx4 v241, s[12:15], s33 offen offset:1024 lds
    s_mov_b32 m0, 149504
    s_mov_b32 s33, 67584
    buffer_load_dwordx4 v242, s[12:15], s33 offen offset:2048 lds
    s_mov_b32 m0, 152576
    s_mov_b32 s33, 70656
    buffer_load_dwordx4 v240, s[12:15], s33 offen offset:0 lds
    s_mov_b32 m0, 152576
    s_mov_b32 s33, 70656
    buffer_load_dwordx4 v241, s[12:15], s33 offen offset:1024 lds
    s_mov_b32 m0, 152576
    s_mov_b32 s33, 70656
    buffer_load_dwordx4 v242, s[12:15], s33 offen offset:2048 lds
L_bw4:
L_bw0:
    s_add_u32 s52, s3, 344064
    s_add_u32 m0, s26, 25600
    s_mov_b64 exec, s[98:99]
    buffer_load_dwordx4 v58, s[4:7], s52 offen nt lds
    s_mov_b64 exec, -1
    s_add_u32 s52, s24, 344832
    s_add_u32 m0, s26, 26400
    s_mov_b64 exec, s[98:99]
    buffer_load_dwordx4 v59, s[4:7], s52 offen nt lds
    s_mov_b64 exec, -1
    s_waitcnt vmcnt(26)
    s_barrier
    ds_read_b128 v[70:73], v60 offset:0
    ds_read_b64 v[74:75], v61 offset:0
    ds_read_b128 v[82:85], v60 offset:3456
    ds_read_b64 v[86:87], v61 offset:3456
    ds_read_b128 v[106:109], v60 offset:6912
    ds_read_b64 v[110:111], v61 offset:6912
    ds_read_b64_tr_b16 a[0:1], v51 offset:25600
    ds_read_b64_tr_b16 a[2:3], v51 offset:27136
    ds_read_b64_tr_b16 a[4:5], v51 offset:25608
    ds_read_b64_tr_b16 a[6:7], v51 offset:27144
    ds_read_b64_tr_b16 a[8:9], v52 offset:25600
    ds_read_b64_tr_b16 a[10:11], v52 offset:27136
    ds_read_b128 a[72:75], v45 offset:0
    ds_read_b128 a[76:79], v45 offset:6400
    ds_read_b128 a[80:83], v45 offset:12800
    ds_read_b128 a[84:87], v45 offset:19200
    s_add_u32 s52, s3, 430080
    s_add_u32 m0, s26, 32000
    s_mov_b64 exec, s[98:99]
    buffer_load_dwordx4 v58, s[4:7], s52 offen nt lds
    s_mov_b64 exec, -1
    s_add_u32 s52, s24, 430848
    s_add_u32 m0, s26, 32800
    s_mov_b64 exec, s[98:99]
    buffer_load_dwordx4 v59, s[4:7], s52 offen nt lds
    s_mov_b64 exec, -1
    s_add_u32 s52, s25, 129024
    s_add_u32 m0, s27, 112768
    s_mov_b64 exec, s[0:1]
    buffer_load_dwordx4 v31, s[8:11], s52 offen nt lds
    s_mov_b64 exec, -1
    s_add_u32 s52, s3, 516096
    s_add_u32 m0, s26, 38400
    s_mov_b64 exec, s[98:99]
    buffer_load_dwordx4 v58, s[4:7], s52 offen nt lds
    s_mov_b64 exec, -1
    s_waitcnt lgkmcnt(10)
    v_lshlrev_b32 v64, 16, v70
    ds_read_b64_tr_b16 a[12:13], v51 offset:37888
    v_and_b32 v65, s31, v70
    v_lshlrev_b32 v66, 16, v71
    v_and_b32 v67, s31, v71
    ds_read_b64_tr_b16 a[14:15], v51 offset:39424
    v_lshlrev_b32 v68, 16, v72
    v_and_b32 v69, s31, v72
    v_lshlrev_b32 v70, 16, v73
    ds_read_b64_tr_b16 a[16:17], v51 offset:37896
    v_and_b32 v71, s31, v73
    v_lshlrev_b32 v72, 16, v74
    v_and_b32 v73, s31, v74
    ds_read_b64_tr_b16 a[18:19], v51 offset:39432
    v_lshlrev_b32 v74, 16, v75
    v_and_b32 v75, s31, v75
    v_lshlrev_b32 v88, 16, v82
    ds_read_b64_tr_b16 a[20:21], v52 offset:37888
    v_and_b32 v89, s31, v82
    v_lshlrev_b32 v90, 16, v83
    v_and_b32 v91, s31, v83
    ds_read_b64_tr_b16 a[22:23], v52 offset:39424
    v_lshlrev_b32 v92, 16, v84
    v_and_b32 v93, s31, v84
    v_lshlrev_b32 v94, 16, v85
    ds_read_b128 a[88:91], v45 offset:64
    v_and_b32 v95, s31, v85
    v_lshlrev_b32 v96, 16, v86
    v_and_b32 v97, s31, v86
    ds_read_b128 a[92:95], v45 offset:6464
    v_lshlrev_b32 v98, 16, v87
    v_and_b32 v99, s31, v87
    v_lshlrev_b32 v112, 16, v106
    ds_read_b128 a[96:99], v45 offset:12864
    v_and_b32 v113, s31, v106
    v_lshlrev_b32 v114, 16, v107
    v_and_b32 v115, s31, v107
    ds_read_b128 a[100:103], v45 offset:19264
    v_lshlrev_b32 v116, 16, v108
    v_and_b32 v117, s31, v108
    v_lshlrev_b32 v118, 16, v109
    v_and_b32 v119, s31, v109
    v_lshlrev_b32 v120, 16, v110
    v_and_b32 v121, s31, v110
    v_lshlrev_b32 v122, 16, v111
    v_and_b32 v123, s31, v111
    s_nop 1
    s_waitcnt lgkmcnt(13)
    v_mfma_f32_16x16x32_bf16 v[64:67], a[0:3], a[72:75], v[64:67]
    ds_read_b128 a[104:107], v45 offset:128
    ds_read_b128 a[108:111], v45 offset:6528
    v_mfma_f32_16x16x32_bf16 v[68:71], a[4:7], a[72:75], v[68:71]
    ds_read_b128 a[112:115], v45 offset:12928
    ds_read_b128 a[116:119], v45 offset:19328
    v_mfma_f32_16x16x32_bf16 v[72:75], a[8:11], a[72:75], v[72:75]
    s_waitcnt lgkmcnt(15)
    v_mfma_f32_16x16x32_bf16 v[76:79], a[0:3], a[76:79], v[88:91]
    v_mfma_f32_16x16x32_bf16 v[80:83], a[4:7], a[76:79], v[92:95]
    s_add_u32 s52, s24, 516864
    s_add_u32 m0, s26, 39200
    s_mov_b64 exec, s[98:99]
    buffer_load_dwordx4 v59, s[4:7], s52 offen nt lds
    s_mov_b64 exec, -1
    v_mfma_f32_16x16x32_bf16 v[84:87], a[8:11], a[76:79], v[96:99]
    v_mfma_f32_16x16x32_bf16 v[88:91], a[0:3], a[80:83], v[88:91]
    v_mfma_f32_16x16x32_bf16 v[92:95], a[4:7], a[80:83], v[92:95]
    v_mfma_f32_16x16x32_bf16 v[96:99], a[8:11], a[80:83], v[96:99]
    s_waitcnt lgkmcnt(14)
    v_mfma_f32_16x16x32_bf16 v[100:103], a[0:3], a[84:87], v[112:115]
    s_add_u32 s52, s3, 602112
    s_add_u32 m0, s26, 44800
    s_mov_b64 exec, s[98:99]
    buffer_load_dwordx4 v58, s[4:7], s52 offen nt lds
    s_mov_b64 exec, -1
    v_mfma_f32_16x16x32_bf16 v[104:107], a[4:7], a[84:87], v[116:119]
    v_mfma_f32_16x16x32_bf16 v[108:111], a[8:11], a[84:87], v[120:123]
    s_waitcnt lgkmcnt(7)
    v_mfma_f32_16x16x32_bf16 v[64:67], a[12:15], a[88:91], v[64:67]
    ds_read_b128 a[72:75], v45 offset:192
    ds_read_b128 a[76:79], v45 offset:6592
    v_mfma_f32_16x16x32_bf16 v[68:71], a[16:19], a[88:91], v[68:71]
    s_cmp_eq_u32 s28, 3
    s_cbranch_scc1 L_bq1
    s_waitcnt vmcnt(8)
L_bq1:
    s_barrier
    s_cmp_lg_u32 s28, 0
    s_cbranch_scc1 L_nf
    v_mov_b32 v39, 1
    s_lshr_b32 s35, s2, 3
    v_lshlrev_b32 v39, s35, v39
    buffer_atomic_or v39, v13, s[56:59], 0 offen sc1
L_nf:
    v_mfma_f32_16x16x32_bf16 v[72:75], a[20:23], a[88:91], v[72:75]
    s_add_u32 s52, s24, 602880
    s_add_u32 m0, s26, 45600
    s_mov_b64 exec, s[98:99]
    buffer_load_dwordx4 v59, s[4:7], s52 offen nt lds
    s_mov_b64 exec, -1
    s_waitcnt lgkmcnt(8)
    v_mfma_f32_16x16x32_bf16 v[76:79], a[12:15], a[92:95], v[76:79]
    ds_read_b64_tr_b16 a[24:25], v51 offset:0
    ds_read_b64_tr_b16 a[26:27], v51 offset:1536
    v_mfma_f32_16x16x32_bf16 v[80:83], a[16:19], a[92:95], v[80:83]
    ds_read_b64_tr_b16 a[28:29], v51 offset:8
    ds_read_b64_tr_b16 a[30:31], v51 offset:1544
    v_mfma_f32_16x16x32_bf16 v[84:87], a[20:23], a[92:95], v[84:87]
    ds_read_b64_tr_b16 a[32:33], v52 offset:0
    ds_read_b64_tr_b16 a[34:35], v52 offset:1536
    s_waitcnt lgkmcnt(13)
    v_mfma_f32_16x16x32_bf16 v[88:91], a[12:15], a[96:99], v[88:91]
    ds_read_b128 a[80:83], v45 offset:12992
    ds_read_b128 a[84:87], v45 offset:19392
    v_mfma_f32_16x16x32_bf16 v[92:95], a[16:19], a[96:99], v[92:95]
    s_add_u32 s52, s25, 172032
    s_add_u32 m0, s27, 116224
    s_mov_b64 exec, s[0:1]
    buffer_load_dwordx4 v31, s[8:11], s52 offen nt lds
    s_mov_b64 exec, -1
    v_mfma_f32_16x16x32_bf16 v[96:99], a[20:23], a[96:99], v[96:99]
    ds_read_b64_tr_b16 a[36:37], v51 offset:12288
    ds_read_b64_tr_b16 a[38:39], v51 offset:13824
    s_waitcnt lgkmcnt(15)
    v_mfma_f32_16x16x32_bf16 v[100:103], a[12:15], a[100:103], v[100:103]
    ds_read_b64_tr_b16 a[40:41], v51 offset:12296
    ds_read_b64_tr_b16 a[42:43], v51 offset:13832
    v_mfma_f32_16x16x32_bf16 v[104:107], a[16:19], a[100:103], v[104:107]
    ds_read_b64_tr_b16 a[44:45], v52 offset:12288
    ds_read_b64_tr_b16 a[46:47], v52 offset:13824
    v_mfma_f32_16x16x32_bf16 v[108:111], a[20:23], a[100:103], v[108:111]
    s_waitcnt lgkmcnt(8)
    v_mfma_f32_16x16x32_bf16 v[64:67], a[24:27], a[104:107], v[64:67]
    s_add_u32 s52, s3, 688128
    buffer_load_dwordx4 a[120:123], v58, s[4:7], s52 offen nt
    v_mfma_f32_16x16x32_bf16 v[68:71], a[28:31], a[104:107], v[68:71]
    ds_read_b128 a[88:91], v45 offset:256
    ds_read_b128 a[92:95], v45 offset:6656
    v_mfma_f32_16x16x32_bf16 v[72:75], a[32:35], a[104:107], v[72:75]
    ds_read_b128 a[96:99], v45 offset:13056
    ds_read_b128 a[100:103], v45 offset:19456
    v_mfma_f32_16x16x32_bf16 v[76:79], a[24:27], a[108:111], v[76:79]
    v_mfma_f32_16x16x32_bf16 v[80:83], a[28:31], a[108:111], v[80:83]
    v_mfma_f32_16x16x32_bf16 v[84:87], a[32:35], a[108:111], v[84:87]
    s_add_u32 s52, s24, 688896
    buffer_load_dwordx4 a[124:127], v59, s[4:7], s52 offen nt
    v_mfma_f32_16x16x32_bf16 v[88:91], a[24:27], a[112:115], v[88:91]
    v_mfma_f32_16x16x32_bf16 v[92:95], a[28:31], a[112:115], v[92:95]
    v_mfma_f32_16x16x32_bf16 v[96:99], a[32:35], a[112:115], v[96:99]
    v_mfma_f32_16x16x32_bf16 v[100:103], a[24:27], a[116:119], v[100:103]
    v_mfma_f32_16x16x32_bf16 v[104:107], a[28:31], a[116:119], v[104:107]
    s_add_u32 s52, s3, 774144
    buffer_load_dwordx4 a[128:131], v58, s[4:7], s52 offen nt
    v_mfma_f32_16x16x32_bf16 v[108:111], a[32:35], a[116:119], v[108:111]
    s_waitcnt lgkmcnt(4)
    v_mfma_f32_16x16x32_bf16 v[64:67], a[36:39], a[72:75], v[64:67]
    ds_read_b128 a[104:107], v45 offset:320
    ds_read_b128 a[108:111], v45 offset:6720
    v_mfma_f32_16x16x32_bf16 v[68:71], a[40:43], a[72:75], v[68:71]
    s_cmp_lg_u32 s28, 3
    s_cbranch_scc1 L_bq2
    s_waitcnt vmcnt(13)
L_bq2:
    s_barrier
    v_mfma_f32_16x16x32_bf16 v[72:75], a[44:47], a[72:75], v[72:75]
    ds_read_b64_tr_b16 a[48:49], v53 offset:0
    ds_read_b64_tr_b16 a[50:51], v53 offset:1536
    v_mfma_f32_16x16x32_bf16 v[76:79], a[36:39], a[76:79], v[76:79]
    s_add_u32 s52, s24, 774912
    buffer_load_dwordx4 a[132:135], v59, s[4:7], s52 offen nt
    v_mfma_f32_16x16x32_bf16 v[80:83], a[40:43], a[76:79], v[80:83]
    ds_read_b64_tr_b16 a[52:53], v53 offset:8
    ds_read_b64_tr_b16 a[54:55], v53 offset:1544
    v_mfma_f32_16x16x32_bf16 v[84:87], a[44:47], a[76:79], v[84:87]
    ds_read_b64_tr_b16 a[56:57], v54 offset:0
    ds_read_b64_tr_b16 a[58:59], v54 offset:1536
    v_mfma_f32_16x16x32_bf16 v[88:91], a[36:39], a[80:83], v[88:91]
    ds_read_b128 a[112:115], v45 offset:13120
    ds_read_b128 a[116:119], v45 offset:19520
    v_mfma_f32_16x16x32_bf16 v[92:95], a[40:43], a[80:83], v[92:95]
    ds_read_b64_tr_b16 a[60:61], v53 offset:12288
    ds_read_b64_tr_b16 a[62:63], v53 offset:13824
    v_mfma_f32_16x16x32_bf16 v[96:99], a[44:47], a[80:83], v[96:99]
    s_add_u32 s52, s25, 215040
    s_add_u32 m0, s27, 119680
    s_mov_b64 exec, s[0:1]
    buffer_load_dwordx4 v31, s[8:11], s52 offen nt lds
    s_mov_b64 exec, -1
    v_mfma_f32_16x16x32_bf16 v[100:103], a[36:39], a[84:87], v[100:103]
    ds_read_b64_tr_b16 a[64:65], v53 offset:12296
    ds_read_b64_tr_b16 a[66:67], v53 offset:13832
    v_mfma_f32_16x16x32_bf16 v[104:107], a[40:43], a[84:87], v[104:107]
    ds_read_b64_tr_b16 a[68:69], v54 offset:12288
    ds_read_b64_tr_b16 a[70:71], v54 offset:13824
    v_mfma_f32_16x16x32_bf16 v[108:111], a[44:47], a[84:87], v[108:111]
    s_waitcnt lgkmcnt(8)
    v_mfma_f32_16x16x32_bf16 v[64:67], a[48:51], a[88:91], v[64:67]
    v_mfma_f32_16x16x32_bf16 v[68:71], a[52:55], a[88:91], v[68:71]
    s_add_u32 s52, s3, 860160
    buffer_load_dwordx4 a[136:139], v58, s[4:7], s52 offen nt
    v_mfma_f32_16x16x32_bf16 v[72:75], a[56:59], a[88:91], v[72:75]
    v_mfma_f32_16x16x32_bf16 v[76:79], a[48:51], a[92:95], v[76:79]
    v_mfma_f32_16x16x32_bf16 v[80:83], a[52:55], a[92:95], v[80:83]
    v_mfma_f32_16x16x32_bf16 v[84:87], a[56:59], a[92:95], v[84:87]
    v_mfma_f32_16x16x32_bf16 v[88:91], a[48:51], a[96:99], v[88:91]
    s_add_u32 s52, s24, 860928
    buffer_load_dwordx4 a[140:143], v59, s[4:7], s52 offen nt
    v_mfma_f32_16x16x32_bf16 v[92:95], a[52:55], a[96:99], v[92:95]
    v_mfma_f32_16x16x32_bf16 v[96:99], a[56:59], a[96:99], v[96:99]
    v_mfma_f32_16x16x32_bf16 v[100:103], a[48:51], a[100:103], v[100:103]
    v_mfma_f32_16x16x32_bf16 v[104:107], a[52:55], a[100:103], v[104:107]
    v_mfma_f32_16x16x32_bf16 v[108:111], a[56:59], a[100:103], v[108:111]
    s_waitcnt vmcnt(12)
    s_waitcnt lgkmcnt(0)
    s_barrier
    v_mfma_f32_16x16x32_bf16 v[64:67], a[60:63], a[104:107], v[64:67]
    s_add_u32 s52, s3, 946176
    buffer_load_dwordx4 a[144:147], v58, s[4:7], s52 offen nt
    v_mfma_f32_16x16x32_bf16 v[68:71], a[64:67], a[104:107], v[68:71]
    ds_read_b128 a[72:75], v45 offset:25600
    ds_read_b128 a[76:79], v45 offset:25664
    v_mfma_f32_16x16x32_bf16 v[72:75], a[68:71], a[104:107], v[72:75]
    ds_read_b128 a[80:83], v45 offset:25728
    ds_read_b128 a[84:87], v45 offset:25792
    v_mfma_f32_16x16x32_bf16 v[76:79], a[60:63], a[108:111], v[76:79]
    ds_read_b128 a[88:91], v45 offset:25856
    ds_read_b128 a[92:95], v45 offset:25920
    v_mfma_f32_16x16x32_bf16 v[80:83], a[64:67], a[108:111], v[80:83]
    ds_read_b128 v[130:133], v60 offset:10368
    ds_read_b64 v[134:135], v61 offset:10368
    v_mfma_f32_16x16x32_bf16 v[84:87], a[68:71], a[108:111], v[84:87]
    s_add_u32 s52, s24, 946944
    buffer_load_dwordx4 a[148:151], v59, s[4:7], s52 offen nt
    v_mfma_f32_16x16x32_bf16 v[88:91], a[60:63], a[112:115], v[88:91]
    s_waitcnt lgkmcnt(0)
    v_lshlrev_b32 v136, 16, v130
    v_mfma_f32_16x16x32_bf16 v[92:95], a[64:67], a[112:115], v[92:95]
    v_and_b32 v137, s31, v130
    v_lshlrev_b32 v138, 16, v131
    v_mfma_f32_16x16x32_bf16 v[96:99], a[68:71], a[112:115], v[96:99]
    v_and_b32 v139, s31, v131
    v_lshlrev_b32 v140, 16, v132
    v_mfma_f32_16x16x32_bf16 v[100:103], a[60:63], a[116:119], v[100:103]
    v_and_b32 v141, s31, v132
    v_lshlrev_b32 v142, 16, v133
    v_mfma_f32_16x16x32_bf16 v[104:107], a[64:67], a[116:119], v[104:107]
    s_add_u32 s52, s25, 258048
    s_add_u32 m0, s27, 123136
    s_mov_b64 exec, s[0:1]
    buffer_load_dwordx4 v31, s[8:11], s52 offen nt lds
    s_mov_b64 exec, -1
    v_mfma_f32_16x16x32_bf16 v[108:111], a[68:71], a[116:119], v[108:111]
    v_and_b32 v143, s31, v133
    v_lshlrev_b32 v144, 16, v134
    v_mfma_f32_16x16x32_bf16 v[112:115], a[0:3], a[72:75], v[112:115]
    ds_read_b128 a[96:99], v45 offset:32000
    v_and_b32 v145, s31, v134
    v_mfma_f32_16x16x32_bf16 v[116:119], a[4:7], a[72:75], v[116:119]
    v_lshlrev_b32 v146, 16, v135
    v_and_b32 v147, s31, v135
    v_mfma_f32_16x16x32_bf16 v[120:123], a[8:11], a[72:75], v[120:123]
    v_mfma_f32_16x16x32_bf16 v[112:115], a[12:15], a[76:79], v[112:115]
    ds_read_b128 a[100:103], v45 offset:32064
    v_cvt_pk_bf16_f32 v64, v64, v65
    v_cvt_pk_bf16_f32 v65, v66, v67
    v_mfma_f32_16x16x32_bf16 v[116:119], a[16:19], a[76:79], v[116:119]
    s_add_u32 s52, s3, 1032192
    buffer_load_dwordx4 a[152:155], v58, s[4:7], s52 offen nt
    v_cvt_pk_bf16_f32 v66, v68, v69
    v_mfma_f32_16x16x32_bf16 v[120:123], a[20:23], a[76:79], v[120:123]
    v_cvt_pk_bf16_f32 v67, v70, v71
    v_cvt_pk_bf16_f32 v68, v72, v73
    v_cvt_pk_bf16_f32 v69, v74, v75
    v_mfma_f32_16x16x32_bf16 v[112:115], a[24:27], a[80:83], v[112:115]
    ds_read_b128 a[104:107], v45 offset:32128
    ds_write_b128 v47, v[64:67] offset:0
    v_mfma_f32_16x16x32_bf16 v[116:119], a[28:31], a[80:83], v[116:119]
    ds_write_b64 v49, v[68:69] offset:0
    v_cvt_pk_bf16_f32 v76, v76, v77
    v_mfma_f32_16x16x32_bf16 v[120:123], a[32:35], a[80:83], v[120:123]
    v_cvt_pk_bf16_f32 v77, v78, v79
    v_cvt_pk_bf16_f32 v78, v80, v81
    v_cvt_pk_bf16_f32 v79, v82, v83
    v_mfma_f32_16x16x32_bf16 v[112:115], a[36:39], a[84:87], v[112:115]
    ds_read_b128 a[108:111], v45 offset:32192
    v_cvt_pk_bf16_f32 v80, v84, v85
    v_cvt_pk_bf16_f32 v81, v86, v87
    v_mfma_f32_16x16x32_bf16 v[116:119], a[40:43], a[84:87], v[116:119]
    s_add_u32 s52, s24, 1032960
    buffer_load_dwordx4 a[156:159], v59, s[4:7], s52 offen nt
    v_mfma_f32_16x16x32_bf16 v[120:123], a[44:47], a[84:87], v[120:123]
    ds_write_b128 v47, v[76:79] offset:6400
    v_mfma_f32_16x16x32_bf16 v[112:115], a[48:51], a[88:91], v[112:115]
    ds_read_b128 a[112:115], v45 offset:32256
    ds_write_b64 v49, v[80:81] offset:6400
    v_mfma_f32_16x16x32_bf16 v[116:119], a[52:55], a[88:91], v[116:119]
    v_cvt_pk_bf16_f32 v88, v88, v89
    v_cvt_pk_bf16_f32 v89, v90, v91
    v_mfma_f32_16x16x32_bf16 v[120:123], a[56:59], a[88:91], v[120:123]
    v_cvt_pk_bf16_f32 v90, v92, v93
    v_cvt_pk_bf16_f32 v91, v94, v95
    v_mfma_f32_16x16x32_bf16 v[112:115], a[60:63], a[92:95], v[112:115]
    ds_read_b128 a[116:119], v45 offset:32320
    v_cvt_pk_bf16_f32 v92, v96, v97
    v_mfma_f32_16x16x32_bf16 v[116:119], a[64:67], a[92:95], v[116:119]
    s_add_u32 s52, s3, 1118208
    buffer_load_dwordx4 a[160:163], v58, s[4:7], s52 offen nt
    v_mfma_f32_16x16x32_bf16 v[120:123], a[68:71], a[92:95], v[120:123]
    v_cvt_pk_bf16_f32 v93, v98, v99
    s_waitcnt lgkmcnt(7)
    v_mfma_f32_16x16x32_bf16 v[124:127], a[0:3], a[96:99], v[136:139]
    ds_write_b128 v47, v[88:91] offset:12800
    v_mfma_f32_16x16x32_bf16 v[128:131], a[4:7], a[96:99], v[140:143]
    ds_write_b64 v49, v[92:93] offset:12800
    v_mfma_f32_16x16x32_bf16 v[132:135], a[8:11], a[96:99], v[144:147]
    v_cvt_pk_bf16_f32 v100, v100, v101
    v_cvt_pk_bf16_f32 v101, v102, v103
    v_mfma_f32_16x16x32_bf16 v[124:127], a[12:15], a[100:103], v[124:127]
    s_add_u32 s52, s24, 1118976
    buffer_load_dwordx4 a[164:167], v59, s[4:7], s52 offen nt
    v_mfma_f32_16x16x32_bf16 v[128:131], a[16:19], a[100:103], v[128:131]
    v_cvt_pk_bf16_f32 v102, v104, v105
    v_cvt_pk_bf16_f32 v103, v106, v107
    v_mfma_f32_16x16x32_bf16 v[132:135], a[20:23], a[100:103], v[132:135]
    v_cvt_pk_bf16_f32 v104, v108, v109
    v_cvt_pk_bf16_f32 v105, v110, v111
    v_mfma_f32_16x16x32_bf16 v[124:127], a[24:27], a[104:107], v[124:127]
    ds_write_b128 v47, v[100:103] offset:19200
    v_mfma_f32_16x16x32_bf16 v[128:131], a[28:31], a[104:107], v[128:131]
    ds_write_b64 v49, v[104:105] offset:19200
    v_mfma_f32_16x16x32_bf16 v[132:135], a[32:35], a[104:107], v[132:135]
    s_waitcnt vmcnt(14)
    s_waitcnt lgkmcnt(0)
    s_barrier
    v_mfma_f32_16x16x32_bf16 v[124:127], a[36:39], a[108:111], v[124:127]
    ds_read_b128 a[72:75], v45 offset:38400
    ds_read_b128 v[154:157], v60 offset:13824
    v_mfma_f32_16x16x32_bf16 v[128:131], a[40:43], a[108:111], v[128:131]
    ds_read_b128 a[76:79], v45 offset:38464
    ds_read_b64 v[158:159], v61 offset:13824
    v_mfma_f32_16x16x32_bf16 v[132:135], a[44:47], a[108:111], v[132:135]
    ds_read_b128 a[80:83], v45 offset:38528
    v_cvt_pk_bf16_f32 v112, v112, v113
    v_mfma_f32_16x16x32_bf16 v[124:127], a[48:51], a[112:115], v[124:127]
    ds_read_b128 a[84:87], v45 offset:38592
    v_cvt_pk_bf16_f32 v113, v114, v115
    v_mfma_f32_16x16x32_bf16 v[128:131], a[52:55], a[112:115], v[128:131]
    ds_read_b128 a[88:91], v45 offset:38656
    v_cvt_pk_bf16_f32 v114, v116, v117
    v_mfma_f32_16x16x32_bf16 v[132:135], a[56:59], a[112:115], v[132:135]
    ds_read_b128 a[92:95], v45 offset:38720
    v_cvt_pk_bf16_f32 v115, v118, v119
    v_mfma_f32_16x16x32_bf16 v[124:127], a[60:63], a[116:119], v[124:127]
    s_add_u32 s52, s25, 301056
    s_add_u32 m0, s27, 126592
    s_mov_b64 exec, s[0:1]
    buffer_load_dwordx4 v31, s[8:11], s52 offen nt lds
    s_mov_b64 exec, -1
    v_mfma_f32_16x16x32_bf16 v[128:131], a[64:67], a[116:119], v[128:131]
    s_waitcnt lgkmcnt(4)
    v_lshlrev_b32 v160, 16, v154
    v_mfma_f32_16x16x32_bf16 v[132:135], a[68:71], a[116:119], v[132:135]
    v_and_b32 v161, s31, v154
    s_waitcnt lgkmcnt(3)
    v_mfma_f32_16x16x32_bf16 v[136:139], a[0:3], a[72:75], v[136:139]
    ds_read_b128 a[96:99], v45 offset:44800
    v_lshlrev_b32 v162, 16, v155
    v_mfma_f32_16x16x32_bf16 v[140:143], a[4:7], a[72:75], v[140:143]
    v_and_b32 v163, s31, v155
    v_lshlrev_b32 v164, 16, v156
    v_mfma_f32_16x16x32_bf16 v[144:147], a[8:11], a[72:75], v[144:147]
    s_add_u32 s52, s3, 1204224
    buffer_load_dwordx4 a[168:171], v58, s[4:7], s52 offen nt
    v_mfma_f32_16x16x32_bf16 v[136:139], a[12:15], a[76:79], v[136:139]
    ds_read_b128 a[100:103], v45 offset:44864
    v_and_b32 v165, s31, v156
    v_mfma_f32_16x16x32_bf16 v[140:143], a[16:19], a[76:79], v[140:143]
    v_lshlrev_b32 v166, 16, v157
    v_and_b32 v167, s31, v157
    v_mfma_f32_16x16x32_bf16 v[144:147], a[20:23], a[76:79], v[144:147]
    v_lshlrev_b32 v168, 16, v158
    v_and_b32 v169, s31, v158
    v_mfma_f32_16x16x32_bf16 v[136:139], a[24:27], a[80:83], v[136:139]
    ds_read_b128 a[104:107], v45 offset:44928
    v_lshlrev_b32 v170, 16, v159
    v_mfma_f32_16x16x32_bf16 v[140:143], a[28:31], a[80:83], v[140:143]
    s_add_u32 s52, s24, 1204992
    buffer_load_dwordx4 a[172:175], v59, s[4:7], s52 offen nt
    v_mfma_f32_16x16x32_bf16 v[144:147], a[32:35], a[80:83], v[144:147]
    s_waitcnt lgkmcnt(3)
    v_and_b32 v171, s31, v159
    v_mfma_f32_16x16x32_bf16 v[136:139], a[36:39], a[84:87], v[136:139]
    ds_read_b128 a[108:111], v45 offset:44992
    v_cvt_pk_bf16_f32 v116, v120, v121
    v_mfma_f32_16x16x32_bf16 v[140:143], a[40:43], a[84:87], v[140:143]
    v_cvt_pk_bf16_f32 v117, v122, v123
    v_mfma_f32_16x16x32_bf16 v[144:147], a[44:47], a[84:87], v[144:147]
    ds_write_b128 v47, v[112:115] offset:25600
    v_mfma_f32_16x16x32_bf16 v[136:139], a[48:51], a[88:91], v[136:139]
    ds_read_b128 a[112:115], v45 offset:45056
    v_mfma_f32_16x16x32_bf16 v[140:143], a[52:55], a[88:91], v[140:143]
    s_add_u32 s52, s3, 1290240
    buffer_load_dwordx4 a[176:179], v58, s[4:7], s52 offen nt
    v_mfma_f32_16x16x32_bf16 v[144:147], a[56:59], a[88:91], v[144:147]
    ds_write_b64 v49, v[116:117] offset:25600
    v_mfma_f32_16x16x32_bf16 v[136:139], a[60:63], a[92:95], v[136:139]
    ds_read_b128 a[116:119], v45 offset:45120
    v_cvt_pk_bf16_f32 v124, v124, v125
    v_mfma_f32_16x16x32_bf16 v[140:143], a[64:67], a[92:95], v[140:143]
    v_cvt_pk_bf16_f32 v125, v126, v127
    v_cvt_pk_bf16_f32 v126, v128, v129
    v_mfma_f32_16x16x32_bf16 v[144:147], a[68:71], a[92:95], v[144:147]
    v_cvt_pk_bf16_f32 v127, v130, v131
    s_waitcnt lgkmcnt(5)
    v_mfma_f32_16x16x32_bf16 v[148:151], a[0:3], a[96:99], v[160:163]
    s_add_u32 s52, s24, 1291008
    buffer_load_dwordx4 a[180:183], v59, s[4:7], s52 offen nt
    v_mfma_f32_16x16x32_bf16 v[152:155], a[4:7], a[96:99], v[164:167]
    v_cvt_pk_bf16_f32 v128, v132, v133
    v_cvt_pk_bf16_f32 v129, v134, v135
    v_mfma_f32_16x16x32_bf16 v[156:159], a[8:11], a[96:99], v[168:171]
    ds_write_b128 v47, v[124:127] offset:32000
    v_mfma_f32_16x16x32_bf16 v[148:151], a[12:15], a[100:103], v[148:151]
    ds_write_b64 v49, v[128:129] offset:32000
    v_mfma_f32_16x16x32_bf16 v[152:155], a[16:19], a[100:103], v[152:155]
    s_waitcnt vmcnt(14)
    ds_write_b128 v55, a[120:123] offset:0
    v_mfma_f32_16x16x32_bf16 v[156:159], a[20:23], a[100:103], v[156:159]
    ds_write_b128 v55, a[124:127] offset:800
    v_mfma_f32_16x16x32_bf16 v[148:151], a[24:27], a[104:107], v[148:151]
    ds_write_b128 v55, a[128:131] offset:6400
    v_mfma_f32_16x16x32_bf16 v[152:155], a[28:31], a[104:107], v[152:155]
    ds_write_b128 v55, a[132:135] offset:7200
    v_mfma_f32_16x16x32_bf16 v[156:159], a[32:35], a[104:107], v[156:159]
    s_waitcnt lgkmcnt(0)
    s_barrier
    v_mfma_f32_16x16x32_bf16 v[148:151], a[36:39], a[108:111], v[148:151]
    ds_read_b128 a[72:75], v46 offset:0
    ds_read_b128 v[178:181], v60 offset:17280
    v_mfma_f32_16x16x32_bf16 v[152:155], a[40:43], a[108:111], v[152:155]
    ds_read_b128 a[76:79], v46 offset:64
    ds_read_b64 v[182:183], v61 offset:17280
    v_mfma_f32_16x16x32_bf16 v[156:159], a[44:47], a[108:111], v[156:159]
    ds_read_b128 a[80:83], v46 offset:128
    v_cvt_pk_bf16_f32 v136, v136, v137
    v_mfma_f32_16x16x32_bf16 v[148:151], a[48:51], a[112:115], v[148:151]
    ds_read_b128 a[84:87], v46 offset:192
    v_cvt_pk_bf16_f32 v137, v138, v139
    v_mfma_f32_16x16x32_bf16 v[152:155], a[52:55], a[112:115], v[152:155]
    ds_read_b128 a[88:91], v46 offset:256
    v_cvt_pk_bf16_f32 v138, v140, v141
    v_mfma_f32_16x16x32_bf16 v[156:159], a[56:59], a[112:115], v[156:159]
    ds_read_b128 a[92:95], v46 offset:320
    v_cvt_pk_bf16_f32 v139, v142, v143
    v_mfma_f32_16x16x32_bf16 v[148:151], a[60:63], a[116:119], v[148:151]
    s_add_u32 s52, s25, 344064
    s_add_u32 m0, s27, 159744
    s_mov_b64 exec, s[0:1]
    buffer_load_dwordx4 v31, s[8:11], s52 offen nt lds
    s_mov_b64 exec, -1
    v_mfma_f32_16x16x32_bf16 v[152:155], a[64:67], a[116:119], v[152:155]
    s_waitcnt lgkmcnt(4)
    v_lshlrev_b32 v184, 16, v178
    v_mfma_f32_16x16x32_bf16 v[156:159], a[68:71], a[116:119], v[156:159]
    v_and_b32 v185, s31, v178
    s_waitcnt lgkmcnt(3)
    v_mfma_f32_16x16x32_bf16 v[160:163], a[0:3], a[72:75], v[160:163]
    ds_read_b128 a[96:99], v46 offset:6400
    v_lshlrev_b32 v186, 16, v179
    v_mfma_f32_16x16x32_bf16 v[164:167], a[4:7], a[72:75], v[164:167]
    v_and_b32 v187, s31, v179
    v_lshlrev_b32 v188, 16, v180
    v_mfma_f32_16x16x32_bf16 v[168:171], a[8:11], a[72:75], v[168:171]
    v_and_b32 v189, s31, v180
    v_lshlrev_b32 v190, 16, v181
    v_mfma_f32_16x16x32_bf16 v[160:163], a[12:15], a[76:79], v[160:163]
    ds_read_b128 a[100:103], v46 offset:6464
    v_and_b32 v191, s31, v181
    v_mfma_f32_16x16x32_bf16 v[164:167], a[16:19], a[76:79], v[164:167]
    v_lshlrev_b32 v192, 16, v182
    v_and_b32 v193, s31, v182
    v_mfma_f32_16x16x32_bf16 v[168:171], a[20:23], a[76:79], v[168:171]
    v_lshlrev_b32 v194, 16, v183
    v_and_b32 v195, s31, v183
    v_mfma_f32_16x16x32_bf16 v[160:163], a[24:27], a[80:83], v[160:163]
    ds_read_b128 a[104:107], v46 offset:6528
    v_cvt_pk_bf16_f32 v140, v144, v145
    v_mfma_f32_16x16x32_bf16 v[164:167], a[28:31], a[80:83], v[164:167]
    v_cvt_pk_bf16_f32 v141, v146, v147
    v_mfma_f32_16x16x32_bf16 v[168:171], a[32:35], a[80:83], v[168:171]
    s_waitcnt lgkmcnt(3)
    v_mfma_f32_16x16x32_bf16 v[160:163], a[36:39], a[84:87], v[160:163]
    ds_read_b128 a[108:111], v46 offset:6592
    v_mfma_f32_16x16x32_bf16 v[164:167], a[40:43], a[84:87], v[164:167]
    ds_write_b128 v47, v[136:139] offset:38400
    v_mfma_f32_16x16x32_bf16 v[168:171], a[44:47], a[84:87], v[168:171]
    ds_write_b64 v49, v[140:141] offset:38400
    v_mfma_f32_16x16x32_bf16 v[160:163], a[48:51], a[88:91], v[160:163]
    ds_read_b128 a[112:115], v46 offset:6656
    v_cvt_pk_bf16_f32 v148, v148, v149
    v_mfma_f32_16x16x32_bf16 v[164:167], a[52:55], a[88:91], v[164:167]
    v_cvt_pk_bf16_f32 v149, v150, v151
    v_cvt_pk_bf16_f32 v150, v152, v153
    v_mfma_f32_16x16x32_bf16 v[168:171], a[56:59], a[88:91], v[168:171]
    v_cvt_pk_bf16_f32 v151, v154, v155
    v_cvt_pk_bf16_f32 v152, v156, v157
    v_mfma_f32_16x16x32_bf16 v[160:163], a[60:63], a[92:95], v[160:163]
    ds_read_b128 a[116:119], v46 offset:6720
    v_cvt_pk_bf16_f32 v153, v158, v159
    v_mfma_f32_16x16x32_bf16 v[164:167], a[64:67], a[92:95], v[164:167]
    ds_write_b128 v47, v[148:151] offset:44800
    v_mfma_f32_16x16x32_bf16 v[168:171], a[68:71], a[92:95], v[168:171]
    s_waitcnt lgkmcnt(6)
    v_mfma_f32_16x16x32_bf16 v[172:175], a[0:3], a[96:99], v[184:187]
    ds_write_b64 v49, v[152:153] offset:44800
    v_mfma_f32_16x16x32_bf16 v[176:179], a[4:7], a[96:99], v[188:191]
    buffer_load_dword v12, v40, s[56:59], 0 offen sc0 sc1
    v_mfma_f32_16x16x32_bf16 v[180:183], a[8:11], a[96:99], v[192:195]
    v_mfma_f32_16x16x32_bf16 v[172:175], a[12:15], a[100:103], v[172:175]
    v_mfma_f32_16x16x32_bf16 v[176:179], a[16:19], a[100:103], v[176:179]
    s_waitcnt vmcnt(11)
    ds_write_b128 v55, a[136:139] offset:12800
    v_mfma_f32_16x16x32_bf16 v[180:183], a[20:23], a[100:103], v[180:183]
    ds_write_b128 v55, a[140:143] offset:13600
    v_mfma_f32_16x16x32_bf16 v[172:175], a[24:27], a[104:107], v[172:175]
    ds_write_b128 v55, a[144:147] offset:19200
    v_mfma_f32_16x16x32_bf16 v[176:179], a[28:31], a[104:107], v[176:179]
    ds_write_b128 v55, a[148:151] offset:20000
    v_mfma_f32_16x16x32_bf16 v[180:183], a[32:35], a[104:107], v[180:183]
    s_waitcnt lgkmcnt(0)
    s_barrier
    v_mfma_f32_16x16x32_bf16 v[172:175], a[36:39], a[108:111], v[172:175]
    ds_read_b128 a[72:75], v46 offset:12800
    ds_read_b128 v[202:205], v60 offset:20736
    v_mfma_f32_16x16x32_bf16 v[176:179], a[40:43], a[108:111], v[176:179]
    ds_read_b128 a[76:79], v46 offset:12864
    ds_read_b64 v[206:207], v61 offset:20736
    v_mfma_f32_16x16x32_bf16 v[180:183], a[44:47], a[108:111], v[180:183]
    ds_read_b128 a[80:83], v46 offset:12928
    v_cvt_pk_bf16_f32 v160, v160, v161
    v_mfma_f32_16x16x32_bf16 v[172:175], a[48:51], a[112:115], v[172:175]
    ds_read_b128 a[84:87], v46 offset:12992
    v_cvt_pk_bf16_f32 v161, v162, v163
    v_mfma_f32_16x16x32_bf16 v[176:179], a[52:55], a[112:115], v[176:179]
    ds_read_b128 a[88:91], v46 offset:13056
    v_cvt_pk_bf16_f32 v162, v164, v165
    v_mfma_f32_16x16x32_bf16 v[180:183], a[56:59], a[112:115], v[180:183]
    ds_read_b128 a[92:95], v46 offset:13120
    v_cvt_pk_bf16_f32 v163, v166, v167
    v_mfma_f32_16x16x32_bf16 v[172:175], a[60:63], a[116:119], v[172:175]
    v_cvt_pk_bf16_f32 v164, v168, v169
    v_cvt_pk_bf16_f32 v165, v170, v171
    v_mfma_f32_16x16x32_bf16 v[176:179], a[64:67], a[116:119], v[176:179]
    s_waitcnt lgkmcnt(4)
    v_lshlrev_b32 v208, 16, v202
    v_mfma_f32_16x16x32_bf16 v[180:183], a[68:71], a[116:119], v[180:183]
    v_and_b32 v209, s31, v202
    s_waitcnt lgkmcnt(3)
    v_mfma_f32_16x16x32_bf16 v[184:187], a[0:3], a[72:75], v[184:187]
    ds_read_b128 a[96:99], v46 offset:19200
    v_lshlrev_b32 v210, 16, v203
    v_mfma_f32_16x16x32_bf16 v[188:191], a[4:7], a[72:75], v[188:191]
    v_and_b32 v211, s31, v203
    v_lshlrev_b32 v212, 16, v204
    v_mfma_f32_16x16x32_bf16 v[192:195], a[8:11], a[72:75], v[192:195]
    v_and_b32 v213, s31, v204
    v_lshlrev_b32 v214, 16, v205
    v_mfma_f32_16x16x32_bf16 v[184:187], a[12:15], a[76:79], v[184:187]
    ds_read_b128 a[100:103], v46 offset:19264
    v_and_b32 v215, s31, v205
    v_mfma_f32_16x16x32_bf16 v[188:191], a[16:19], a[76:79], v[188:191]
    v_lshlrev_b32 v216, 16, v206
    v_and_b32 v217, s31, v206
    v_mfma_f32_16x16x32_bf16 v[192:195], a[20:23], a[76:79], v[192:195]
    v_lshlrev_b32 v218, 16, v207
    v_and_b32 v219, s31, v207
    v_mfma_f32_16x16x32_bf16 v[184:187], a[24:27], a[80:83], v[184:187]
    ds_read_b128 a[104:107], v46 offset:19328
    v_mfma_f32_16x16x32_bf16 v[188:191], a[28:31], a[80:83], v[188:191]
    ds_write_b128 v48, v[160:163] offset:0
    v_mfma_f32_16x16x32_bf16 v[192:195], a[32:35], a[80:83], v[192:195]
    s_waitcnt lgkmcnt(4)
    v_mfma_f32_16x16x32_bf16 v[184:187], a[36:39], a[84:87], v[184:187]
    ds_read_b128 a[108:111], v46 offset:19392
    v_mfma_f32_16x16x32_bf16 v[188:191], a[40:43], a[84:87], v[188:191]
    ds_write_b64 v50, v[164:165] offset:0
    v_mfma_f32_16x16x32_bf16 v[192:195], a[44:47], a[84:87], v[192:195]
    v_cvt_pk_bf16_f32 v172, v172, v173
    v_cvt_pk_bf16_f32 v173, v174, v175
    v_mfma_f32_16x16x32_bf16 v[184:187], a[48:51], a[88:91], v[184:187]
    ds_read_b128 a[112:115], v46 offset:19456
    v_cvt_pk_bf16_f32 v174, v176, v177
    v_mfma_f32_16x16x32_bf16 v[188:191], a[52:55], a[88:91], v[188:191]
    v_cvt_pk_bf16_f32 v175, v178, v179
    v_cvt_pk_bf16_f32 v176, v180, v181
    v_mfma_f32_16x16x32_bf16 v[192:195], a[56:59], a[88:91], v[192:195]
    v_cvt_pk_bf16_f32 v177, v182, v183
    v_mfma_f32_16x16x32_bf16 v[184:187], a[60:63], a[92:95], v[184:187]
    ds_read_b128 a[116:119], v46 offset:19520
    v_mfma_f32_16x16x32_bf16 v[188:191], a[64:67], a[92:95], v[188:191]
    ds_write_b128 v48, v[172:175] offset:6400
    v_mfma_f32_16x16x32_bf16 v[192:195], a[68:71], a[92:95], v[192:195]
    s_waitcnt lgkmcnt(6)
    v_mfma_f32_16x16x32_bf16 v[196:199], a[0:3], a[96:99], v[208:211]
    ds_write_b64 v50, v[176:177] offset:6400
    v_mfma_f32_16x16x32_bf16 v[200:203], a[4:7], a[96:99], v[212:215]
    v_mfma_f32_16x16x32_bf16 v[204:207], a[8:11], a[96:99], v[216:219]
    v_mfma_f32_16x16x32_bf16 v[196:199], a[12:15], a[100:103], v[196:199]
    v_mfma_f32_16x16x32_bf16 v[200:203], a[16:19], a[100:103], v[200:203]
    s_waitcnt vmcnt(6)
    ds_write_b128 v56, a[152:155] offset:0
    v_mfma_f32_16x16x32_bf16 v[204:207], a[20:23], a[100:103], v[204:207]
    ds_write_b128 v56, a[156:159] offset:800
    v_mfma_f32_16x16x32_bf16 v[196:199], a[24:27], a[104:107], v[196:199]
    ds_write_b128 v56, a[160:163] offset:6400
    v_mfma_f32_16x16x32_bf16 v[200:203], a[28:31], a[104:107], v[200:203]
    ds_write_b128 v56, a[164:167] offset:7200
    v_mfma_f32_16x16x32_bf16 v[204:207], a[32:35], a[104:107], v[204:207]
    s_waitcnt vmcnt(0)
    s_cmp_lg_u32 s28, 3
    s_cbranch_scc1 L_polled
    v_and_b32 v39, 7, v32
    v_cmp_eq_u32 vcc, 0, v39
    v_mov_b32 v39, 0x3ffff
    s_nop 0
    v_cndmask_b32 v39, 0, v39, vcc
L_poll:
    v_cmp_ne_u32 vcc, v39, v12
    s_nop 1
    s_or_b32 s60, vcc_lo, vcc_hi
    s_cbranch_scc0 L_polled
    s_sleep 16
    buffer_load_dword v12, v40, s[56:59], 0 offen sc0 sc1
    s_waitcnt vmcnt(0)
    s_branch L_poll
L_polled:
    s_waitcnt lgkmcnt(0)
    s_barrier
    v_mfma_f32_16x16x32_bf16 v[196:199], a[36:39], a[108:111], v[196:199]
    ds_read_b128 a[72:75], v30 offset:0
    ds_read_b128 v[226:229], v60 offset:24192
    v_mfma_f32_16x16x32_bf16 v[200:203], a[40:43], a[108:111], v[200:203]
    ds_read_b128 a[76:79], v30 offset:64
    ds_read_b64 v[230:231], v61 offset:24192
    v_mfma_f32_16x16x32_bf16 v[204:207], a[44:47], a[108:111], v[204:207]
    ds_read_b128 a[80:83], v30 offset:128
    v_cvt_pk_bf16_f32 v184, v184, v185
    v_mfma_f32_16x16x32_bf16 v[196:199], a[48:51], a[112:115], v[196:199]
    ds_read_b128 a[84:87], v30 offset:192
    v_cvt_pk_bf16_f32 v185, v186, v187
    v_mfma_f32_16x16x32_bf16 v[200:203], a[52:55], a[112:115], v[200:203]
    ds_read_b128 a[88:91], v30 offset:256
    v_cvt_pk_bf16_f32 v186, v188, v189
    v_mfma_f32_16x16x32_bf16 v[204:207], a[56:59], a[112:115], v[204:207]
    ds_read_b128 a[92:95], v30 offset:320
    v_cvt_pk_bf16_f32 v187, v190, v191
    v_mfma_f32_16x16x32_bf16 v[196:199], a[60:63], a[116:119], v[196:199]
    s_mov_b32 s54, 0
    buffer_load_dwordx4 a[192:195], v6, s[16:19], s54 offen offset:0
    v_mfma_f32_16x16x32_bf16 v[200:203], a[64:67], a[116:119], v[200:203]
    s_waitcnt lgkmcnt(4)
    v_lshlrev_b32 v232, 16, v226
    v_mfma_f32_16x16x32_bf16 v[204:207], a[68:71], a[116:119], v[204:207]
    v_and_b32 v233, s31, v226
    s_waitcnt lgkmcnt(3)
    v_mfma_f32_16x16x32_bf16 v[208:211], a[0:3], a[72:75], v[208:211]
    ds_read_b128 a[96:99], v30 offset:6400
    v_lshlrev_b32 v234, 16, v227
    v_mfma_f32_16x16x32_bf16 v[212:215], a[4:7], a[72:75], v[212:215]
    buffer_load_dwordx4 a[196:199], v6, s[16:19], s54 offen offset:1024
    v_mfma_f32_16x16x32_bf16 v[216:219], a[8:11], a[72:75], v[216:219]
    v_and_b32 v235, s31, v227
    v_lshlrev_b32 v236, 16, v228
    v_mfma_f32_16x16x32_bf16 v[208:211], a[12:15], a[76:79], v[208:211]
    ds_read_b128 a[100:103], v30 offset:6464
    v_and_b32 v237, s31, v228
    v_mfma_f32_16x16x32_bf16 v[212:215], a[16:19], a[76:79], v[212:215]
    buffer_load_dwordx4 a[200:203], v6, s[16:19], s54 offen offset:2048
    v_mfma_f32_16x16x32_bf16 v[216:219], a[20:23], a[76:79], v[216:219]
    v_lshlrev_b32 v238, 16, v229
    v_and_b32 v239, s31, v229
    v_mfma_f32_16x16x32_bf16 v[208:211], a[24:27], a[80:83], v[208:211]
    ds_read_b128 a[104:107], v30 offset:6528
    v_lshlrev_b32 v240, 16, v230
    v_mfma_f32_16x16x32_bf16 v[212:215], a[28:31], a[80:83], v[212:215]
    s_add_u32 s54, s54, s44
    buffer_load_dwordx4 a[204:207], v6, s[16:19], s54 offen offset:0
    v_mfma_f32_16x16x32_bf16 v[216:219], a[32:35], a[80:83], v[216:219]
    s_waitcnt lgkmcnt(3)
    v_and_b32 v241, s31, v230
    v_mfma_f32_16x16x32_bf16 v[208:211], a[36:39], a[84:87], v[208:211]
    ds_read_b128 a[108:111], v30 offset:6592
    v_lshlrev_b32 v242, 16, v231
    v_mfma_f32_16x16x32_bf16 v[212:215], a[40:43], a[84:87], v[212:215]
    buffer_load_dwordx4 a[208:211], v6, s[16:19], s54 offen offset:1024
    v_mfma_f32_16x16x32_bf16 v[216:219], a[44:47], a[84:87], v[216:219]
    v_and_b32 v243, s31, v231
    v_cvt_pk_bf16_f32 v188, v192, v193
    v_mfma_f32_16x16x32_bf16 v[208:211], a[48:51], a[88:91], v[208:211]
    ds_read_b128 a[112:115], v30 offset:6656
    v_cvt_pk_bf16_f32 v189, v194, v195
    v_mfma_f32_16x16x32_bf16 v[212:215], a[52:55], a[88:91], v[212:215]
    buffer_load_dwordx4 a[212:215], v6, s[16:19], s54 offen offset:2048
    v_mfma_f32_16x16x32_bf16 v[216:219], a[56:59], a[88:91], v[216:219]
    ds_write_b128 v48, v[184:187] offset:12800
    v_mfma_f32_16x16x32_bf16 v[208:211], a[60:63], a[92:95], v[208:211]
    ds_read_b128 a[116:119], v30 offset:6720
    v_mfma_f32_16x16x32_bf16 v[212:215], a[64:67], a[92:95], v[212:215]
    s_add_u32 s54, s54, s44
    buffer_load_dwordx4 a[216:219], v6, s[16:19], s54 offen offset:0
    v_mfma_f32_16x16x32_bf16 v[216:219], a[68:71], a[92:95], v[216:219]
    s_waitcnt lgkmcnt(4)
    v_mfma_f32_16x16x32_bf16 v[220:223], a[0:3], a[96:99], v[232:235]
    ds_write_b64 v50, v[188:189] offset:12800
    v_mfma_f32_16x16x32_bf16 v[224:227], a[4:7], a[96:99], v[236:239]
    buffer_load_dwordx4 a[220:223], v6, s[16:19], s54 offen offset:1024
    v_mfma_f32_16x16x32_bf16 v[228:231], a[8:11], a[96:99], v[240:243]
    v_cvt_pk_bf16_f32 v196, v196, v197
    v_cvt_pk_bf16_f32 v197, v198, v199
    v_mfma_f32_16x16x32_bf16 v[220:223], a[12:15], a[100:103], v[220:223]
    v_cvt_pk_bf16_f32 v198, v200, v201
    v_cvt_pk_bf16_f32 v199, v202, v203
    v_mfma_f32_16x16x32_bf16 v[224:227], a[16:19], a[100:103], v[224:227]
    ds_write_b128 v56, a[168:171] offset:12800
    v_mfma_f32_16x16x32_bf16 v[228:231], a[20:23], a[100:103], v[228:231]
    ds_write_b128 v56, a[172:175] offset:13600
    v_mfma_f32_16x16x32_bf16 v[220:223], a[24:27], a[104:107], v[220:223]
    ds_write_b128 v56, a[176:179] offset:19200
    v_mfma_f32_16x16x32_bf16 v[224:227], a[28:31], a[104:107], v[224:227]
    ds_write_b128 v56, a[180:183] offset:20000
    v_mfma_f32_16x16x32_bf16 v[228:231], a[32:35], a[104:107], v[228:231]
    s_waitcnt lgkmcnt(0)
    s_barrier
    v_mfma_f32_16x16x32_bf16 v[220:223], a[36:39], a[108:111], v[220:223]
    ds_read_b128 a[72:75], v30 offset:12800
    ds_read_b128 v[250:253], v60 offset:57344
    v_mfma_f32_16x16x32_bf16 v[224:227], a[40:43], a[108:111], v[224:227]
    ds_read_b128 a[76:79], v30 offset:12864
    ds_read_b64 v[254:255], v61 offset:57344
    v_mfma_f32_16x16x32_bf16 v[228:231], a[44:47], a[108:111], v[228:231]
    ds_read_b128 a[80:83], v30 offset:12928
    v_cvt_pk_bf16_f32 v200, v204, v205
    v_mfma_f32_16x16x32_bf16 v[220:223], a[48:51], a[112:115], v[220:223]
    ds_read_b128 a[84:87], v30 offset:12992
    v_cvt_pk_bf16_f32 v201, v206, v207
    v_mfma_f32_16x16x32_bf16 v[224:227], a[52:55], a[112:115], v[224:227]
    ds_read_b128 a[88:91], v30 offset:13056
    v_mfma_f32_16x16x32_bf16 v[228:231], a[56:59], a[112:115], v[228:231]
    ds_read_b128 a[92:95], v30 offset:13120
    v_mfma_f32_16x16x32_bf16 v[220:223], a[60:63], a[116:119], v[220:223]
    buffer_load_dwordx4 a[224:227], v6, s[16:19], s54 offen offset:2048
    v_mfma_f32_16x16x32_bf16 v[224:227], a[64:67], a[116:119], v[224:227]
    s_waitcnt lgkmcnt(4)
    v_lshlrev_b32 v244, 16, v250
    v_mfma_f32_16x16x32_bf16 v[228:231], a[68:71], a[116:119], v[228:231]
    v_and_b32 v245, s31, v250
    s_waitcnt lgkmcnt(3)
    v_mfma_f32_16x16x32_bf16 v[232:235], a[0:3], a[72:75], v[232:235]
    ds_read_b128 a[96:99], v30 offset:19200
    v_lshlrev_b32 v246, 16, v251
    v_and_b32 v247, s31, v251
    v_mfma_f32_16x16x32_bf16 v[236:239], a[4:7], a[72:75], v[236:239]
    s_add_u32 s54, s54, s44
    buffer_load_dwordx4 a[228:231], v6, s[16:19], s54 offen offset:0
    v_lshlrev_b32 v248, 16, v252
    v_mfma_f32_16x16x32_bf16 v[240:243], a[8:11], a[72:75], v[240:243]
    v_and_b32 v249, s31, v252
    v_lshlrev_b32 v250, 16, v253
    v_and_b32 v251, s31, v253
    v_mfma_f32_16x16x32_bf16 v[232:235], a[12:15], a[76:79], v[232:235]
    ds_read_b128 a[100:103], v30 offset:19264
    v_lshlrev_b32 v252, 16, v254
    v_and_b32 v253, s31, v254
    v_mfma_f32_16x16x32_bf16 v[236:239], a[16:19], a[76:79], v[236:239]
    buffer_load_dwordx4 a[232:235], v6, s[16:19], s54 offen offset:1024
    v_lshlrev_b32 v254, 16, v255
    v_mfma_f32_16x16x32_bf16 v[240:243], a[20:23], a[76:79], v[240:243]
    v_and_b32 v255, s31, v255
    ds_write_b128 v48, v[196:199] offset:19200
    v_mfma_f32_16x16x32_bf16 v[232:235], a[24:27], a[80:83], v[232:235]
    ds_read_b128 a[104:107], v30 offset:19328
    ds_write_b64 v50, v[200:201] offset:19200
    v_mfma_f32_16x16x32_bf16 v[236:239], a[28:31], a[80:83], v[236:239]
    buffer_load_dwordx4 a[236:239], v6, s[16:19], s54 offen offset:2048
    v_cvt_pk_bf16_f32 v208, v208, v209
    v_mfma_f32_16x16x32_bf16 v[240:243], a[32:35], a[80:83], v[240:243]
    s_waitcnt lgkmcnt(5)
    v_cvt_pk_bf16_f32 v209, v210, v211
    v_cvt_pk_bf16_f32 v210, v212, v213
    v_mfma_f32_16x16x32_bf16 v[232:235], a[36:39], a[84:87], v[232:235]
    ds_read_b128 a[108:111], v30 offset:19392
    v_cvt_pk_bf16_f32 v211, v214, v215
    v_cvt_pk_bf16_f32 v212, v216, v217
    v_mfma_f32_16x16x32_bf16 v[236:239], a[40:43], a[84:87], v[236:239]
    s_lshr_b32 s39, s2, 3
    s_mul_i32 s39, s39, 37248
    v_lshlrev_b32 v35, 7, v0
    buffer_load_dword v62, v35, s[16:19], s39 offen
    v_cvt_pk_bf16_f32 v213, v218, v219
    v_mfma_f32_16x16x32_bf16 v[240:243], a[44:47], a[84:87], v[240:243]
    ds_write_b128 v48, v[208:211] offset:25600
    v_mfma_f32_16x16x32_bf16 v[232:235], a[48:51], a[88:91], v[232:235]
    ds_read_b128 a[112:115], v30 offset:19456
    ds_write_b64 v50, v[212:213] offset:25600
    v_mfma_f32_16x16x32_bf16 v[236:239], a[52:55], a[88:91], v[236:239]
    v_min_u32 v35, 4352, v35
    s_add_u32 s39, s39, 32768
    buffer_load_dword v62, v35, s[16:19], s39 offen
    v_cvt_pk_bf16_f32 v220, v220, v221
    v_mfma_f32_16x16x32_bf16 v[240:243], a[56:59], a[88:91], v[240:243]
    v_cvt_pk_bf16_f32 v221, v222, v223
    v_cvt_pk_bf16_f32 v222, v224, v225
    v_cvt_pk_bf16_f32 v223, v226, v227
    v_mfma_f32_16x16x32_bf16 v[232:235], a[60:63], a[92:95], v[232:235]
    ds_read_b128 a[116:119], v30 offset:19520
    v_cvt_pk_bf16_f32 v224, v228, v229
    v_cvt_pk_bf16_f32 v225, v230, v231
    v_mfma_f32_16x16x32_bf16 v[236:239], a[64:67], a[92:95], v[236:239]
    s_getpc_b64 s[60:61]
L_pc2:
    v_mul_u32_u24 v63, 128, v0
    v_add_u32 v63, L_main-L_pc2, v63
    v_min_u32 v63, L_end-L_pc2, v63
    global_load_dword v63, v63, s[60:61]
    v_mfma_f32_16x16x32_bf16 v[240:243], a[68:71], a[92:95], v[240:243]
    ds_write_b128 v48, v[220:223] offset:32000
    s_waitcnt lgkmcnt(7)
    v_mfma_f32_16x16x32_bf16 v[244:247], a[0:3], a[96:99], v[244:247]
    ds_write_b64 v50, v[224:225] offset:32000
    v_mfma_f32_16x16x32_bf16 v[248:251], a[4:7], a[96:99], v[248:251]
    v_mfma_f32_16x16x32_bf16 v[252:255], a[8:11], a[96:99], v[252:255]
    v_mfma_f32_16x16x32_bf16 v[244:247], a[12:15], a[100:103], v[244:247]
    v_cvt_pk_bf16_f32 v232, v232, v233
    v_cvt_pk_bf16_f32 v233, v234, v235
    v_cvt_pk_bf16_f32 v234, v236, v237
    v_mfma_f32_16x16x32_bf16 v[248:251], a[16:19], a[100:103], v[248:251]
    v_cvt_pk_bf16_f32 v235, v238, v239
    v_cvt_pk_bf16_f32 v236, v240, v241
    v_cvt_pk_bf16_f32 v237, v242, v243
    v_mfma_f32_16x16x32_bf16 v[252:255], a[20:23], a[100:103], v[252:255]
    ds_write_b128 v48, v[232:235] offset:38400
    v_mfma_f32_16x16x32_bf16 v[244:247], a[24:27], a[104:107], v[244:247]
    ds_write_b64 v50, v[236:237] offset:38400
    v_mfma_f32_16x16x32_bf16 v[248:251], a[28:31], a[104:107], v[248:251]
    v_mfma_f32_16x16x32_bf16 v[252:255], a[32:35], a[104:107], v[252:255]
    s_waitcnt lgkmcnt(4)
    v_mfma_f32_16x16x32_bf16 v[244:247], a[36:39], a[108:111], v[244:247]
    v_mfma_f32_16x16x32_bf16 v[248:251], a[40:43], a[108:111], v[248:251]
    v_mfma_f32_16x16x32_bf16 v[252:255], a[44:47], a[108:111], v[252:255]
    v_mfma_f32_16x16x32_bf16 v[244:247], a[48:51], a[112:115], v[244:247]
    v_mfma_f32_16x16x32_bf16 v[248:251], a[52:55], a[112:115], v[248:251]
    v_mfma_f32_16x16x32_bf16 v[252:255], a[56:59], a[112:115], v[252:255]
    v_mfma_f32_16x16x32_bf16 v[244:247], a[60:63], a[116:119], v[244:247]
    v_mfma_f32_16x16x32_bf16 v[248:251], a[64:67], a[116:119], v[248:251]
    v_mfma_f32_16x16x32_bf16 v[252:255], a[68:71], a[116:119], v[252:255]
    s_nop 6
    v_cvt_pk_bf16_f32 v244, v244, v245
    v_cvt_pk_bf16_f32 v245, v246, v247
    v_cvt_pk_bf16_f32 v246, v248, v249
    v_cvt_pk_bf16_f32 v247, v250, v251
    v_cvt_pk_bf16_f32 v248, v252, v253
    v_cvt_pk_bf16_f32 v249, v254, v255
    ds_write_b128 v48, v[244:247] offset:44800
    ds_write_b64 v50, v[248:249] offset:44800
    s_waitcnt lgkmcnt(0)
    s_barrier
L_main:
    ds_read_b64_tr_b16 a[96:97], v4 offset:0
    ds_read_b64_tr_b16 a[98:99], v4 offset:3200
    ds_read_b64_tr_b16 a[100:101], v4 offset:12800
    ds_read_b64_tr_b16 a[102:103], v4 offset:16000
    ds_read_b64_tr_b16 a[104:105], v4 offset:25600
    ds_read_b64_tr_b16 a[106:107], v4 offset:28800
    ds_read_b64_tr_b16 a[108:109], v4 offset:38400
    ds_read_b64_tr_b16 a[110:111], v4 offset:41600
    ds_read_b64_tr_b16 a[112:113], v5 offset:0
    ds_read_b64_tr_b16 a[114:115], v5 offset:3200
    ds_read_b64_tr_b16 a[116:117], v5 offset:12800
    ds_read_b64_tr_b16 a[118:119], v5 offset:16000
    ds_read_b64_tr_b16 a[120:121], v5 offset:25600
    ds_read_b64_tr_b16 a[122:123], v5 offset:28800
    s_waitcnt lgkmcnt(12)
    v_mfma_f32_16x16x32_bf16 v[112:115], a[96:99], v[16:19], 0
    v_mfma_f32_16x16x32_bf16 v[116:119], a[96:99], v[20:23], 0
    s_waitcnt lgkmcnt(10)
    v_mfma_f32_16x16x32_bf16 v[120:123], a[100:103], v[16:19], 0
    v_mfma_f32_16x16x32_bf16 v[124:127], a[100:103], v[20:23], 0
    s_waitcnt lgkmcnt(8)
    v_mfma_f32_16x16x32_bf16 v[128:131], a[104:107], v[16:19], 0
    v_mfma_f32_16x16x32_bf16 v[132:135], a[104:107], v[20:23], 0
    s_waitcnt lgkmcnt(6)
    v_mfma_f32_16x16x32_bf16 v[136:139], a[108:111], v[16:19], 0
    v_mfma_f32_16x16x32_bf16 v[140:143], a[108:111], v[20:23], 0
    s_waitcnt lgkmcnt(4)
    v_mfma_f32_16x16x32_bf16 v[144:147], a[112:115], v[16:19], 0
    v_mfma_f32_16x16x32_bf16 v[148:151], a[112:115], v[20:23], 0
    s_waitcnt lgkmcnt(2)
    v_mfma_f32_16x16x32_bf16 v[152:155], a[116:119], v[16:19], 0
    v_mfma_f32_16x16x32_bf16 v[156:159], a[116:119], v[20:23], 0
    s_waitcnt lgkmcnt(0)
    v_mfma_f32_16x16x32_bf16 v[160:163], a[120:123], v[16:19], 0
    v_mfma_f32_16x16x32_bf16 v[164:167], a[120:123], v[20:23], 0
    s_nop 1
    v_cvt_pk_bf16_f32 v112, v112, v113
    v_cvt_pk_bf16_f32 v113, v114, v115
    ds_write_b64 v3, v[112:113] offset:0
    v_cvt_pk_bf16_f32 v116, v116, v117
    v_cvt_pk_bf16_f32 v117, v118, v119
    ds_write_b64 v3, v[116:117] offset:14336
    v_cvt_pk_bf16_f32 v120, v120, v121
    v_cvt_pk_bf16_f32 v121, v122, v123
    ds_write_b64 v3, v[120:121] offset:1024
    v_cvt_pk_bf16_f32 v124, v124, v125
    v_cvt_pk_bf16_f32 v125, v126, v127
    ds_write_b64 v3, v[124:125] offset:15360
    v_cvt_pk_bf16_f32 v128, v128, v129
    v_cvt_pk_bf16_f32 v129, v130, v131
    ds_write_b64 v3, v[128:129] offset:2048
    v_cvt_pk_bf16_f32 v132, v132, v133
    v_cvt_pk_bf16_f32 v133, v134, v135
    ds_write_b64 v3, v[132:133] offset:16384
    v_cvt_pk_bf16_f32 v136, v136, v137
    v_cvt_pk_bf16_f32 v137, v138, v139
    ds_write_b64 v3, v[136:137] offset:3072
    v_cvt_pk_bf16_f32 v140, v140, v141
    v_cvt_pk_bf16_f32 v141, v142, v143
    ds_write_b64 v3, v[140:141] offset:17408
    v_cvt_pk_bf16_f32 v144, v144, v145
    v_cvt_pk_bf16_f32 v145, v146, v147
    ds_write_b64 v3, v[144:145] offset:4096
    v_cvt_pk_bf16_f32 v148, v148, v149
    v_cvt_pk_bf16_f32 v149, v150, v151
    ds_write_b64 v3, v[148:149] offset:18432
    v_cvt_pk_bf16_f32 v152, v152, v153
    v_cvt_pk_bf16_f32 v153, v154, v155
    ds_write_b64 v3, v[152:153] offset:5120
    v_cvt_pk_bf16_f32 v156, v156, v157
    v_cvt_pk_bf16_f32 v157, v158, v159
    ds_write_b64 v3, v[156:157] offset:19456
    v_cvt_pk_bf16_f32 v160, v160, v161
    v_cvt_pk_bf16_f32 v161, v162, v163
    ds_write_b64 v3, v[160:161] offset:6144
    v_cvt_pk_bf16_f32 v164, v164, v165
    v_cvt_pk_bf16_f32 v165, v166, v167
    ds_write_b64 v3, v[164:165] offset:20480
    ds_read_b64_tr_b16 a[248:249], v4 offset:128
    ds_read_b64_tr_b16 a[250:251], v4 offset:3328
    s_waitcnt vmcnt(0)
    s_waitcnt lgkmcnt(0)
    s_barrier
    ds_read_b128 v[32:35], v1 offset:7168
    ds_read_b128 v[36:39], v1 offset:9216
    ds_read_b128 v[40:43], v1 offset:11264
    ds_read_b128 v[44:47], v14 offset:13312
    s_waitcnt lgkmcnt(0)
    v_mfma_f32_16x16x32_bf16 v[112:115], a[192:195], v[32:35], 0
    v_mfma_f32_16x16x32_bf16 v[124:127], a[192:195], v[36:39], 0
    ds_read_b128 v[48:51], v1 offset:14336
    s_mov_b32 s54, 49664
    v_mfma_f32_16x16x32_bf16 v[136:139], a[192:195], v[40:43], 0
    ds_read_b128 v[52:55], v1 offset:16384
    v_mfma_f32_16x16x32_bf16 v[24:27], a[248:251], v[16:19], 0
    ds_read_b128 v[56:59], v1 offset:18432
    v_mfma_f32_16x16x32_bf16 v[148:151], a[192:195], v[44:47], 0
    ds_read_b128 v[60:63], v14 offset:20480
    v_mfma_f32_16x16x32_bf16 v[28:31], a[248:251], v[20:23], 0
    buffer_load_dwordx4 a[192:195], v6, s[16:19], s54 offen offset:0
    v_mfma_f32_16x16x32_bf16 v[116:119], a[196:199], v[32:35], 0
    ds_read_b64_tr_b16 a[252:253], v4 offset:12928
    v_mfma_f32_16x16x32_bf16 v[128:131], a[196:199], v[36:39], 0
    ds_read_b64_tr_b16 a[254:255], v4 offset:16128
    v_cvt_pk_bf16_f32 v24, v24, v25
    v_mfma_f32_16x16x32_bf16 v[140:143], a[196:199], v[40:43], 0
    v_cvt_pk_bf16_f32 v25, v26, v27
    v_cvt_pk_bf16_f32 v28, v28, v29
    v_mfma_f32_16x16x32_bf16 v[152:155], a[196:199], v[44:47], 0
    ds_write_b64 v3, v[24:25] offset:28672
    v_mfma_f32_16x16x32_bf16 v[120:123], a[200:203], v[32:35], 0
    v_cvt_pk_bf16_f32 v29, v30, v31
    v_mfma_f32_16x16x32_bf16 v[132:135], a[200:203], v[36:39], 0
    buffer_load_dwordx4 a[196:199], v6, s[16:19], s54 offen offset:1024
    v_mfma_f32_16x16x32_bf16 v[144:147], a[200:203], v[40:43], 0
    ds_write_b64 v3, v[28:29] offset:43008
    v_mfma_f32_16x16x32_bf16 v[156:159], a[200:203], v[44:47], 0
    s_waitcnt lgkmcnt(2)
    v_mfma_f32_16x16x32_bf16 v[160:163], a[204:207], v[48:51], 0
    buffer_load_dwordx4 a[200:203], v6, s[16:19], s54 offen offset:2048
    v_mfma_f32_16x16x32_bf16 v[172:175], a[204:207], v[52:55], 0
    ds_read_b128 v[32:35], v2 offset:7168
    s_mov_b32 s54, 62080
    v_mfma_f32_16x16x32_bf16 v[184:187], a[204:207], v[56:59], 0
    ds_read_b128 v[36:39], v2 offset:9216
    v_mfma_f32_16x16x32_bf16 v[24:27], a[252:255], v[16:19], 0
    ds_read_b128 v[40:43], v2 offset:11264
    v_mfma_f32_16x16x32_bf16 v[196:199], a[204:207], v[60:63], 0
    ds_read_b128 v[44:47], v15 offset:13312
    v_mfma_f32_16x16x32_bf16 v[28:31], a[252:255], v[20:23], 0
    buffer_load_dwordx4 a[204:207], v6, s[16:19], s54 offen offset:0
    v_mfma_f32_16x16x32_bf16 v[164:167], a[208:211], v[48:51], 0
    ds_read_b64_tr_b16 a[248:249], v4 offset:25728
    v_mfma_f32_16x16x32_bf16 v[176:179], a[208:211], v[52:55], 0
    ds_read_b64_tr_b16 a[250:251], v4 offset:28928
    v_cvt_pk_bf16_f32 v24, v24, v25
    v_mfma_f32_16x16x32_bf16 v[188:191], a[208:211], v[56:59], 0
    v_cvt_pk_bf16_f32 v25, v26, v27
    v_cvt_pk_bf16_f32 v28, v28, v29
    v_mfma_f32_16x16x32_bf16 v[200:203], a[208:211], v[60:63], 0
    ds_write_b64 v3, v[24:25] offset:29696
    v_mfma_f32_16x16x32_bf16 v[168:171], a[212:215], v[48:51], 0
    v_cvt_pk_bf16_f32 v29, v30, v31
    v_mfma_f32_16x16x32_bf16 v[180:183], a[212:215], v[52:55], 0
    buffer_load_dwordx4 a[208:211], v6, s[16:19], s54 offen offset:1024
    v_mfma_f32_16x16x32_bf16 v[192:195], a[212:215], v[56:59], 0
    ds_write_b64 v3, v[28:29] offset:44032
    v_mfma_f32_16x16x32_bf16 v[204:207], a[212:215], v[60:63], 0
    s_waitcnt lgkmcnt(2)
    v_mfma_f32_16x16x32_bf16 v[112:115], a[216:219], v[32:35], v[112:115]
    buffer_load_dwordx4 a[212:215], v6, s[16:19], s54 offen offset:2048
    v_mfma_f32_16x16x32_bf16 v[124:127], a[216:219], v[36:39], v[124:127]
    ds_read_b128 v[48:51], v2 offset:14336
    s_mov_b32 s54, 74496
    v_mfma_f32_16x16x32_bf16 v[136:139], a[216:219], v[40:43], v[136:139]
    ds_read_b128 v[52:55], v2 offset:16384
    v_mfma_f32_16x16x32_bf16 v[24:27], a[248:251], v[16:19], 0
    ds_read_b128 v[56:59], v2 offset:18432
    v_mfma_f32_16x16x32_bf16 v[148:151], a[216:219], v[44:47], v[148:151]
    ds_read_b128 v[60:63], v15 offset:20480
    v_mfma_f32_16x16x32_bf16 v[28:31], a[248:251], v[20:23], 0
    buffer_load_dwordx4 a[216:219], v6, s[16:19], s54 offen offset:0
    v_mfma_f32_16x16x32_bf16 v[116:119], a[220:223], v[32:35], v[116:119]
    ds_read_b64_tr_b16 a[252:253], v4 offset:38528
    v_mfma_f32_16x16x32_bf16 v[128:131], a[220:223], v[36:39], v[128:131]
    ds_read_b64_tr_b16 a[254:255], v4 offset:41728
    v_cvt_pk_bf16_f32 v24, v24, v25
    v_mfma_f32_16x16x32_bf16 v[140:143], a[220:223], v[40:43], v[140:143]
    v_cvt_pk_bf16_f32 v25, v26, v27
    v_cvt_pk_bf16_f32 v28, v28, v29
    v_mfma_f32_16x16x32_bf16 v[152:155], a[220:223], v[44:47], v[152:155]
    ds_write_b64 v3, v[24:25] offset:30720
    v_mfma_f32_16x16x32_bf16 v[120:123], a[224:227], v[32:35], v[120:123]
    v_cvt_pk_bf16_f32 v29, v30, v31
    v_mfma_f32_16x16x32_bf16 v[132:135], a[224:227], v[36:39], v[132:135]
    buffer_load_dwordx4 a[220:223], v6, s[16:19], s54 offen offset:1024
    v_mfma_f32_16x16x32_bf16 v[144:147], a[224:227], v[40:43], v[144:147]
    ds_write_b64 v3, v[28:29] offset:45056
    v_mfma_f32_16x16x32_bf16 v[156:159], a[224:227], v[44:47], v[156:159]
    s_waitcnt lgkmcnt(2)
    v_mfma_f32_16x16x32_bf16 v[160:163], a[228:231], v[48:51], v[160:163]
    buffer_load_dwordx4 a[224:227], v6, s[16:19], s54 offen offset:2048
    v_mfma_f32_16x16x32_bf16 v[172:175], a[228:231], v[52:55], v[172:175]
    ds_read_b128 v[32:35], v1 offset:0
    s_mov_b32 s54, 86912
    v_mfma_f32_16x16x32_bf16 v[184:187], a[228:231], v[56:59], v[184:187]
    ds_read_b128 v[36:39], v1 offset:2048
    v_mfma_f32_16x16x32_bf16 v[24:27], a[252:255], v[16:19], 0
    ds_read_b128 v[40:43], v1 offset:4096
    v_mfma_f32_16x16x32_bf16 v[196:199], a[228:231], v[60:63], v[196:199]
    ds_read_b128 v[44:47], v14 offset:6144
    v_mfma_f32_16x16x32_bf16 v[28:31], a[252:255], v[20:23], 0
    buffer_load_dwordx4 a[228:231], v6, s[16:19], s54 offen offset:0
    v_mfma_f32_16x16x32_bf16 v[164:167], a[232:235], v[48:51], v[164:167]
    ds_read_b64_tr_b16 a[248:249], v5 offset:128
    v_mfma_f32_16x16x32_bf16 v[176:179], a[232:235], v[52:55], v[176:179]
    ds_read_b64_tr_b16 a[250:251], v5 offset:3328
    v_cvt_pk_bf16_f32 v24, v24, v25
    v_mfma_f32_16x16x32_bf16 v[188:191], a[232:235], v[56:59], v[188:191]
    v_cvt_pk_bf16_f32 v25, v26, v27
    v_cvt_pk_bf16_f32 v28, v28, v29
    v_mfma_f32_16x16x32_bf16 v[200:203], a[232:235], v[60:63], v[200:203]
    ds_write_b64 v3, v[24:25] offset:31744
    v_mfma_f32_16x16x32_bf16 v[168:171], a[236:239], v[48:51], v[168:171]
    v_cvt_pk_bf16_f32 v29, v30, v31
    v_mfma_f32_16x16x32_bf16 v[180:183], a[236:239], v[52:55], v[180:183]
    buffer_load_dwordx4 a[232:235], v6, s[16:19], s54 offen offset:1024
    v_mfma_f32_16x16x32_bf16 v[192:195], a[236:239], v[56:59], v[192:195]
    ds_write_b64 v3, v[28:29] offset:46080
    v_mfma_f32_16x16x32_bf16 v[204:207], a[236:239], v[60:63], v[204:207]
    s_waitcnt vmcnt(8) lgkmcnt(2)
    v_mfma_f32_16x16x32_bf16 v[64:67], a[192:195], v[32:35], 0
    buffer_load_dwordx4 a[236:239], v6, s[16:19], s54 offen offset:2048
    v_mfma_f32_16x16x32_bf16 v[76:79], a[192:195], v[36:39], 0
    ds_read_b128 v[48:51], v1 offset:21504
    s_mov_b32 s54, 99328
    v_mfma_f32_16x16x32_bf16 v[88:91], a[192:195], v[40:43], 0
    ds_read_b128 v[52:55], v1 offset:23552
    v_mfma_f32_16x16x32_bf16 v[24:27], a[248:251], v[16:19], 0
    ds_read_b128 v[56:59], v1 offset:25600
    v_mfma_f32_16x16x32_bf16 v[100:103], a[192:195], v[44:47], 0
    ds_read_b128 v[60:63], v14 offset:27648
    v_mfma_f32_16x16x32_bf16 v[28:31], a[248:251], v[20:23], 0
    buffer_load_dwordx4 a[192:195], v6, s[16:19], s54 offen offset:0
    v_mfma_f32_16x16x32_bf16 v[68:71], a[196:199], v[32:35], 0
    ds_read_b64_tr_b16 a[252:253], v5 offset:12928
    v_mfma_f32_16x16x32_bf16 v[80:83], a[196:199], v[36:39], 0
    ds_read_b64_tr_b16 a[254:255], v5 offset:16128
    v_cvt_pk_bf16_f32 v24, v24, v25
    v_mfma_f32_16x16x32_bf16 v[92:95], a[196:199], v[40:43], 0
    v_cvt_pk_bf16_f32 v25, v26, v27
    v_cvt_pk_bf16_f32 v28, v28, v29
    v_mfma_f32_16x16x32_bf16 v[104:107], a[196:199], v[44:47], 0
    ds_write_b64 v3, v[24:25] offset:32768
    v_mfma_f32_16x16x32_bf16 v[72:75], a[200:203], v[32:35], 0
    v_cvt_pk_bf16_f32 v29, v30, v31
    v_mfma_f32_16x16x32_bf16 v[84:87], a[200:203], v[36:39], 0
    buffer_load_dwordx4 a[196:199], v6, s[16:19], s54 offen offset:1024
    v_mfma_f32_16x16x32_bf16 v[96:99], a[200:203], v[40:43], 0
    ds_write_b64 v3, v[28:29] offset:47104
    v_mfma_f32_16x16x32_bf16 v[108:111], a[200:203], v[44:47], 0
    s_waitcnt vmcnt(8) lgkmcnt(2)
    v_mfma_f32_16x16x32_bf16 v[208:211], a[204:207], v[48:51], 0
    buffer_load_dwordx4 a[200:203], v6, s[16:19], s54 offen offset:2048
    v_mfma_f32_16x16x32_bf16 v[220:223], a[204:207], v[52:55], 0
    ds_read_b128 v[32:35], v2 offset:0
    s_mov_b32 s54, 111744
    v_mfma_f32_16x16x32_bf16 v[232:235], a[204:207], v[56:59], 0
    ds_read_b128 v[36:39], v2 offset:2048
    v_mfma_f32_16x16x32_bf16 v[24:27], a[252:255], v[16:19], 0
    ds_read_b128 v[40:43], v2 offset:4096
    v_mfma_f32_16x16x32_bf16 v[244:247], a[204:207], v[60:63], 0
    ds_read_b128 v[44:47], v15 offset:6144
    v_mfma_f32_16x16x32_bf16 v[28:31], a[252:255], v[20:23], 0
    buffer_load_dwordx4 a[204:207], v6, s[16:19], s54 offen offset:0
    v_mfma_f32_16x16x32_bf16 v[212:215], a[208:211], v[48:51], 0
    ds_read_b64_tr_b16 a[248:249], v5 offset:25728
    v_mfma_f32_16x16x32_bf16 v[224:227], a[208:211], v[52:55], 0
    ds_read_b64_tr_b16 a[250:251], v5 offset:28928
    v_cvt_pk_bf16_f32 v24, v24, v25
    v_mfma_f32_16x16x32_bf16 v[236:239], a[208:211], v[56:59], 0
    v_cvt_pk_bf16_f32 v25, v26, v27
    v_cvt_pk_bf16_f32 v28, v28, v29
    v_mfma_f32_16x16x32_bf16 v[248:251], a[208:211], v[60:63], 0
    ds_write_b64 v3, v[24:25] offset:33792
    v_mfma_f32_16x16x32_bf16 v[216:219], a[212:215], v[48:51], 0
    v_cvt_pk_bf16_f32 v29, v30, v31
    v_mfma_f32_16x16x32_bf16 v[228:231], a[212:215], v[52:55], 0
    buffer_load_dwordx4 a[208:211], v6, s[16:19], s54 offen offset:1024
    v_mfma_f32_16x16x32_bf16 v[240:243], a[212:215], v[56:59], 0
    ds_write_b64 v3, v[28:29] offset:48128
    v_mfma_f32_16x16x32_bf16 v[252:255], a[212:215], v[60:63], 0
    s_waitcnt vmcnt(8) lgkmcnt(2)
    v_mfma_f32_16x16x32_bf16 v[64:67], a[216:219], v[32:35], v[64:67]
    buffer_load_dwordx4 a[212:215], v6, s[16:19], s54 offen offset:2048
    v_mfma_f32_16x16x32_bf16 v[76:79], a[216:219], v[36:39], v[76:79]
    ds_read_b128 v[48:51], v2 offset:21504
    s_mov_b32 s54, 124160
    v_mfma_f32_16x16x32_bf16 v[88:91], a[216:219], v[40:43], v[88:91]
    ds_read_b128 v[52:55], v2 offset:23552
    v_mfma_f32_16x16x32_bf16 v[24:27], a[248:251], v[16:19], 0
    ds_read_b128 v[56:59], v2 offset:25600
    v_mfma_f32_16x16x32_bf16 v[100:103], a[216:219], v[44:47], v[100:103]
    ds_read_b128 v[60:63], v15 offset:27648
    v_mfma_f32_16x16x32_bf16 v[28:31], a[248:251], v[20:23], 0
    buffer_load_dwordx4 a[216:219], v6, s[16:19], s54 offen offset:0
    v_mfma_f32_16x16x32_bf16 v[68:71], a[220:223], v[32:35], v[68:71]
    s_nop 0
    v_mfma_f32_16x16x32_bf16 v[80:83], a[220:223], v[36:39], v[80:83]
    s_nop 0
    v_cvt_pk_bf16_f32 v24, v24, v25
    v_mfma_f32_16x16x32_bf16 v[92:95], a[220:223], v[40:43], v[92:95]
    v_cvt_pk_bf16_f32 v25, v26, v27
    v_cvt_pk_bf16_f32 v28, v28, v29
    v_mfma_f32_16x16x32_bf16 v[104:107], a[220:223], v[44:47], v[104:107]
    ds_write_b64 v3, v[24:25] offset:34816
    v_mfma_f32_16x16x32_bf16 v[72:75], a[224:227], v[32:35], v[72:75]
    v_cvt_pk_bf16_f32 v29, v30, v31
    v_mfma_f32_16x16x32_bf16 v[84:87], a[224:227], v[36:39], v[84:87]
    buffer_load_dwordx4 a[220:223], v6, s[16:19], s54 offen offset:1024
    v_mfma_f32_16x16x32_bf16 v[96:99], a[224:227], v[40:43], v[96:99]
    ds_write_b64 v3, v[28:29] offset:49152
    v_mfma_f32_16x16x32_bf16 v[108:111], a[224:227], v[44:47], v[108:111]
    s_waitcnt vmcnt(8) lgkmcnt(2)
    v_mfma_f32_16x16x32_bf16 v[208:211], a[228:231], v[48:51], v[208:211]
    buffer_load_dwordx4 a[224:227], v6, s[16:19], s54 offen offset:2048
    v_mfma_f32_16x16x32_bf16 v[220:223], a[228:231], v[52:55], v[220:223]
    s_mov_b32 s54, 136576
    v_mfma_f32_16x16x32_bf16 v[232:235], a[228:231], v[56:59], v[232:235]
    s_waitcnt lgkmcnt(0)
    s_barrier
    v_mfma_f32_16x16x32_bf16 v[244:247], a[228:231], v[60:63], v[244:247]
    buffer_load_dwordx4 a[228:231], v6, s[16:19], s54 offen offset:0
    v_mfma_f32_16x16x32_bf16 v[212:215], a[232:235], v[48:51], v[212:215]
    ds_read_b128 v[32:35], v1 offset:35840
    v_mfma_f32_16x16x32_bf16 v[224:227], a[232:235], v[52:55], v[224:227]
    ds_read_b128 v[36:39], v1 offset:37888
    v_mfma_f32_16x16x32_bf16 v[236:239], a[232:235], v[56:59], v[236:239]
    ds_read_b128 v[40:43], v1 offset:39936
    v_mfma_f32_16x16x32_bf16 v[248:251], a[232:235], v[60:63], v[248:251]
    ds_read_b128 v[44:47], v14 offset:41984
    v_mfma_f32_16x16x32_bf16 v[216:219], a[236:239], v[48:51], v[216:219]
    buffer_load_dwordx4 a[232:235], v6, s[16:19], s54 offen offset:1024
    v_mfma_f32_16x16x32_bf16 v[228:231], a[236:239], v[52:55], v[228:231]
    ds_read_b64_tr_b16 a[248:249], v4 offset:256
    v_mfma_f32_16x16x32_bf16 v[240:243], a[236:239], v[56:59], v[240:243]
    ds_read_b64_tr_b16 a[250:251], v4 offset:3456
    v_mfma_f32_16x16x32_bf16 v[252:255], a[236:239], v[60:63], v[252:255]
    s_waitcnt vmcnt(8) lgkmcnt(0)
    v_mfma_f32_16x16x32_bf16 v[112:115], a[192:195], v[32:35], v[112:115]
    buffer_load_dwordx4 a[236:239], v6, s[16:19], s54 offen offset:2048
    v_mfma_f32_16x16x32_bf16 v[124:127], a[192:195], v[36:39], v[124:127]
    ds_read_b128 v[48:51], v1 offset:43008
    s_mov_b32 s54, 148992
    v_mfma_f32_16x16x32_bf16 v[136:139], a[192:195], v[40:43], v[136:139]
    ds_read_b128 v[52:55], v1 offset:45056
    v_mfma_f32_16x16x32_bf16 v[24:27], a[248:251], v[16:19], 0
    ds_read_b128 v[56:59], v1 offset:47104
    v_mfma_f32_16x16x32_bf16 v[148:151], a[192:195], v[44:47], v[148:151]
    ds_read_b128 v[60:63], v14 offset:49152
    v_mfma_f32_16x16x32_bf16 v[28:31], a[248:251], v[20:23], 0
    buffer_load_dwordx4 a[192:195], v6, s[16:19], s54 offen offset:0
    v_mfma_f32_16x16x32_bf16 v[116:119], a[196:199], v[32:35], v[116:119]
    ds_read_b64_tr_b16 a[252:253], v4 offset:13056
    v_mfma_f32_16x16x32_bf16 v[128:131], a[196:199], v[36:39], v[128:131]
    ds_read_b64_tr_b16 a[254:255], v4 offset:16256
    v_cvt_pk_bf16_f32 v24, v24, v25
    v_mfma_f32_16x16x32_bf16 v[140:143], a[196:199], v[40:43], v[140:143]
    v_cvt_pk_bf16_f32 v25, v26, v27
    v_cvt_pk_bf16_f32 v28, v28, v29
    v_mfma_f32_16x16x32_bf16 v[152:155], a[196:199], v[44:47], v[152:155]
    ds_write_b64 v3, v[24:25] offset:0
    v_mfma_f32_16x16x32_bf16 v[120:123], a[200:203], v[32:35], v[120:123]
    v_cvt_pk_bf16_f32 v29, v30, v31
    v_mfma_f32_16x16x32_bf16 v[132:135], a[200:203], v[36:39], v[132:135]
    buffer_load_dwordx4 a[196:199], v6, s[16:19], s54 offen offset:1024
    v_mfma_f32_16x16x32_bf16 v[144:147], a[200:203], v[40:43], v[144:147]
    ds_write_b64 v3, v[28:29] offset:14336
    v_mfma_f32_16x16x32_bf16 v[156:159], a[200:203], v[44:47], v[156:159]
    s_waitcnt vmcnt(8) lgkmcnt(2)
    v_mfma_f32_16x16x32_bf16 v[160:163], a[204:207], v[48:51], v[160:163]
    buffer_load_dwordx4 a[200:203], v6, s[16:19], s54 offen offset:2048
    v_mfma_f32_16x16x32_bf16 v[172:175], a[204:207], v[52:55], v[172:175]
    ds_read_b128 v[32:35], v2 offset:35840
    s_mov_b32 s54, 161408
    v_mfma_f32_16x16x32_bf16 v[184:187], a[204:207], v[56:59], v[184:187]
    ds_read_b128 v[36:39], v2 offset:37888
    v_mfma_f32_16x16x32_bf16 v[24:27], a[252:255], v[16:19], 0
    ds_read_b128 v[40:43], v2 offset:39936
    v_mfma_f32_16x16x32_bf16 v[196:199], a[204:207], v[60:63], v[196:199]
    ds_read_b128 v[44:47], v15 offset:41984
    v_mfma_f32_16x16x32_bf16 v[28:31], a[252:255], v[20:23], 0
    buffer_load_dwordx4 a[204:207], v6, s[16:19], s54 offen offset:0
    v_mfma_f32_16x16x32_bf16 v[164:167], a[208:211], v[48:51], v[164:167]
    ds_read_b64_tr_b16 a[248:249], v4 offset:25856
    v_mfma_f32_16x16x32_bf16 v[176:179], a[208:211], v[52:55], v[176:179]
    ds_read_b64_tr_b16 a[250:251], v4 offset:29056
    v_cvt_pk_bf16_f32 v24, v24, v25
    v_mfma_f32_16x16x32_bf16 v[188:191], a[208:211], v[56:59], v[188:191]
    v_cvt_pk_bf16_f32 v25, v26, v27
    v_cvt_pk_bf16_f32 v28, v28, v29
    v_mfma_f32_16x16x32_bf16 v[200:203], a[208:211], v[60:63], v[200:203]
    ds_write_b64 v3, v[24:25] offset:1024
    v_mfma_f32_16x16x32_bf16 v[168:171], a[212:215], v[48:51], v[168:171]
    v_cvt_pk_bf16_f32 v29, v30, v31
    v_mfma_f32_16x16x32_bf16 v[180:183], a[212:215], v[52:55], v[180:183]
    buffer_load_dwordx4 a[208:211], v6, s[16:19], s54 offen offset:1024
    v_mfma_f32_16x16x32_bf16 v[192:195], a[212:215], v[56:59], v[192:195]
    ds_write_b64 v3, v[28:29] offset:15360
    v_mfma_f32_16x16x32_bf16 v[204:207], a[212:215], v[60:63], v[204:207]
    s_waitcnt vmcnt(8) lgkmcnt(2)
    v_mfma_f32_16x16x32_bf16 v[112:115], a[216:219], v[32:35], v[112:115]
    buffer_load_dwordx4 a[212:215], v6, s[16:19], s54 offen offset:2048
    v_mfma_f32_16x16x32_bf16 v[124:127], a[216:219], v[36:39], v[124:127]
    ds_read_b128 v[48:51], v2 offset:43008
    s_mov_b32 s54, 173824
    v_mfma_f32_16x16x32_bf16 v[136:139], a[216:219], v[40:43], v[136:139]
    ds_read_b128 v[52:55], v2 offset:45056
    v_mfma_f32_16x16x32_bf16 v[24:27], a[248:251], v[16:19], 0
    ds_read_b128 v[56:59], v2 offset:47104
    v_mfma_f32_16x16x32_bf16 v[148:151], a[216:219], v[44:47], v[148:151]
    ds_read_b128 v[60:63], v15 offset:49152
    v_mfma_f32_16x16x32_bf16 v[28:31], a[248:251], v[20:23], 0
    buffer_load_dwordx4 a[216:219], v6, s[16:19], s54 offen offset:0
    v_mfma_f32_16x16x32_bf16 v[116:119], a[220:223], v[32:35], v[116:119]
    ds_read_b64_tr_b16 a[252:253], v4 offset:38656
    v_mfma_f32_16x16x32_bf16 v[128:131], a[220:223], v[36:39], v[128:131]
    ds_read_b64_tr_b16 a[254:255], v4 offset:41856
    v_cvt_pk_bf16_f32 v24, v24, v25
    v_mfma_f32_16x16x32_bf16 v[140:143], a[220:223], v[40:43], v[140:143]
    v_cvt_pk_bf16_f32 v25, v26, v27
    v_cvt_pk_bf16_f32 v28, v28, v29
    v_mfma_f32_16x16x32_bf16 v[152:155], a[220:223], v[44:47], v[152:155]
    ds_write_b64 v3, v[24:25] offset:2048
    v_mfma_f32_16x16x32_bf16 v[120:123], a[224:227], v[32:35], v[120:123]
    v_cvt_pk_bf16_f32 v29, v30, v31
    v_mfma_f32_16x16x32_bf16 v[132:135], a[224:227], v[36:39], v[132:135]
    buffer_load_dwordx4 a[220:223], v6, s[16:19], s54 offen offset:1024
    v_mfma_f32_16x16x32_bf16 v[144:147], a[224:227], v[40:43], v[144:147]
    ds_write_b64 v3, v[28:29] offset:16384
    v_mfma_f32_16x16x32_bf16 v[156:159], a[224:227], v[44:47], v[156:159]
    s_waitcnt vmcnt(8) lgkmcnt(2)
    v_mfma_f32_16x16x32_bf16 v[160:163], a[228:231], v[48:51], v[160:163]
    buffer_load_dwordx4 a[224:227], v6, s[16:19], s54 offen offset:2048
    v_mfma_f32_16x16x32_bf16 v[172:175], a[228:231], v[52:55], v[172:175]
    ds_read_b128 v[32:35], v1 offset:28672
    s_mov_b32 s54, 186240
    v_mfma_f32_16x16x32_bf16 v[184:187], a[228:231], v[56:59], v[184:187]
    ds_read_b128 v[36:39], v1 offset:30720
    v_mfma_f32_16x16x32_bf16 v[24:27], a[252:255], v[16:19], 0
    ds_read_b128 v[40:43], v1 offset:32768
    v_mfma_f32_16x16x32_bf16 v[196:199], a[228:231], v[60:63], v[196:199]
    ds_read_b128 v[44:47], v14 offset:34816
    v_mfma_f32_16x16x32_bf16 v[28:31], a[252:255], v[20:23], 0
    buffer_load_dwordx4 a[228:231], v6, s[16:19], s54 offen offset:0
    v_mfma_f32_16x16x32_bf16 v[164:167], a[232:235], v[48:51], v[164:167]
    ds_read_b64_tr_b16 a[248:249], v5 offset:256
    v_mfma_f32_16x16x32_bf16 v[176:179], a[232:235], v[52:55], v[176:179]
    ds_read_b64_tr_b16 a[250:251], v5 offset:3456
    v_cvt_pk_bf16_f32 v24, v24, v25
    v_mfma_f32_16x16x32_bf16 v[188:191], a[232:235], v[56:59], v[188:191]
    v_cvt_pk_bf16_f32 v25, v26, v27
    v_cvt_pk_bf16_f32 v28, v28, v29
    v_mfma_f32_16x16x32_bf16 v[200:203], a[232:235], v[60:63], v[200:203]
    ds_write_b64 v3, v[24:25] offset:3072
    v_mfma_f32_16x16x32_bf16 v[168:171], a[236:239], v[48:51], v[168:171]
    v_cvt_pk_bf16_f32 v29, v30, v31
    v_mfma_f32_16x16x32_bf16 v[180:183], a[236:239], v[52:55], v[180:183]
    buffer_load_dwordx4 a[232:235], v6, s[16:19], s54 offen offset:1024
    v_mfma_f32_16x16x32_bf16 v[192:195], a[236:239], v[56:59], v[192:195]
    ds_write_b64 v3, v[28:29] offset:17408
    v_mfma_f32_16x16x32_bf16 v[204:207], a[236:239], v[60:63], v[204:207]
    s_waitcnt vmcnt(8) lgkmcnt(2)
    v_mfma_f32_16x16x32_bf16 v[64:67], a[192:195], v[32:35], v[64:67]
    buffer_load_dwordx4 a[236:239], v6, s[16:19], s54 offen offset:2048
    v_mfma_f32_16x16x32_bf16 v[76:79], a[192:195], v[36:39], v[76:79]
    ds_read_b128 v[48:51], v1 offset:50176
    s_mov_b32 s54, 198656
    v_mfma_f32_16x16x32_bf16 v[88:91], a[192:195], v[40:43], v[88:91]
    ds_read_b128 v[52:55], v1 offset:52224
    v_mfma_f32_16x16x32_bf16 v[24:27], a[248:251], v[16:19], 0
    ds_read_b128 v[56:59], v1 offset:54272
    v_mfma_f32_16x16x32_bf16 v[100:103], a[192:195], v[44:47], v[100:103]
    ds_read_b128 v[60:63], v14 offset:56320
    v_mfma_f32_16x16x32_bf16 v[28:31], a[248:251], v[20:23], 0
    buffer_load_dwordx4 a[192:195], v6, s[16:19], s54 offen offset:0
    v_mfma_f32_16x16x32_bf16 v[68:71], a[196:199], v[32:35], v[68:71]
    ds_read_b64_tr_b16 a[252:253], v5 offset:13056
    v_mfma_f32_16x16x32_bf16 v[80:83], a[196:199], v[36:39], v[80:83]
    ds_read_b64_tr_b16 a[254:255], v5 offset:16256
    v_cvt_pk_bf16_f32 v24, v24, v25
    v_mfma_f32_16x16x32_bf16 v[92:95], a[196:199], v[40:43], v[92:95]
    v_cvt_pk_bf16_f32 v25, v26, v27
    v_cvt_pk_bf16_f32 v28, v28, v29
    v_mfma_f32_16x16x32_bf16 v[104:107], a[196:199], v[44:47], v[104:107]
    ds_write_b64 v3, v[24:25] offset:4096
    v_mfma_f32_16x16x32_bf16 v[72:75], a[200:203], v[32:35], v[72:75]
    v_cvt_pk_bf16_f32 v29, v30, v31
    v_mfma_f32_16x16x32_bf16 v[84:87], a[200:203], v[36:39], v[84:87]
    buffer_load_dwordx4 a[196:199], v6, s[16:19], s54 offen offset:1024
    v_mfma_f32_16x16x32_bf16 v[96:99], a[200:203], v[40:43], v[96:99]
    ds_write_b64 v3, v[28:29] offset:18432
    v_mfma_f32_16x16x32_bf16 v[108:111], a[200:203], v[44:47], v[108:111]
    s_waitcnt vmcnt(8) lgkmcnt(2)
    v_mfma_f32_16x16x32_bf16 v[208:211], a[204:207], v[48:51], v[208:211]
    buffer_load_dwordx4 a[200:203], v6, s[16:19], s54 offen offset:2048
    v_mfma_f32_16x16x32_bf16 v[220:223], a[204:207], v[52:55], v[220:223]
    ds_read_b128 v[32:35], v2 offset:28672
    s_mov_b32 s54, 211072
    v_mfma_f32_16x16x32_bf16 v[232:235], a[204:207], v[56:59], v[232:235]
    ds_read_b128 v[36:39], v2 offset:30720
    v_mfma_f32_16x16x32_bf16 v[24:27], a[252:255], v[16:19], 0
    ds_read_b128 v[40:43], v2 offset:32768
    v_mfma_f32_16x16x32_bf16 v[244:247], a[204:207], v[60:63], v[244:247]
    ds_read_b128 v[44:47], v15 offset:34816
    v_mfma_f32_16x16x32_bf16 v[28:31], a[252:255], v[20:23], 0
    buffer_load_dwordx4 a[204:207], v6, s[16:19], s54 offen offset:0
    v_mfma_f32_16x16x32_bf16 v[212:215], a[208:211], v[48:51], v[212:215]
    ds_read_b64_tr_b16 a[248:249], v5 offset:25856
    v_mfma_f32_16x16x32_bf16 v[224:227], a[208:211], v[52:55], v[224:227]
    ds_read_b64_tr_b16 a[250:251], v5 offset:29056
    v_cvt_pk_bf16_f32 v24, v24, v25
    v_mfma_f32_16x16x32_bf16 v[236:239], a[208:211], v[56:59], v[236:239]
    v_cvt_pk_bf16_f32 v25, v26, v27
    v_cvt_pk_bf16_f32 v28, v28, v29
    v_mfma_f32_16x16x32_bf16 v[248:251], a[208:211], v[60:63], v[248:251]
    ds_write_b64 v3, v[24:25] offset:5120
    v_mfma_f32_16x16x32_bf16 v[216:219], a[212:215], v[48:51], v[216:219]
    v_cvt_pk_bf16_f32 v29, v30, v31
    v_mfma_f32_16x16x32_bf16 v[228:231], a[212:215], v[52:55], v[228:231]
    buffer_load_dwordx4 a[208:211], v6, s[16:19], s54 offen offset:1024
    v_mfma_f32_16x16x32_bf16 v[240:243], a[212:215], v[56:59], v[240:243]
    ds_write_b64 v3, v[28:29] offset:19456
    v_mfma_f32_16x16x32_bf16 v[252:255], a[212:215], v[60:63], v[252:255]
    s_waitcnt vmcnt(8) lgkmcnt(2)
    v_mfma_f32_16x16x32_bf16 v[64:67], a[216:219], v[32:35], v[64:67]
    buffer_load_dwordx4 a[212:215], v6, s[16:19], s54 offen offset:2048
    v_mfma_f32_16x16x32_bf16 v[76:79], a[216:219], v[36:39], v[76:79]
    ds_read_b128 v[48:51], v2 offset:50176
    s_mov_b32 s54, 223488
    v_mfma_f32_16x16x32_bf16 v[88:91], a[216:219], v[40:43], v[88:91]
    ds_read_b128 v[52:55], v2 offset:52224
    v_mfma_f32_16x16x32_bf16 v[24:27], a[248:251], v[16:19], 0
    ds_read_b128 v[56:59], v2 offset:54272
    v_mfma_f32_16x16x32_bf16 v[100:103], a[216:219], v[44:47], v[100:103]
    ds_read_b128 v[60:63], v15 offset:56320
    v_mfma_f32_16x16x32_bf16 v[28:31], a[248:251], v[20:23], 0
    buffer_load_dwordx4 a[216:219], v6, s[16:19], s54 offen offset:0
    v_mfma_f32_16x16x32_bf16 v[68:71], a[220:223], v[32:35], v[68:71]
    s_nop 0
    v_mfma_f32_16x16x32_bf16 v[80:83], a[220:223], v[36:39], v[80:83]
    s_nop 0
    v_cvt_pk_bf16_f32 v24, v24, v25
    v_mfma_f32_16x16x32_bf16 v[92:95], a[220:223], v[40:43], v[92:95]
    v_cvt_pk_bf16_f32 v25, v26, v27
    v_cvt_pk_bf16_f32 v28, v28, v29
    v_mfma_f32_16x16x32_bf16 v[104:107], a[220:223], v[44:47], v[104:107]
    ds_write_b64 v3, v[24:25] offset:6144
    v_mfma_f32_16x16x32_bf16 v[72:75], a[224:227], v[32:35], v[72:75]
    v_cvt_pk_bf16_f32 v29, v30, v31
    v_mfma_f32_16x16x32_bf16 v[84:87], a[224:227], v[36:39], v[84:87]
    buffer_load_dwordx4 a[220:223], v6, s[16:19], s54 offen offset:1024
    v_mfma_f32_16x16x32_bf16 v[96:99], a[224:227], v[40:43], v[96:99]
    ds_write_b64 v3, v[28:29] offset:20480
    v_mfma_f32_16x16x32_bf16 v[108:111], a[224:227], v[44:47], v[108:111]
    s_waitcnt vmcnt(8) lgkmcnt(2)
    v_mfma_f32_16x16x32_bf16 v[208:211], a[228:231], v[48:51], v[208:211]
    buffer_load_dwordx4 a[224:227], v6, s[16:19], s54 offen offset:2048
    v_mfma_f32_16x16x32_bf16 v[220:223], a[228:231], v[52:55], v[220:223]
    s_mov_b32 s54, 235904
    v_mfma_f32_16x16x32_bf16 v[232:235], a[228:231], v[56:59], v[232:235]
    s_waitcnt lgkmcnt(0)
    s_barrier
    v_mfma_f32_16x16x32_bf16 v[244:247], a[228:231], v[60:63], v[244:247]
    buffer_load_dwordx4 a[228:231], v6, s[16:19], s54 offen offset:0
    v_mfma_f32_16x16x32_bf16 v[212:215], a[232:235], v[48:51], v[212:215]
    ds_read_b128 v[32:35], v1 offset:7168
    v_mfma_f32_16x16x32_bf16 v[224:227], a[232:235], v[52:55], v[224:227]
    ds_read_b128 v[36:39], v1 offset:9216
    v_mfma_f32_16x16x32_bf16 v[236:239], a[232:235], v[56:59], v[236:239]
    ds_read_b128 v[40:43], v1 offset:11264
    v_mfma_f32_16x16x32_bf16 v[248:251], a[232:235], v[60:63], v[248:251]
    ds_read_b128 v[44:47], v14 offset:13312
    v_mfma_f32_16x16x32_bf16 v[216:219], a[236:239], v[48:51], v[216:219]
    buffer_load_dwordx4 a[232:235], v6, s[16:19], s54 offen offset:1024
    v_mfma_f32_16x16x32_bf16 v[228:231], a[236:239], v[52:55], v[228:231]
    ds_read_b64_tr_b16 a[248:249], v4 offset:0
    v_mfma_f32_16x16x32_bf16 v[240:243], a[236:239], v[56:59], v[240:243]
    ds_read_b64_tr_b16 a[250:251], v4 offset:3200
    v_mfma_f32_16x16x32_bf16 v[252:255], a[236:239], v[60:63], v[252:255]
    s_waitcnt vmcnt(8) lgkmcnt(0)
    v_mfma_f32_16x16x32_bf16 v[112:115], a[192:195], v[32:35], v[112:115]
    buffer_load_dwordx4 a[236:239], v6, s[16:19], s54 offen offset:2048
    v_mfma_f32_16x16x32_bf16 v[124:127], a[192:195], v[36:39], v[124:127]
    ds_read_b128 v[48:51], v1 offset:14336
    s_mov_b32 s54, 248320
    v_mfma_f32_16x16x32_bf16 v[136:139], a[192:195], v[40:43], v[136:139]
    ds_read_b128 v[52:55], v1 offset:16384
    v_mfma_f32_16x16x32_bf16 v[24:27], a[248:251], a[240:243], 0
    ds_read_b128 v[56:59], v1 offset:18432
    v_mfma_f32_16x16x32_bf16 v[148:151], a[192:195], v[44:47], v[148:151]
    ds_read_b128 v[60:63], v14 offset:20480
    v_mfma_f32_16x16x32_bf16 v[28:31], a[248:251], a[244:247], 0
    buffer_load_dwordx4 a[192:195], v6, s[16:19], s54 offen offset:0
    v_mfma_f32_16x16x32_bf16 v[116:119], a[196:199], v[32:35], v[116:119]
    ds_read_b64_tr_b16 a[252:253], v4 offset:12800
    v_mfma_f32_16x16x32_bf16 v[128:131], a[196:199], v[36:39], v[128:131]
    ds_read_b64_tr_b16 a[254:255], v4 offset:16000
    v_cvt_pk_bf16_f32 v24, v24, v25
    v_mfma_f32_16x16x32_bf16 v[140:143], a[196:199], v[40:43], v[140:143]
    v_cvt_pk_bf16_f32 v25, v26, v27
    v_cvt_pk_bf16_f32 v28, v28, v29
    v_mfma_f32_16x16x32_bf16 v[152:155], a[196:199], v[44:47], v[152:155]
    ds_write_b64 v3, v[24:25] offset:28672
    v_mfma_f32_16x16x32_bf16 v[120:123], a[200:203], v[32:35], v[120:123]
    v_cvt_pk_bf16_f32 v29, v30, v31
    v_mfma_f32_16x16x32_bf16 v[132:135], a[200:203], v[36:39], v[132:135]
    buffer_load_dwordx4 a[196:199], v6, s[16:19], s54 offen offset:1024
    v_mfma_f32_16x16x32_bf16 v[144:147], a[200:203], v[40:43], v[144:147]
    ds_write_b64 v3, v[28:29] offset:43008
    v_mfma_f32_16x16x32_bf16 v[156:159], a[200:203], v[44:47], v[156:159]
    s_waitcnt vmcnt(8) lgkmcnt(2)
    v_mfma_f32_16x16x32_bf16 v[160:163], a[204:207], v[48:51], v[160:163]
    buffer_load_dwordx4 a[200:203], v6, s[16:19], s54 offen offset:2048
    v_mfma_f32_16x16x32_bf16 v[172:175], a[204:207], v[52:55], v[172:175]
    ds_read_b128 v[32:35], v2 offset:7168
    s_mov_b32 s54, 260736
    v_mfma_f32_16x16x32_bf16 v[184:187], a[204:207], v[56:59], v[184:187]
    ds_read_b128 v[36:39], v2 offset:9216
    v_mfma_f32_16x16x32_bf16 v[24:27], a[252:255], a[240:243], 0
    ds_read_b128 v[40:43], v2 offset:11264
    v_mfma_f32_16x16x32_bf16 v[196:199], a[204:207], v[60:63], v[196:199]
    ds_read_b128 v[44:47], v15 offset:13312
    v_mfma_f32_16x16x32_bf16 v[28:31], a[252:255], a[244:247], 0
    buffer_load_dwordx4 a[204:207], v6, s[16:19], s54 offen offset:0
    v_mfma_f32_16x16x32_bf16 v[164:167], a[208:211], v[48:51], v[164:167]
    ds_read_b64_tr_b16 a[248:249], v4 offset:25600
    v_mfma_f32_16x16x32_bf16 v[176:179], a[208:211], v[52:55], v[176:179]
    ds_read_b64_tr_b16 a[250:251], v4 offset:28800
    v_cvt_pk_bf16_f32 v24, v24, v25
    v_mfma_f32_16x16x32_bf16 v[188:191], a[208:211], v[56:59], v[188:191]
    v_cvt_pk_bf16_f32 v25, v26, v27
    v_cvt_pk_bf16_f32 v28, v28, v29
    v_mfma_f32_16x16x32_bf16 v[200:203], a[208:211], v[60:63], v[200:203]
    ds_write_b64 v3, v[24:25] offset:29696
    v_mfma_f32_16x16x32_bf16 v[168:171], a[212:215], v[48:51], v[168:171]
    v_cvt_pk_bf16_f32 v29, v30, v31
    v_mfma_f32_16x16x32_bf16 v[180:183], a[212:215], v[52:55], v[180:183]
    buffer_load_dwordx4 a[208:211], v6, s[16:19], s54 offen offset:1024
    v_mfma_f32_16x16x32_bf16 v[192:195], a[212:215], v[56:59], v[192:195]
    ds_write_b64 v3, v[28:29] offset:44032
    v_mfma_f32_16x16x32_bf16 v[204:207], a[212:215], v[60:63], v[204:207]
    s_waitcnt vmcnt(8) lgkmcnt(2)
    v_mfma_f32_16x16x32_bf16 v[112:115], a[216:219], v[32:35], v[112:115]
    buffer_load_dwordx4 a[212:215], v6, s[16:19], s54 offen offset:2048
    v_mfma_f32_16x16x32_bf16 v[124:127], a[216:219], v[36:39], v[124:127]
    ds_read_b128 v[48:51], v2 offset:14336
    s_mov_b32 s54, 273152
    v_mfma_f32_16x16x32_bf16 v[136:139], a[216:219], v[40:43], v[136:139]
    ds_read_b128 v[52:55], v2 offset:16384
    v_mfma_f32_16x16x32_bf16 v[24:27], a[248:251], a[240:243], 0
    ds_read_b128 v[56:59], v2 offset:18432
    v_mfma_f32_16x16x32_bf16 v[148:151], a[216:219], v[44:47], v[148:151]
    ds_read_b128 v[60:63], v15 offset:20480
    v_mfma_f32_16x16x32_bf16 v[28:31], a[248:251], a[244:247], 0
    buffer_load_dwordx4 a[216:219], v6, s[16:19], s54 offen offset:0
    v_mfma_f32_16x16x32_bf16 v[116:119], a[220:223], v[32:35], v[116:119]
    ds_read_b64_tr_b16 a[252:253], v4 offset:38400
    v_mfma_f32_16x16x32_bf16 v[128:131], a[220:223], v[36:39], v[128:131]
    ds_read_b64_tr_b16 a[254:255], v4 offset:41600
    v_cvt_pk_bf16_f32 v24, v24, v25
    v_mfma_f32_16x16x32_bf16 v[140:143], a[220:223], v[40:43], v[140:143]
    v_cvt_pk_bf16_f32 v25, v26, v27
    v_cvt_pk_bf16_f32 v28, v28, v29
    v_mfma_f32_16x16x32_bf16 v[152:155], a[220:223], v[44:47], v[152:155]
    ds_write_b64 v3, v[24:25] offset:30720
    v_mfma_f32_16x16x32_bf16 v[120:123], a[224:227], v[32:35], v[120:123]
    v_cvt_pk_bf16_f32 v29, v30, v31
    v_mfma_f32_16x16x32_bf16 v[132:135], a[224:227], v[36:39], v[132:135]
    buffer_load_dwordx4 a[220:223], v6, s[16:19], s54 offen offset:1024
    v_mfma_f32_16x16x32_bf16 v[144:147], a[224:227], v[40:43], v[144:147]
    ds_write_b64 v3, v[28:29] offset:45056
    v_mfma_f32_16x16x32_bf16 v[156:159], a[224:227], v[44:47], v[156:159]
    s_waitcnt vmcnt(8) lgkmcnt(2)
    v_mfma_f32_16x16x32_bf16 v[160:163], a[228:231], v[48:51], v[160:163]
    buffer_load_dwordx4 a[224:227], v6, s[16:19], s54 offen offset:2048
    v_mfma_f32_16x16x32_bf16 v[172:175], a[228:231], v[52:55], v[172:175]
    ds_read_b128 v[32:35], v1 offset:0
    s_mov_b32 s54, 285568
    v_mfma_f32_16x16x32_bf16 v[184:187], a[228:231], v[56:59], v[184:187]
    ds_read_b128 v[36:39], v1 offset:2048
    v_mfma_f32_16x16x32_bf16 v[24:27], a[252:255], a[240:243], 0
    ds_read_b128 v[40:43], v1 offset:4096
    v_mfma_f32_16x16x32_bf16 v[196:199], a[228:231], v[60:63], v[196:199]
    ds_read_b128 v[44:47], v14 offset:6144
    v_mfma_f32_16x16x32_bf16 v[28:31], a[252:255], a[244:247], 0
    buffer_load_dwordx4 a[228:231], v6, s[16:19], s54 offen offset:0
    v_mfma_f32_16x16x32_bf16 v[164:167], a[232:235], v[48:51], v[164:167]
    ds_read_b64_tr_b16 a[248:249], v5 offset:0
    v_mfma_f32_16x16x32_bf16 v[176:179], a[232:235], v[52:55], v[176:179]
    ds_read_b64_tr_b16 a[250:251], v5 offset:3200
    v_cvt_pk_bf16_f32 v24, v24, v25
    v_mfma_f32_16x16x32_bf16 v[188:191], a[232:235], v[56:59], v[188:191]
    v_cvt_pk_bf16_f32 v25, v26, v27
    v_cvt_pk_bf16_f32 v28, v28, v29
    v_mfma_f32_16x16x32_bf16 v[200:203], a[232:235], v[60:63], v[200:203]
    ds_write_b64 v3, v[24:25] offset:31744
    v_mfma_f32_16x16x32_bf16 v[168:171], a[236:239], v[48:51], v[168:171]
    v_cvt_pk_bf16_f32 v29, v30, v31
    v_mfma_f32_16x16x32_bf16 v[180:183], a[236:239], v[52:55], v[180:183]
    buffer_load_dwordx4 a[232:235], v6, s[16:19], s54 offen offset:1024
    v_mfma_f32_16x16x32_bf16 v[192:195], a[236:239], v[56:59], v[192:195]
    ds_write_b64 v3, v[28:29] offset:46080
    v_mfma_f32_16x16x32_bf16 v[204:207], a[236:239], v[60:63], v[204:207]
    v_pk_add_f32 v[64:65], v[64:65], v[112:113]
    v_pk_add_f32 v[66:67], v[66:67], v[114:115]
    v_pk_add_f32 v[76:77], v[76:77], v[124:125]
    v_pk_add_f32 v[78:79], v[78:79], v[126:127]
    v_pk_add_f32 v[88:89], v[88:89], v[136:137]
    v_pk_add_f32 v[90:91], v[90:91], v[138:139]
    v_pk_add_f32 v[100:101], v[100:101], v[148:149]
    v_pk_add_f32 v[102:103], v[102:103], v[150:151]
    v_pk_add_f32 v[68:69], v[68:69], v[116:117]
    v_pk_add_f32 v[70:71], v[70:71], v[118:119]
    v_pk_add_f32 v[80:81], v[80:81], v[128:129]
    v_pk_add_f32 v[82:83], v[82:83], v[130:131]
    v_pk_add_f32 v[92:93], v[92:93], v[140:141]
    v_pk_add_f32 v[94:95], v[94:95], v[142:143]
    v_pk_add_f32 v[104:105], v[104:105], v[152:153]
    v_pk_add_f32 v[106:107], v[106:107], v[154:155]
    v_pk_add_f32 v[72:73], v[72:73], v[120:121]
    v_pk_add_f32 v[74:75], v[74:75], v[122:123]
    v_pk_add_f32 v[84:85], v[84:85], v[132:133]
    v_pk_add_f32 v[86:87], v[86:87], v[134:135]
    v_pk_add_f32 v[96:97], v[96:97], v[144:145]
    v_pk_add_f32 v[98:99], v[98:99], v[146:147]
    v_pk_add_f32 v[108:109], v[108:109], v[156:157]
    v_pk_add_f32 v[110:111], v[110:111], v[158:159]
    v_pk_add_f32 v[208:209], v[208:209], v[112:113] neg_lo:[0,1] neg_hi:[0,1]
    v_pk_add_f32 v[210:211], v[210:211], v[114:115] neg_lo:[0,1] neg_hi:[0,1]
    v_pk_add_f32 v[220:221], v[220:221], v[124:125] neg_lo:[0,1] neg_hi:[0,1]
    v_pk_add_f32 v[222:223], v[222:223], v[126:127] neg_lo:[0,1] neg_hi:[0,1]
    v_pk_add_f32 v[232:233], v[232:233], v[136:137] neg_lo:[0,1] neg_hi:[0,1]
    v_pk_add_f32 v[234:235], v[234:235], v[138:139] neg_lo:[0,1] neg_hi:[0,1]
    v_pk_add_f32 v[244:245], v[244:245], v[148:149] neg_lo:[0,1] neg_hi:[0,1]
    v_pk_add_f32 v[246:247], v[246:247], v[150:151] neg_lo:[0,1] neg_hi:[0,1]
    v_pk_add_f32 v[212:213], v[212:213], v[116:117] neg_lo:[0,1] neg_hi:[0,1]
    v_pk_add_f32 v[214:215], v[214:215], v[118:119] neg_lo:[0,1] neg_hi:[0,1]
    v_pk_add_f32 v[224:225], v[224:225], v[128:129] neg_lo:[0,1] neg_hi:[0,1]
    v_pk_add_f32 v[226:227], v[226:227], v[130:131] neg_lo:[0,1] neg_hi:[0,1]
    v_pk_add_f32 v[236:237], v[236:237], v[140:141] neg_lo:[0,1] neg_hi:[0,1]
    v_pk_add_f32 v[238:239], v[238:239], v[142:143] neg_lo:[0,1] neg_hi:[0,1]
    v_pk_add_f32 v[248:249], v[248:249], v[152:153] neg_lo:[0,1] neg_hi:[0,1]
    v_pk_add_f32 v[250:251], v[250:251], v[154:155] neg_lo:[0,1] neg_hi:[0,1]
    v_pk_add_f32 v[216:217], v[216:217], v[120:121] neg_lo:[0,1] neg_hi:[0,1]
    v_pk_add_f32 v[218:219], v[218:219], v[122:123] neg_lo:[0,1] neg_hi:[0,1]
    v_pk_add_f32 v[228:229], v[228:229], v[132:133] neg_lo:[0,1] neg_hi:[0,1]
    v_pk_add_f32 v[230:231], v[230:231], v[134:135] neg_lo:[0,1] neg_hi:[0,1]
    v_pk_add_f32 v[240:241], v[240:241], v[144:145] neg_lo:[0,1] neg_hi:[0,1]
    v_pk_add_f32 v[242:243], v[242:243], v[146:147] neg_lo:[0,1] neg_hi:[0,1]
    v_pk_add_f32 v[252:253], v[252:253], v[156:157] neg_lo:[0,1] neg_hi:[0,1]
    v_pk_add_f32 v[254:255], v[254:255], v[158:159] neg_lo:[0,1] neg_hi:[0,1]
    v_pk_add_f32 v[64:65], v[64:65], v[160:161]
    v_pk_add_f32 v[66:67], v[66:67], v[162:163]
    v_pk_add_f32 v[76:77], v[76:77], v[172:173]
    v_pk_add_f32 v[78:79], v[78:79], v[174:175]
    v_pk_add_f32 v[88:89], v[88:89], v[184:185]
    v_pk_add_f32 v[90:91], v[90:91], v[186:187]
    v_pk_add_f32 v[100:101], v[100:101], v[196:197]
    v_pk_add_f32 v[102:103], v[102:103], v[198:199]
    v_pk_add_f32 v[68:69], v[68:69], v[164:165]
    v_pk_add_f32 v[70:71], v[70:71], v[166:167]
    v_pk_add_f32 v[80:81], v[80:81], v[176:177]
    v_pk_add_f32 v[82:83], v[82:83], v[178:179]
    v_pk_add_f32 v[92:93], v[92:93], v[188:189]
    v_pk_add_f32 v[94:95], v[94:95], v[190:191]
    v_pk_add_f32 v[104:105], v[104:105], v[200:201]
    v_pk_add_f32 v[106:107], v[106:107], v[202:203]
    v_pk_add_f32 v[72:73], v[72:73], v[168:169]
    v_pk_add_f32 v[74:75], v[74:75], v[170:171]
    v_pk_add_f32 v[84:85], v[84:85], v[180:181]
    v_pk_add_f32 v[86:87], v[86:87], v[182:183]
    v_pk_add_f32 v[96:97], v[96:97], v[192:193]
    v_pk_add_f32 v[98:99], v[98:99], v[194:195]
    v_pk_add_f32 v[108:109], v[108:109], v[204:205]
    v_pk_add_f32 v[110:111], v[110:111], v[206:207]
    v_pk_add_f32 v[208:209], v[208:209], v[160:161]
    v_pk_add_f32 v[210:211], v[210:211], v[162:163]
    v_pk_add_f32 v[220:221], v[220:221], v[172:173]
    v_pk_add_f32 v[222:223], v[222:223], v[174:175]
    v_pk_add_f32 v[232:233], v[232:233], v[184:185]
    v_pk_add_f32 v[234:235], v[234:235], v[186:187]
    v_pk_add_f32 v[244:245], v[244:245], v[196:197]
    v_pk_add_f32 v[246:247], v[246:247], v[198:199]
    v_pk_add_f32 v[212:213], v[212:213], v[164:165]
    v_pk_add_f32 v[214:215], v[214:215], v[166:167]
    v_pk_add_f32 v[224:225], v[224:225], v[176:177]
    v_pk_add_f32 v[226:227], v[226:227], v[178:179]
    v_pk_add_f32 v[236:237], v[236:237], v[188:189]
    v_pk_add_f32 v[238:239], v[238:239], v[190:191]
    v_pk_add_f32 v[248:249], v[248:249], v[200:201]
    v_pk_add_f32 v[250:251], v[250:251], v[202:203]
    v_pk_add_f32 v[216:217], v[216:217], v[168:169]
    v_pk_add_f32 v[218:219], v[218:219], v[170:171]
    v_pk_add_f32 v[228:229], v[228:229], v[180:181]
    v_pk_add_f32 v[230:231], v[230:231], v[182:183]
    v_pk_add_f32 v[240:241], v[240:241], v[192:193]
    v_pk_add_f32 v[242:243], v[242:243], v[194:195]
    v_pk_add_f32 v[252:253], v[252:253], v[204:205]
    v_pk_add_f32 v[254:255], v[254:255], v[206:207]
    s_nop 0
    s_waitcnt vmcnt(8) lgkmcnt(2)
    v_mfma_f32_16x16x32_bf16 v[64:67], a[192:195], v[32:35], v[64:67]
    buffer_load_dwordx4 a[236:239], v6, s[16:19], s54 offen offset:2048
    v_mfma_f32_16x16x32_bf16 v[76:79], a[192:195], v[36:39], v[76:79]
    ds_read_b128 v[48:51], v1 offset:21504
    s_mov_b32 s54, 297984
    v_mfma_f32_16x16x32_bf16 v[88:91], a[192:195], v[40:43], v[88:91]
    ds_read_b128 v[52:55], v1 offset:23552
    v_mfma_f32_16x16x32_bf16 v[24:27], a[248:251], a[240:243], 0
    ds_read_b128 v[56:59], v1 offset:25600
    v_mfma_f32_16x16x32_bf16 v[100:103], a[192:195], v[44:47], v[100:103]
    ds_read_b128 v[60:63], v14 offset:27648
    v_mfma_f32_16x16x32_bf16 v[28:31], a[248:251], a[244:247], 0
    buffer_load_dwordx4 a[192:195], v6, s[16:19], s54 offen offset:0
    v_mfma_f32_16x16x32_bf16 v[68:71], a[196:199], v[32:35], v[68:71]
    ds_read_b64_tr_b16 a[252:253], v5 offset:12800
    v_mfma_f32_16x16x32_bf16 v[80:83], a[196:199], v[36:39], v[80:83]
    ds_read_b64_tr_b16 a[254:255], v5 offset:16000
    v_cvt_pk_bf16_f32 v24, v24, v25
    v_mfma_f32_16x16x32_bf16 v[92:95], a[196:199], v[40:43], v[92:95]
    v_cvt_pk_bf16_f32 v25, v26, v27
    v_cvt_pk_bf16_f32 v28, v28, v29
    v_mfma_f32_16x16x32_bf16 v[104:107], a[196:199], v[44:47], v[104:107]
    ds_write_b64 v3, v[24:25] offset:32768
    v_mfma_f32_16x16x32_bf16 v[72:75], a[200:203], v[32:35], v[72:75]
    v_cvt_pk_bf16_f32 v29, v30, v31
    v_mfma_f32_16x16x32_bf16 v[84:87], a[200:203], v[36:39], v[84:87]
    buffer_load_dwordx4 a[196:199], v6, s[16:19], s54 offen offset:1024
    v_mfma_f32_16x16x32_bf16 v[96:99], a[200:203], v[40:43], v[96:99]
    ds_write_b64 v3, v[28:29] offset:47104
    v_mfma_f32_16x16x32_bf16 v[108:111], a[200:203], v[44:47], v[108:111]
    s_waitcnt vmcnt(8) lgkmcnt(2)
    v_mfma_f32_16x16x32_bf16 v[208:211], a[204:207], v[48:51], v[208:211]
    buffer_load_dwordx4 a[200:203], v6, s[16:19], s54 offen offset:2048
    v_mfma_f32_16x16x32_bf16 v[220:223], a[204:207], v[52:55], v[220:223]
    ds_read_b128 v[32:35], v2 offset:0
    s_mov_b32 s54, 310400
    v_mfma_f32_16x16x32_bf16 v[232:235], a[204:207], v[56:59], v[232:235]
    ds_read_b128 v[36:39], v2 offset:2048
    v_mfma_f32_16x16x32_bf16 v[24:27], a[252:255], a[240:243], 0
    ds_read_b128 v[40:43], v2 offset:4096
    v_mfma_f32_16x16x32_bf16 v[244:247], a[204:207], v[60:63], v[244:247]
    ds_read_b128 v[44:47], v15 offset:6144
    v_mfma_f32_16x16x32_bf16 v[28:31], a[252:255], a[244:247], 0
    buffer_load_dwordx4 a[204:207], v6, s[16:19], s54 offen offset:0
    v_mfma_f32_16x16x32_bf16 v[212:215], a[208:211], v[48:51], v[212:215]
    ds_read_b64_tr_b16 a[248:249], v5 offset:25600
    v_mfma_f32_16x16x32_bf16 v[224:227], a[208:211], v[52:55], v[224:227]
    ds_read_b64_tr_b16 a[250:251], v5 offset:28800
    v_cvt_pk_bf16_f32 v24, v24, v25
    v_mfma_f32_16x16x32_bf16 v[236:239], a[208:211], v[56:59], v[236:239]
    v_cvt_pk_bf16_f32 v25, v26, v27
    v_cvt_pk_bf16_f32 v28, v28, v29
    v_mfma_f32_16x16x32_bf16 v[248:251], a[208:211], v[60:63], v[248:251]
    ds_write_b64 v3, v[24:25] offset:33792
    v_mfma_f32_16x16x32_bf16 v[216:219], a[212:215], v[48:51], v[216:219]
    v_cvt_pk_bf16_f32 v29, v30, v31
    v_mfma_f32_16x16x32_bf16 v[228:231], a[212:215], v[52:55], v[228:231]
    buffer_load_dwordx4 a[208:211], v6, s[16:19], s54 offen offset:1024
    v_mfma_f32_16x16x32_bf16 v[240:243], a[212:215], v[56:59], v[240:243]
    ds_write_b64 v3, v[28:29] offset:48128
    v_mfma_f32_16x16x32_bf16 v[252:255], a[212:215], v[60:63], v[252:255]
    s_waitcnt vmcnt(8) lgkmcnt(2)
    v_mfma_f32_16x16x32_bf16 v[64:67], a[216:219], v[32:35], v[64:67]
    buffer_load_dwordx4 a[212:215], v6, s[16:19], s54 offen offset:2048
    v_mfma_f32_16x16x32_bf16 v[76:79], a[216:219], v[36:39], v[76:79]
    ds_read_b128 v[48:51], v2 offset:21504
    s_mov_b32 s54, 322816
    v_mfma_f32_16x16x32_bf16 v[88:91], a[216:219], v[40:43], v[88:91]
    ds_read_b128 v[52:55], v2 offset:23552
    v_mfma_f32_16x16x32_bf16 v[24:27], a[248:251], a[240:243], 0
    ds_read_b128 v[56:59], v2 offset:25600
    v_mfma_f32_16x16x32_bf16 v[100:103], a[216:219], v[44:47], v[100:103]
    ds_read_b128 v[60:63], v15 offset:27648
    v_mfma_f32_16x16x32_bf16 v[28:31], a[248:251], a[244:247], 0
    buffer_load_dwordx4 a[216:219], v6, s[16:19], s54 offen offset:0
    v_mfma_f32_16x16x32_bf16 v[68:71], a[220:223], v[32:35], v[68:71]
    s_nop 0
    v_mfma_f32_16x16x32_bf16 v[80:83], a[220:223], v[36:39], v[80:83]
    s_nop 0
    v_cvt_pk_bf16_f32 v24, v24, v25
    v_mfma_f32_16x16x32_bf16 v[92:95], a[220:223], v[40:43], v[92:95]
    v_cvt_pk_bf16_f32 v25, v26, v27
    v_cvt_pk_bf16_f32 v28, v28, v29
    v_mfma_f32_16x16x32_bf16 v[104:107], a[220:223], v[44:47], v[104:107]
    ds_write_b64 v3, v[24:25] offset:34816
    v_mfma_f32_16x16x32_bf16 v[72:75], a[224:227], v[32:35], v[72:75]
    v_cvt_pk_bf16_f32 v29, v30, v31
    v_mfma_f32_16x16x32_bf16 v[84:87], a[224:227], v[36:39], v[84:87]
    buffer_load_dwordx4 a[220:223], v6, s[16:19], s54 offen offset:1024
    v_mfma_f32_16x16x32_bf16 v[96:99], a[224:227], v[40:43], v[96:99]
    ds_write_b64 v3, v[28:29] offset:49152
    v_mfma_f32_16x16x32_bf16 v[108:111], a[224:227], v[44:47], v[108:111]
    s_waitcnt vmcnt(8) lgkmcnt(2)
    v_mfma_f32_16x16x32_bf16 v[208:211], a[228:231], v[48:51], v[208:211]
    buffer_load_dwordx4 a[224:227], v6, s[16:19], s54 offen offset:2048
    v_mfma_f32_16x16x32_bf16 v[220:223], a[228:231], v[52:55], v[220:223]
    s_mov_b32 s54, 335232
    v_accvgpr_write_b32 a0, v64
    v_accvgpr_write_b32 a1, v65
    v_mfma_f32_16x16x32_bf16 v[232:235], a[228:231], v[56:59], v[232:235]
    s_waitcnt lgkmcnt(0)
    s_barrier
    v_accvgpr_write_b32 a2, v66
    v_accvgpr_write_b32 a3, v67
    v_mfma_f32_16x16x32_bf16 v[244:247], a[228:231], v[60:63], v[244:247]
    buffer_load_dwordx4 a[228:231], v6, s[16:19], s54 offen offset:0
    v_accvgpr_write_b32 a12, v76
    v_accvgpr_write_b32 a13, v77
    v_mfma_f32_16x16x32_bf16 v[212:215], a[232:235], v[48:51], v[212:215]
    ds_read_b128 v[32:35], v1 offset:35840
    v_accvgpr_write_b32 a14, v78
    v_accvgpr_write_b32 a15, v79
    v_mfma_f32_16x16x32_bf16 v[224:227], a[232:235], v[52:55], v[224:227]
    ds_read_b128 v[36:39], v1 offset:37888
    v_accvgpr_write_b32 a24, v88
    v_accvgpr_write_b32 a25, v89
    v_mfma_f32_16x16x32_bf16 v[236:239], a[232:235], v[56:59], v[236:239]
    ds_read_b128 v[40:43], v1 offset:39936
    v_accvgpr_write_b32 a26, v90
    v_mfma_f32_16x16x32_bf16 v[248:251], a[232:235], v[60:63], v[248:251]
    ds_read_b128 v[44:47], v14 offset:41984
    v_accvgpr_write_b32 a27, v91
    v_mfma_f32_16x16x32_bf16 v[216:219], a[236:239], v[48:51], v[216:219]
    buffer_load_dwordx4 a[232:235], v6, s[16:19], s54 offen offset:1024
    v_accvgpr_write_b32 a36, v100
    v_mfma_f32_16x16x32_bf16 v[228:231], a[236:239], v[52:55], v[228:231]
    ds_read_b64_tr_b16 a[248:249], v4 offset:128
    v_accvgpr_write_b32 a37, v101
    v_mfma_f32_16x16x32_bf16 v[240:243], a[236:239], v[56:59], v[240:243]
    ds_read_b64_tr_b16 a[250:251], v4 offset:3328
    v_accvgpr_write_b32 a38, v102
    v_mfma_f32_16x16x32_bf16 v[252:255], a[236:239], v[60:63], v[252:255]
    v_accvgpr_write_b32 a39, v103
    s_waitcnt vmcnt(8) lgkmcnt(0)
    v_mfma_f32_16x16x32_bf16 v[112:115], a[192:195], v[32:35], 0
    buffer_load_dwordx4 a[236:239], v6, s[16:19], s54 offen offset:2048
    v_mfma_f32_16x16x32_bf16 v[124:127], a[192:195], v[36:39], 0
    ds_read_b128 v[48:51], v1 offset:43008
    s_mov_b32 s54, 347648
    v_accvgpr_write_b32 a4, v68
    v_accvgpr_write_b32 a5, v69
    v_mfma_f32_16x16x32_bf16 v[136:139], a[192:195], v[40:43], 0
    ds_read_b128 v[52:55], v1 offset:45056
    v_accvgpr_write_b32 a6, v70
    v_accvgpr_write_b32 a7, v71
    v_mfma_f32_16x16x32_bf16 v[24:27], a[248:251], a[240:243], 0
    ds_read_b128 v[56:59], v1 offset:47104
    v_accvgpr_write_b32 a16, v80
    v_accvgpr_write_b32 a17, v81
    v_mfma_f32_16x16x32_bf16 v[148:151], a[192:195], v[44:47], 0
    ds_read_b128 v[60:63], v14 offset:49152
    v_accvgpr_write_b32 a18, v82
    v_mfma_f32_16x16x32_bf16 v[28:31], a[248:251], a[244:247], 0
    buffer_load_dwordx4 a[192:195], v6, s[16:19], s54 offen offset:0
    v_accvgpr_write_b32 a19, v83
    v_mfma_f32_16x16x32_bf16 v[116:119], a[196:199], v[32:35], 0
    ds_read_b64_tr_b16 a[252:253], v4 offset:12928
    v_accvgpr_write_b32 a28, v92
    v_mfma_f32_16x16x32_bf16 v[128:131], a[196:199], v[36:39], 0
    ds_read_b64_tr_b16 a[254:255], v4 offset:16128
    v_cvt_pk_bf16_f32 v24, v24, v25
    v_accvgpr_write_b32 a29, v93
    v_mfma_f32_16x16x32_bf16 v[140:143], a[196:199], v[40:43], 0
    v_cvt_pk_bf16_f32 v25, v26, v27
    v_cvt_pk_bf16_f32 v28, v28, v29
    v_accvgpr_write_b32 a30, v94
    v_mfma_f32_16x16x32_bf16 v[152:155], a[196:199], v[44:47], 0
    ds_write_b64 v3, v[24:25] offset:0
    v_accvgpr_write_b32 a31, v95
    v_mfma_f32_16x16x32_bf16 v[120:123], a[200:203], v[32:35], 0
    v_cvt_pk_bf16_f32 v29, v30, v31
    v_accvgpr_write_b32 a40, v104
    v_mfma_f32_16x16x32_bf16 v[132:135], a[200:203], v[36:39], 0
    buffer_load_dwordx4 a[196:199], v6, s[16:19], s54 offen offset:1024
    v_accvgpr_write_b32 a41, v105
    v_mfma_f32_16x16x32_bf16 v[144:147], a[200:203], v[40:43], 0
    ds_write_b64 v3, v[28:29] offset:14336
    v_accvgpr_write_b32 a42, v106
    v_mfma_f32_16x16x32_bf16 v[156:159], a[200:203], v[44:47], 0
    v_accvgpr_write_b32 a43, v107
    s_waitcnt vmcnt(8) lgkmcnt(2)
    v_mfma_f32_16x16x32_bf16 v[160:163], a[204:207], v[48:51], 0
    buffer_load_dwordx4 a[200:203], v6, s[16:19], s54 offen offset:2048
    v_mfma_f32_16x16x32_bf16 v[172:175], a[204:207], v[52:55], 0
    ds_read_b128 v[32:35], v2 offset:35840
    s_mov_b32 s54, 360064
    v_accvgpr_write_b32 a8, v72
    v_accvgpr_write_b32 a9, v73
    v_mfma_f32_16x16x32_bf16 v[184:187], a[204:207], v[56:59], 0
    ds_read_b128 v[36:39], v2 offset:37888
    v_accvgpr_write_b32 a10, v74
    v_accvgpr_write_b32 a11, v75
    v_mfma_f32_16x16x32_bf16 v[24:27], a[252:255], a[240:243], 0
    ds_read_b128 v[40:43], v2 offset:39936
    v_accvgpr_write_b32 a20, v84
    v_accvgpr_write_b32 a21, v85
    v_mfma_f32_16x16x32_bf16 v[196:199], a[204:207], v[60:63], 0
    ds_read_b128 v[44:47], v15 offset:41984
    v_accvgpr_write_b32 a22, v86
    v_mfma_f32_16x16x32_bf16 v[28:31], a[252:255], a[244:247], 0
    buffer_load_dwordx4 a[204:207], v6, s[16:19], s54 offen offset:0
    v_accvgpr_write_b32 a23, v87
    v_mfma_f32_16x16x32_bf16 v[164:167], a[208:211], v[48:51], 0
    ds_read_b64_tr_b16 a[248:249], v4 offset:25728
    v_accvgpr_write_b32 a32, v96
    v_mfma_f32_16x16x32_bf16 v[176:179], a[208:211], v[52:55], 0
    ds_read_b64_tr_b16 a[250:251], v4 offset:28928
    v_cvt_pk_bf16_f32 v24, v24, v25
    v_accvgpr_write_b32 a33, v97
    v_mfma_f32_16x16x32_bf16 v[188:191], a[208:211], v[56:59], 0
    v_cvt_pk_bf16_f32 v25, v26, v27
    v_cvt_pk_bf16_f32 v28, v28, v29
    v_accvgpr_write_b32 a34, v98
    v_mfma_f32_16x16x32_bf16 v[200:203], a[208:211], v[60:63], 0
    ds_write_b64 v3, v[24:25] offset:1024
    v_accvgpr_write_b32 a35, v99
    v_mfma_f32_16x16x32_bf16 v[168:171], a[212:215], v[48:51], 0
    v_cvt_pk_bf16_f32 v29, v30, v31
    v_accvgpr_write_b32 a44, v108
    v_mfma_f32_16x16x32_bf16 v[180:183], a[212:215], v[52:55], 0
    buffer_load_dwordx4 a[208:211], v6, s[16:19], s54 offen offset:1024
    v_accvgpr_write_b32 a45, v109
    v_mfma_f32_16x16x32_bf16 v[192:195], a[212:215], v[56:59], 0
    ds_write_b64 v3, v[28:29] offset:15360
    v_accvgpr_write_b32 a46, v110
    v_mfma_f32_16x16x32_bf16 v[204:207], a[212:215], v[60:63], 0
    v_accvgpr_write_b32 a47, v111
    s_waitcnt vmcnt(8) lgkmcnt(2)
    v_mfma_f32_16x16x32_bf16 v[112:115], a[216:219], v[32:35], v[112:115]
    buffer_load_dwordx4 a[212:215], v6, s[16:19], s54 offen offset:2048
    v_mfma_f32_16x16x32_bf16 v[124:127], a[216:219], v[36:39], v[124:127]
    ds_read_b128 v[48:51], v2 offset:43008
    s_mov_b32 s54, 372480
    v_accvgpr_write_b32 a48, v208
    v_accvgpr_write_b32 a49, v209
    v_mfma_f32_16x16x32_bf16 v[136:139], a[216:219], v[40:43], v[136:139]
    ds_read_b128 v[52:55], v2 offset:45056
    v_accvgpr_write_b32 a50, v210
    v_accvgpr_write_b32 a51, v211
    v_mfma_f32_16x16x32_bf16 v[24:27], a[248:251], a[240:243], 0
    ds_read_b128 v[56:59], v2 offset:47104
    v_accvgpr_write_b32 a60, v220
    v_accvgpr_write_b32 a61, v221
    v_mfma_f32_16x16x32_bf16 v[148:151], a[216:219], v[44:47], v[148:151]
    ds_read_b128 v[60:63], v15 offset:49152
    v_accvgpr_write_b32 a62, v222
    v_mfma_f32_16x16x32_bf16 v[28:31], a[248:251], a[244:247], 0
    buffer_load_dwordx4 a[216:219], v6, s[16:19], s54 offen offset:0
    v_accvgpr_write_b32 a63, v223
    v_mfma_f32_16x16x32_bf16 v[116:119], a[220:223], v[32:35], v[116:119]
    ds_read_b64_tr_b16 a[252:253], v4 offset:38528
    v_accvgpr_write_b32 a72, v232
    v_mfma_f32_16x16x32_bf16 v[128:131], a[220:223], v[36:39], v[128:131]
    ds_read_b64_tr_b16 a[254:255], v4 offset:41728
    v_cvt_pk_bf16_f32 v24, v24, v25
    v_accvgpr_write_b32 a73, v233
    v_mfma_f32_16x16x32_bf16 v[140:143], a[220:223], v[40:43], v[140:143]
    v_cvt_pk_bf16_f32 v25, v26, v27
    v_cvt_pk_bf16_f32 v28, v28, v29
    v_accvgpr_write_b32 a74, v234
    v_mfma_f32_16x16x32_bf16 v[152:155], a[220:223], v[44:47], v[152:155]
    ds_write_b64 v3, v[24:25] offset:2048
    v_accvgpr_write_b32 a75, v235
    v_mfma_f32_16x16x32_bf16 v[120:123], a[224:227], v[32:35], v[120:123]
    v_cvt_pk_bf16_f32 v29, v30, v31
    v_accvgpr_write_b32 a84, v244
    v_mfma_f32_16x16x32_bf16 v[132:135], a[224:227], v[36:39], v[132:135]
    buffer_load_dwordx4 a[220:223], v6, s[16:19], s54 offen offset:1024
    v_accvgpr_write_b32 a85, v245
    v_mfma_f32_16x16x32_bf16 v[144:147], a[224:227], v[40:43], v[144:147]
    ds_write_b64 v3, v[28:29] offset:16384
    v_accvgpr_write_b32 a86, v246
    v_mfma_f32_16x16x32_bf16 v[156:159], a[224:227], v[44:47], v[156:159]
    v_accvgpr_write_b32 a87, v247
    s_waitcnt vmcnt(8) lgkmcnt(2)
    v_mfma_f32_16x16x32_bf16 v[160:163], a[228:231], v[48:51], v[160:163]
    buffer_load_dwordx4 a[224:227], v6, s[16:19], s54 offen offset:2048
    v_mfma_f32_16x16x32_bf16 v[172:175], a[228:231], v[52:55], v[172:175]
    ds_read_b128 v[32:35], v1 offset:28672
    s_mov_b32 s54, 384896
    v_accvgpr_write_b32 a52, v212
    v_accvgpr_write_b32 a53, v213
    v_mfma_f32_16x16x32_bf16 v[184:187], a[228:231], v[56:59], v[184:187]
    ds_read_b128 v[36:39], v1 offset:30720
    v_accvgpr_write_b32 a54, v214
    v_accvgpr_write_b32 a55, v215
    v_mfma_f32_16x16x32_bf16 v[24:27], a[252:255], a[240:243], 0
    ds_read_b128 v[40:43], v1 offset:32768
    v_accvgpr_write_b32 a64, v224
    v_accvgpr_write_b32 a65, v225
    v_mfma_f32_16x16x32_bf16 v[196:199], a[228:231], v[60:63], v[196:199]
    ds_read_b128 v[44:47], v14 offset:34816
    v_accvgpr_write_b32 a66, v226
    v_mfma_f32_16x16x32_bf16 v[28:31], a[252:255], a[244:247], 0
    buffer_load_dwordx4 a[228:231], v6, s[16:19], s54 offen offset:0
    v_accvgpr_write_b32 a67, v227
    v_mfma_f32_16x16x32_bf16 v[164:167], a[232:235], v[48:51], v[164:167]
    ds_read_b64_tr_b16 a[248:249], v5 offset:128
    v_accvgpr_write_b32 a76, v236
    v_mfma_f32_16x16x32_bf16 v[176:179], a[232:235], v[52:55], v[176:179]
    ds_read_b64_tr_b16 a[250:251], v5 offset:3328
    v_cvt_pk_bf16_f32 v24, v24, v25
    v_accvgpr_write_b32 a77, v237
    v_mfma_f32_16x16x32_bf16 v[188:191], a[232:235], v[56:59], v[188:191]
    v_cvt_pk_bf16_f32 v25, v26, v27
    v_cvt_pk_bf16_f32 v28, v28, v29
    v_accvgpr_write_b32 a78, v238
    v_mfma_f32_16x16x32_bf16 v[200:203], a[232:235], v[60:63], v[200:203]
    ds_write_b64 v3, v[24:25] offset:3072
    v_accvgpr_write_b32 a79, v239
    v_mfma_f32_16x16x32_bf16 v[168:171], a[236:239], v[48:51], v[168:171]
    v_cvt_pk_bf16_f32 v29, v30, v31
    v_accvgpr_write_b32 a88, v248
    v_mfma_f32_16x16x32_bf16 v[180:183], a[236:239], v[52:55], v[180:183]
    buffer_load_dwordx4 a[232:235], v6, s[16:19], s54 offen offset:1024
    v_accvgpr_write_b32 a89, v249
    v_mfma_f32_16x16x32_bf16 v[192:195], a[236:239], v[56:59], v[192:195]
    ds_write_b64 v3, v[28:29] offset:17408
    v_accvgpr_write_b32 a90, v250
    v_mfma_f32_16x16x32_bf16 v[204:207], a[236:239], v[60:63], v[204:207]
    v_accvgpr_write_b32 a91, v251
    s_waitcnt vmcnt(8) lgkmcnt(2)
    v_mfma_f32_16x16x32_bf16 v[64:67], a[192:195], v[32:35], v[64:67]
    buffer_load_dwordx4 a[236:239], v6, s[16:19], s54 offen offset:2048
    v_mfma_f32_16x16x32_bf16 v[76:79], a[192:195], v[36:39], v[76:79]
    ds_read_b128 v[48:51], v1 offset:50176
    s_mov_b32 s54, 397312
    v_accvgpr_write_b32 a56, v216
    v_accvgpr_write_b32 a57, v217
    v_mfma_f32_16x16x32_bf16 v[88:91], a[192:195], v[40:43], v[88:91]
    ds_read_b128 v[52:55], v1 offset:52224
    v_accvgpr_write_b32 a58, v218
    v_accvgpr_write_b32 a59, v219
    v_mfma_f32_16x16x32_bf16 v[24:27], a[248:251], a[240:243], 0
    ds_read_b128 v[56:59], v1 offset:54272
    v_accvgpr_write_b32 a68, v228
    v_accvgpr_write_b32 a69, v229
    v_mfma_f32_16x16x32_bf16 v[100:103], a[192:195], v[44:47], v[100:103]
    ds_read_b128 v[60:63], v14 offset:56320
    v_accvgpr_write_b32 a70, v230
    v_mfma_f32_16x16x32_bf16 v[28:31], a[248:251], a[244:247], 0
    buffer_load_dwordx4 a[192:195], v6, s[16:19], s54 offen offset:0
    v_accvgpr_write_b32 a71, v231
    v_mfma_f32_16x16x32_bf16 v[68:71], a[196:199], v[32:35], v[68:71]
    ds_read_b64_tr_b16 a[252:253], v5 offset:12928
    v_accvgpr_write_b32 a80, v240
    v_mfma_f32_16x16x32_bf16 v[80:83], a[196:199], v[36:39], v[80:83]
    ds_read_b64_tr_b16 a[254:255], v5 offset:16128
    v_cvt_pk_bf16_f32 v24, v24, v25
    v_accvgpr_write_b32 a81, v241
    v_mfma_f32_16x16x32_bf16 v[92:95], a[196:199], v[40:43], v[92:95]
    v_cvt_pk_bf16_f32 v25, v26, v27
    v_cvt_pk_bf16_f32 v28, v28, v29
    v_accvgpr_write_b32 a82, v242
    v_mfma_f32_16x16x32_bf16 v[104:107], a[196:199], v[44:47], v[104:107]
    ds_write_b64 v3, v[24:25] offset:4096
    v_accvgpr_write_b32 a83, v243
    v_mfma_f32_16x16x32_bf16 v[72:75], a[200:203], v[32:35], v[72:75]
    v_cvt_pk_bf16_f32 v29, v30, v31
    v_accvgpr_write_b32 a92, v252
    v_mfma_f32_16x16x32_bf16 v[84:87], a[200:203], v[36:39], v[84:87]
    buffer_load_dwordx4 a[196:199], v6, s[16:19], s54 offen offset:1024
    v_accvgpr_write_b32 a93, v253
    v_mfma_f32_16x16x32_bf16 v[96:99], a[200:203], v[40:43], v[96:99]
    ds_write_b64 v3, v[28:29] offset:18432
    v_accvgpr_write_b32 a94, v254
    v_mfma_f32_16x16x32_bf16 v[108:111], a[200:203], v[44:47], v[108:111]
    v_accvgpr_write_b32 a95, v255
    s_waitcnt vmcnt(8) lgkmcnt(2)
    v_mfma_f32_16x16x32_bf16 v[208:211], a[204:207], v[48:51], v[208:211]
    buffer_load_dwordx4 a[200:203], v6, s[16:19], s54 offen offset:2048
    v_mfma_f32_16x16x32_bf16 v[220:223], a[204:207], v[52:55], v[220:223]
    ds_read_b128 v[32:35], v2 offset:28672
    s_mov_b32 s54, 409728
    v_mfma_f32_16x16x32_bf16 v[232:235], a[204:207], v[56:59], v[232:235]
    ds_read_b128 v[36:39], v2 offset:30720
    v_mfma_f32_16x16x32_bf16 v[24:27], a[252:255], a[240:243], 0
    ds_read_b128 v[40:43], v2 offset:32768
    v_mfma_f32_16x16x32_bf16 v[244:247], a[204:207], v[60:63], v[244:247]
    ds_read_b128 v[44:47], v15 offset:34816
    v_mfma_f32_16x16x32_bf16 v[28:31], a[252:255], a[244:247], 0
    buffer_load_dwordx4 a[204:207], v6, s[16:19], s54 offen offset:0
    v_mfma_f32_16x16x32_bf16 v[212:215], a[208:211], v[48:51], v[212:215]
    ds_read_b64_tr_b16 a[248:249], v5 offset:25728
    v_mfma_f32_16x16x32_bf16 v[224:227], a[208:211], v[52:55], v[224:227]
    ds_read_b64_tr_b16 a[250:251], v5 offset:28928
    v_cvt_pk_bf16_f32 v24, v24, v25
    v_mfma_f32_16x16x32_bf16 v[236:239], a[208:211], v[56:59], v[236:239]
    v_cvt_pk_bf16_f32 v25, v26, v27
    v_cvt_pk_bf16_f32 v28, v28, v29
    v_mfma_f32_16x16x32_bf16 v[248:251], a[208:211], v[60:63], v[248:251]
    ds_write_b64 v3, v[24:25] offset:5120
    v_mfma_f32_16x16x32_bf16 v[216:219], a[212:215], v[48:51], v[216:219]
    v_cvt_pk_bf16_f32 v29, v30, v31
    v_mfma_f32_16x16x32_bf16 v[228:231], a[212:215], v[52:55], v[228:231]
    buffer_load_dwordx4 a[208:211], v6, s[16:19], s54 offen offset:1024
    v_mfma_f32_16x16x32_bf16 v[240:243], a[212:215], v[56:59], v[240:243]
    ds_write_b64 v3, v[28:29] offset:19456
    v_mfma_f32_16x16x32_bf16 v[252:255], a[212:215], v[60:63], v[252:255]
    s_waitcnt vmcnt(8) lgkmcnt(2)
    v_mfma_f32_16x16x32_bf16 v[64:67], a[216:219], v[32:35], v[64:67]
    buffer_load_dwordx4 a[212:215], v6, s[16:19], s54 offen offset:2048
    v_mfma_f32_16x16x32_bf16 v[76:79], a[216:219], v[36:39], v[76:79]
    ds_read_b128 v[48:51], v2 offset:50176
    s_mov_b32 s54, 422144
    v_mfma_f32_16x16x32_bf16 v[88:91], a[216:219], v[40:43], v[88:91]
    ds_read_b128 v[52:55], v2 offset:52224
    v_mfma_f32_16x16x32_bf16 v[24:27], a[248:251], a[240:243], 0
    ds_read_b128 v[56:59], v2 offset:54272
    v_mfma_f32_16x16x32_bf16 v[100:103], a[216:219], v[44:47], v[100:103]
    ds_read_b128 v[60:63], v15 offset:56320
    v_mfma_f32_16x16x32_bf16 v[28:31], a[248:251], a[244:247], 0
    buffer_load_dwordx4 a[216:219], v6, s[16:19], s54 offen offset:0
    v_mfma_f32_16x16x32_bf16 v[68:71], a[220:223], v[32:35], v[68:71]
    s_nop 0
    v_mfma_f32_16x16x32_bf16 v[80:83], a[220:223], v[36:39], v[80:83]
    s_nop 0
    v_cvt_pk_bf16_f32 v24, v24, v25
    v_mfma_f32_16x16x32_bf16 v[92:95], a[220:223], v[40:43], v[92:95]
    v_cvt_pk_bf16_f32 v25, v26, v27
    v_cvt_pk_bf16_f32 v28, v28, v29
    v_mfma_f32_16x16x32_bf16 v[104:107], a[220:223], v[44:47], v[104:107]
    ds_write_b64 v3, v[24:25] offset:6144
    v_mfma_f32_16x16x32_bf16 v[72:75], a[224:227], v[32:35], v[72:75]
    v_cvt_pk_bf16_f32 v29, v30, v31
    v_mfma_f32_16x16x32_bf16 v[84:87], a[224:227], v[36:39], v[84:87]
    buffer_load_dwordx4 a[220:223], v6, s[16:19], s54 offen offset:1024
    v_mfma_f32_16x16x32_bf16 v[96:99], a[224:227], v[40:43], v[96:99]
    ds_write_b64 v3, v[28:29] offset:20480
    v_mfma_f32_16x16x32_bf16 v[108:111], a[224:227], v[44:47], v[108:111]
    s_waitcnt vmcnt(8) lgkmcnt(2)
    v_mfma_f32_16x16x32_bf16 v[208:211], a[228:231], v[48:51], v[208:211]
    buffer_load_dwordx4 a[224:227], v6, s[16:19], s54 offen offset:2048
    v_mfma_f32_16x16x32_bf16 v[220:223], a[228:231], v[52:55], v[220:223]
    s_mov_b32 s54, 434560
    v_mfma_f32_16x16x32_bf16 v[232:235], a[228:231], v[56:59], v[232:235]
    s_waitcnt lgkmcnt(0)
    s_barrier
    v_mfma_f32_16x16x32_bf16 v[244:247], a[228:231], v[60:63], v[244:247]
    buffer_load_dwordx4 a[228:231], v6, s[16:19], s54 offen offset:0
    v_mfma_f32_16x16x32_bf16 v[212:215], a[232:235], v[48:51], v[212:215]
    ds_read_b128 v[32:35], v1 offset:7168
    v_mfma_f32_16x16x32_bf16 v[224:227], a[232:235], v[52:55], v[224:227]
    ds_read_b128 v[36:39], v1 offset:9216
    v_mfma_f32_16x16x32_bf16 v[236:239], a[232:235], v[56:59], v[236:239]
    ds_read_b128 v[40:43], v1 offset:11264
    v_mfma_f32_16x16x32_bf16 v[248:251], a[232:235], v[60:63], v[248:251]
    ds_read_b128 v[44:47], v14 offset:13312
    v_mfma_f32_16x16x32_bf16 v[216:219], a[236:239], v[48:51], v[216:219]
    buffer_load_dwordx4 a[232:235], v6, s[16:19], s54 offen offset:1024
    v_mfma_f32_16x16x32_bf16 v[228:231], a[236:239], v[52:55], v[228:231]
    ds_read_b64_tr_b16 a[248:249], v4 offset:256
    v_mfma_f32_16x16x32_bf16 v[240:243], a[236:239], v[56:59], v[240:243]
    ds_read_b64_tr_b16 a[250:251], v4 offset:3456
    v_mfma_f32_16x16x32_bf16 v[252:255], a[236:239], v[60:63], v[252:255]
    s_waitcnt vmcnt(8) lgkmcnt(0)
    v_mfma_f32_16x16x32_bf16 v[112:115], a[192:195], v[32:35], v[112:115]
    buffer_load_dwordx4 a[236:239], v6, s[16:19], s54 offen offset:2048
    v_mfma_f32_16x16x32_bf16 v[124:127], a[192:195], v[36:39], v[124:127]
    ds_read_b128 v[48:51], v1 offset:14336
    s_mov_b32 s54, 446976
    v_mfma_f32_16x16x32_bf16 v[136:139], a[192:195], v[40:43], v[136:139]
    ds_read_b128 v[52:55], v1 offset:16384
    v_mfma_f32_16x16x32_bf16 v[24:27], a[248:251], a[240:243], 0
    ds_read_b128 v[56:59], v1 offset:18432
    v_mfma_f32_16x16x32_bf16 v[148:151], a[192:195], v[44:47], v[148:151]
    ds_read_b128 v[60:63], v14 offset:20480
    v_mfma_f32_16x16x32_bf16 v[28:31], a[248:251], a[244:247], 0
    buffer_load_dwordx4 a[192:195], v6, s[16:19], s54 offen offset:0
    v_mfma_f32_16x16x32_bf16 v[116:119], a[196:199], v[32:35], v[116:119]
    ds_read_b64_tr_b16 a[252:253], v4 offset:13056
    v_mfma_f32_16x16x32_bf16 v[128:131], a[196:199], v[36:39], v[128:131]
    ds_read_b64_tr_b16 a[254:255], v4 offset:16256
    v_cvt_pk_bf16_f32 v24, v24, v25
    v_mfma_f32_16x16x32_bf16 v[140:143], a[196:199], v[40:43], v[140:143]
    v_cvt_pk_bf16_f32 v25, v26, v27
    v_cvt_pk_bf16_f32 v28, v28, v29
    v_mfma_f32_16x16x32_bf16 v[152:155], a[196:199], v[44:47], v[152:155]
    ds_write_b64 v3, v[24:25] offset:28672
    v_mfma_f32_16x16x32_bf16 v[120:123], a[200:203], v[32:35], v[120:123]
    v_cvt_pk_bf16_f32 v29, v30, v31
    v_mfma_f32_16x16x32_bf16 v[132:135], a[200:203], v[36:39], v[132:135]
    buffer_load_dwordx4 a[196:199], v6, s[16:19], s54 offen offset:1024
    v_mfma_f32_16x16x32_bf16 v[144:147], a[200:203], v[40:43], v[144:147]
    ds_write_b64 v3, v[28:29] offset:43008
    v_mfma_f32_16x16x32_bf16 v[156:159], a[200:203], v[44:47], v[156:159]
    s_waitcnt vmcnt(8) lgkmcnt(2)
    v_mfma_f32_16x16x32_bf16 v[160:163], a[204:207], v[48:51], v[160:163]
    buffer_load_dwordx4 a[200:203], v6, s[16:19], s54 offen offset:2048
    v_mfma_f32_16x16x32_bf16 v[172:175], a[204:207], v[52:55], v[172:175]
    ds_read_b128 v[32:35], v2 offset:7168
    s_mov_b32 s54, 459392
    v_mfma_f32_16x16x32_bf16 v[184:187], a[204:207], v[56:59], v[184:187]
    ds_read_b128 v[36:39], v2 offset:9216
    v_mfma_f32_16x16x32_bf16 v[24:27], a[252:255], a[240:243], 0
    ds_read_b128 v[40:43], v2 offset:11264
    v_mfma_f32_16x16x32_bf16 v[196:199], a[204:207], v[60:63], v[196:199]
    ds_read_b128 v[44:47], v15 offset:13312
    v_mfma_f32_16x16x32_bf16 v[28:31], a[252:255], a[244:247], 0
    buffer_load_dwordx4 a[204:207], v6, s[16:19], s54 offen offset:0
    v_mfma_f32_16x16x32_bf16 v[164:167], a[208:211], v[48:51], v[164:167]
    ds_read_b64_tr_b16 a[248:249], v4 offset:25856
    v_mfma_f32_16x16x32_bf16 v[176:179], a[208:211], v[52:55], v[176:179]
    ds_read_b64_tr_b16 a[250:251], v4 offset:29056
    v_cvt_pk_bf16_f32 v24, v24, v25
    v_mfma_f32_16x16x32_bf16 v[188:191], a[208:211], v[56:59], v[188:191]
    v_cvt_pk_bf16_f32 v25, v26, v27
    v_cvt_pk_bf16_f32 v28, v28, v29
    v_mfma_f32_16x16x32_bf16 v[200:203], a[208:211], v[60:63], v[200:203]
    ds_write_b64 v3, v[24:25] offset:29696
    v_mfma_f32_16x16x32_bf16 v[168:171], a[212:215], v[48:51], v[168:171]
    v_cvt_pk_bf16_f32 v29, v30, v31
    v_mfma_f32_16x16x32_bf16 v[180:183], a[212:215], v[52:55], v[180:183]
    buffer_load_dwordx4 a[208:211], v6, s[16:19], s54 offen offset:1024
    v_mfma_f32_16x16x32_bf16 v[192:195], a[212:215], v[56:59], v[192:195]
    ds_write_b64 v3, v[28:29] offset:44032
    v_mfma_f32_16x16x32_bf16 v[204:207], a[212:215], v[60:63], v[204:207]
    s_waitcnt vmcnt(8) lgkmcnt(2)
    v_mfma_f32_16x16x32_bf16 v[112:115], a[216:219], v[32:35], v[112:115]
    buffer_load_dwordx4 a[212:215], v6, s[16:19], s54 offen offset:2048
    v_mfma_f32_16x16x32_bf16 v[124:127], a[216:219], v[36:39], v[124:127]
    ds_read_b128 v[48:51], v2 offset:14336
    s_mov_b32 s54, 471808
    v_mfma_f32_16x16x32_bf16 v[136:139], a[216:219], v[40:43], v[136:139]
    ds_read_b128 v[52:55], v2 offset:16384
    v_mfma_f32_16x16x32_bf16 v[24:27], a[248:251], a[240:243], 0
    ds_read_b128 v[56:59], v2 offset:18432
    v_mfma_f32_16x16x32_bf16 v[148:151], a[216:219], v[44:47], v[148:151]
    ds_read_b128 v[60:63], v15 offset:20480
    v_mfma_f32_16x16x32_bf16 v[28:31], a[248:251], a[244:247], 0
    buffer_load_dwordx4 a[216:219], v6, s[16:19], s54 offen offset:0
    v_mfma_f32_16x16x32_bf16 v[116:119], a[220:223], v[32:35], v[116:119]
    ds_read_b64_tr_b16 a[252:253], v4 offset:38656
    v_mfma_f32_16x16x32_bf16 v[128:131], a[220:223], v[36:39], v[128:131]
    ds_read_b64_tr_b16 a[254:255], v4 offset:41856
    v_cvt_pk_bf16_f32 v24, v24, v25
    v_mfma_f32_16x16x32_bf16 v[140:143], a[220:223], v[40:43], v[140:143]
    v_cvt_pk_bf16_f32 v25, v26, v27
    v_cvt_pk_bf16_f32 v28, v28, v29
    v_mfma_f32_16x16x32_bf16 v[152:155], a[220:223], v[44:47], v[152:155]
    ds_write_b64 v3, v[24:25] offset:30720
    v_mfma_f32_16x16x32_bf16 v[120:123], a[224:227], v[32:35], v[120:123]
    v_cvt_pk_bf16_f32 v29, v30, v31
    v_mfma_f32_16x16x32_bf16 v[132:135], a[224:227], v[36:39], v[132:135]
    buffer_load_dwordx4 a[220:223], v6, s[16:19], s54 offen offset:1024
    v_mfma_f32_16x16x32_bf16 v[144:147], a[224:227], v[40:43], v[144:147]
    ds_write_b64 v3, v[28:29] offset:45056
    v_mfma_f32_16x16x32_bf16 v[156:159], a[224:227], v[44:47], v[156:159]
    s_waitcnt vmcnt(8) lgkmcnt(2)
    v_mfma_f32_16x16x32_bf16 v[160:163], a[228:231], v[48:51], v[160:163]
    buffer_load_dwordx4 a[224:227], v6, s[16:19], s54 offen offset:2048
    v_mfma_f32_16x16x32_bf16 v[172:175], a[228:231], v[52:55], v[172:175]
    ds_read_b128 v[32:35], v1 offset:0
    s_mov_b32 s54, 484224
    v_mfma_f32_16x16x32_bf16 v[184:187], a[228:231], v[56:59], v[184:187]
    ds_read_b128 v[36:39], v1 offset:2048
    v_mfma_f32_16x16x32_bf16 v[24:27], a[252:255], a[240:243], 0
    ds_read_b128 v[40:43], v1 offset:4096
    v_mfma_f32_16x16x32_bf16 v[196:199], a[228:231], v[60:63], v[196:199]
    ds_read_b128 v[44:47], v14 offset:6144
    v_mfma_f32_16x16x32_bf16 v[28:31], a[252:255], a[244:247], 0
    buffer_load_dwordx4 a[228:231], v6, s[16:19], s54 offen offset:0
    v_mfma_f32_16x16x32_bf16 v[164:167], a[232:235], v[48:51], v[164:167]
    ds_read_b64_tr_b16 a[248:249], v5 offset:256
    v_mfma_f32_16x16x32_bf16 v[176:179], a[232:235], v[52:55], v[176:179]
    ds_read_b64_tr_b16 a[250:251], v5 offset:3456
    v_cvt_pk_bf16_f32 v24, v24, v25
    v_mfma_f32_16x16x32_bf16 v[188:191], a[232:235], v[56:59], v[188:191]
    v_cvt_pk_bf16_f32 v25, v26, v27
    v_cvt_pk_bf16_f32 v28, v28, v29
    v_mfma_f32_16x16x32_bf16 v[200:203], a[232:235], v[60:63], v[200:203]
    ds_write_b64 v3, v[24:25] offset:31744
    v_mfma_f32_16x16x32_bf16 v[168:171], a[236:239], v[48:51], v[168:171]
    v_cvt_pk_bf16_f32 v29, v30, v31
    v_mfma_f32_16x16x32_bf16 v[180:183], a[236:239], v[52:55], v[180:183]
    buffer_load_dwordx4 a[232:235], v6, s[16:19], s54 offen offset:1024
    v_mfma_f32_16x16x32_bf16 v[192:195], a[236:239], v[56:59], v[192:195]
    ds_write_b64 v3, v[28:29] offset:46080
    v_mfma_f32_16x16x32_bf16 v[204:207], a[236:239], v[60:63], v[204:207]
    s_waitcnt vmcnt(8) lgkmcnt(2)
    v_mfma_f32_16x16x32_bf16 v[64:67], a[192:195], v[32:35], v[64:67]
    buffer_load_dwordx4 a[236:239], v6, s[16:19], s54 offen offset:2048
    v_mfma_f32_16x16x32_bf16 v[76:79], a[192:195], v[36:39], v[76:79]
    ds_read_b128 v[48:51], v1 offset:21504
    s_mov_b32 s54, 496640
    v_mfma_f32_16x16x32_bf16 v[88:91], a[192:195], v[40:43], v[88:91]
    ds_read_b128 v[52:55], v1 offset:23552
    v_mfma_f32_16x16x32_bf16 v[24:27], a[248:251], a[240:243], 0
    ds_read_b128 v[56:59], v1 offset:25600
    v_mfma_f32_16x16x32_bf16 v[100:103], a[192:195], v[44:47], v[100:103]
    ds_read_b128 v[60:63], v14 offset:27648
    v_mfma_f32_16x16x32_bf16 v[28:31], a[248:251], a[244:247], 0
    buffer_load_dwordx4 a[192:195], v6, s[16:19], s54 offen offset:0
    v_mfma_f32_16x16x32_bf16 v[68:71], a[196:199], v[32:35], v[68:71]
    ds_read_b64_tr_b16 a[252:253], v5 offset:13056
    v_mfma_f32_16x16x32_bf16 v[80:83], a[196:199], v[36:39], v[80:83]
    ds_read_b64_tr_b16 a[254:255], v5 offset:16256
    v_cvt_pk_bf16_f32 v24, v24, v25
    v_mfma_f32_16x16x32_bf16 v[92:95], a[196:199], v[40:43], v[92:95]
    v_cvt_pk_bf16_f32 v25, v26, v27
    v_cvt_pk_bf16_f32 v28, v28, v29
    v_mfma_f32_16x16x32_bf16 v[104:107], a[196:199], v[44:47], v[104:107]
    ds_write_b64 v3, v[24:25] offset:32768
    v_mfma_f32_16x16x32_bf16 v[72:75], a[200:203], v[32:35], v[72:75]
    v_cvt_pk_bf16_f32 v29, v30, v31
    v_mfma_f32_16x16x32_bf16 v[84:87], a[200:203], v[36:39], v[84:87]
    buffer_load_dwordx4 a[196:199], v6, s[16:19], s54 offen offset:1024
    v_mfma_f32_16x16x32_bf16 v[96:99], a[200:203], v[40:43], v[96:99]
    ds_write_b64 v3, v[28:29] offset:47104
    v_mfma_f32_16x16x32_bf16 v[108:111], a[200:203], v[44:47], v[108:111]
    s_waitcnt vmcnt(8) lgkmcnt(2)
    v_mfma_f32_16x16x32_bf16 v[208:211], a[204:207], v[48:51], v[208:211]
    buffer_load_dwordx4 a[200:203], v6, s[16:19], s54 offen offset:2048
    v_mfma_f32_16x16x32_bf16 v[220:223], a[204:207], v[52:55], v[220:223]
    ds_read_b128 v[32:35], v2 offset:0
    s_mov_b32 s54, 509056
    v_mfma_f32_16x16x32_bf16 v[232:235], a[204:207], v[56:59], v[232:235]
    ds_read_b128 v[36:39], v2 offset:2048
    v_mfma_f32_16x16x32_bf16 v[24:27], a[252:255], a[240:243], 0
    ds_read_b128 v[40:43], v2 offset:4096
    v_mfma_f32_16x16x32_bf16 v[244:247], a[204:207], v[60:63], v[244:247]
    ds_read_b128 v[44:47], v15 offset:6144
    v_mfma_f32_16x16x32_bf16 v[28:31], a[252:255], a[244:247], 0
    buffer_load_dwordx4 a[204:207], v6, s[16:19], s54 offen offset:0
    v_mfma_f32_16x16x32_bf16 v[212:215], a[208:211], v[48:51], v[212:215]
    ds_read_b64_tr_b16 a[248:249], v5 offset:25856
    v_mfma_f32_16x16x32_bf16 v[224:227], a[208:211], v[52:55], v[224:227]
    ds_read_b64_tr_b16 a[250:251], v5 offset:29056
    v_cvt_pk_bf16_f32 v24, v24, v25
    v_mfma_f32_16x16x32_bf16 v[236:239], a[208:211], v[56:59], v[236:239]
    v_cvt_pk_bf16_f32 v25, v26, v27
    v_cvt_pk_bf16_f32 v28, v28, v29
    v_mfma_f32_16x16x32_bf16 v[248:251], a[208:211], v[60:63], v[248:251]
    ds_write_b64 v3, v[24:25] offset:33792
    v_mfma_f32_16x16x32_bf16 v[216:219], a[212:215], v[48:51], v[216:219]
    v_cvt_pk_bf16_f32 v29, v30, v31
    v_mfma_f32_16x16x32_bf16 v[228:231], a[212:215], v[52:55], v[228:231]
    buffer_load_dwordx4 a[208:211], v6, s[16:19], s54 offen offset:1024
    v_mfma_f32_16x16x32_bf16 v[240:243], a[212:215], v[56:59], v[240:243]
    ds_write_b64 v3, v[28:29] offset:48128
    v_mfma_f32_16x16x32_bf16 v[252:255], a[212:215], v[60:63], v[252:255]
    s_waitcnt vmcnt(8) lgkmcnt(2)
    v_mfma_f32_16x16x32_bf16 v[64:67], a[216:219], v[32:35], v[64:67]
    buffer_load_dwordx4 a[212:215], v6, s[16:19], s54 offen offset:2048
    v_mfma_f32_16x16x32_bf16 v[76:79], a[216:219], v[36:39], v[76:79]
    ds_read_b128 v[48:51], v2 offset:21504
    s_mov_b32 s54, 521472
    v_sub_u32 v4, v4, v11
    v_mfma_f32_16x16x32_bf16 v[88:91], a[216:219], v[40:43], v[88:91]
    ds_read_b128 v[52:55], v2 offset:23552
    v_sub_u32 v5, v5, v11
    v_mfma_f32_16x16x32_bf16 v[24:27], a[248:251], a[240:243], 0
    ds_read_b128 v[56:59], v2 offset:25600
    v_mfma_f32_16x16x32_bf16 v[100:103], a[216:219], v[44:47], v[100:103]
    ds_read_b128 v[60:63], v15 offset:27648
    v_mfma_f32_16x16x32_bf16 v[28:31], a[248:251], a[244:247], 0
    buffer_load_dwordx4 a[216:219], v6, s[16:19], s54 offen offset:0
    v_mfma_f32_16x16x32_bf16 v[68:71], a[220:223], v[32:35], v[68:71]
    s_nop 0
    v_mfma_f32_16x16x32_bf16 v[80:83], a[220:223], v[36:39], v[80:83]
    s_nop 0
    v_cvt_pk_bf16_f32 v24, v24, v25
    v_mfma_f32_16x16x32_bf16 v[92:95], a[220:223], v[40:43], v[92:95]
    v_cvt_pk_bf16_f32 v25, v26, v27
    v_cvt_pk_bf16_f32 v28, v28, v29
    v_mfma_f32_16x16x32_bf16 v[104:107], a[220:223], v[44:47], v[104:107]
    ds_write_b64 v3, v[24:25] offset:34816
    v_mfma_f32_16x16x32_bf16 v[72:75], a[224:227], v[32:35], v[72:75]
    v_cvt_pk_bf16_f32 v29, v30, v31
    v_mfma_f32_16x16x32_bf16 v[84:87], a[224:227], v[36:39], v[84:87]
    buffer_load_dwordx4 a[220:223], v6, s[16:19], s54 offen offset:1024
    v_mfma_f32_16x16x32_bf16 v[96:99], a[224:227], v[40:43], v[96:99]
    ds_write_b64 v3, v[28:29] offset:49152
    v_mfma_f32_16x16x32_bf16 v[108:111], a[224:227], v[44:47], v[108:111]
    s_waitcnt vmcnt(8) lgkmcnt(2)
    v_mfma_f32_16x16x32_bf16 v[208:211], a[228:231], v[48:51], v[208:211]
    buffer_load_dwordx4 a[224:227], v6, s[16:19], s54 offen offset:2048
    v_mfma_f32_16x16x32_bf16 v[220:223], a[228:231], v[52:55], v[220:223]
    s_mov_b32 s54, 533888
    v_mfma_f32_16x16x32_bf16 v[232:235], a[228:231], v[56:59], v[232:235]
    s_waitcnt lgkmcnt(0)
    s_barrier
    v_mfma_f32_16x16x32_bf16 v[244:247], a[228:231], v[60:63], v[244:247]
    buffer_load_dwordx4 a[228:231], v6, s[16:19], s54 offen offset:0
    v_mfma_f32_16x16x32_bf16 v[212:215], a[232:235], v[48:51], v[212:215]
    ds_read_b128 v[32:35], v1 offset:35840
    v_mfma_f32_16x16x32_bf16 v[224:227], a[232:235], v[52:55], v[224:227]
    ds_read_b128 v[36:39], v1 offset:37888
    v_mfma_f32_16x16x32_bf16 v[236:239], a[232:235], v[56:59], v[236:239]
    ds_read_b128 v[40:43], v1 offset:39936
    v_mfma_f32_16x16x32_bf16 v[248:251], a[232:235], v[60:63], v[248:251]
    ds_read_b128 v[44:47], v14 offset:41984
    v_mfma_f32_16x16x32_bf16 v[216:219], a[236:239], v[48:51], v[216:219]
    buffer_load_dwordx4 a[232:235], v6, s[16:19], s54 offen offset:1024
    v_mfma_f32_16x16x32_bf16 v[228:231], a[236:239], v[52:55], v[228:231]
    ds_read_b64_tr_b16 a[248:249], v4 offset:0
    v_mfma_f32_16x16x32_bf16 v[240:243], a[236:239], v[56:59], v[240:243]
    ds_read_b64_tr_b16 a[250:251], v4 offset:3200
    v_mfma_f32_16x16x32_bf16 v[252:255], a[236:239], v[60:63], v[252:255]
    s_waitcnt vmcnt(8) lgkmcnt(0)
    v_mfma_f32_16x16x32_bf16 v[112:115], a[192:195], v[32:35], v[112:115]
    buffer_load_dwordx4 a[236:239], v6, s[16:19], s54 offen offset:2048
    v_mfma_f32_16x16x32_bf16 v[124:127], a[192:195], v[36:39], v[124:127]
    ds_read_b128 v[48:51], v1 offset:43008
    s_mov_b32 s54, 546304
    v_mfma_f32_16x16x32_bf16 v[136:139], a[192:195], v[40:43], v[136:139]
    ds_read_b128 v[52:55], v1 offset:45056
    v_mfma_f32_16x16x32_bf16 v[24:27], a[248:251], a[240:243], 0
    ds_read_b128 v[56:59], v1 offset:47104
    v_mfma_f32_16x16x32_bf16 v[148:151], a[192:195], v[44:47], v[148:151]
    ds_read_b128 v[60:63], v14 offset:49152
    v_mfma_f32_16x16x32_bf16 v[28:31], a[248:251], a[244:247], 0
    buffer_load_dwordx4 a[192:195], v6, s[16:19], s54 offen offset:0
    v_mfma_f32_16x16x32_bf16 v[116:119], a[196:199], v[32:35], v[116:119]
    ds_read_b64_tr_b16 a[252:253], v4 offset:12800
    v_mfma_f32_16x16x32_bf16 v[128:131], a[196:199], v[36:39], v[128:131]
    ds_read_b64_tr_b16 a[254:255], v4 offset:16000
    v_cvt_pk_bf16_f32 v24, v24, v25
    v_mfma_f32_16x16x32_bf16 v[140:143], a[196:199], v[40:43], v[140:143]
    v_cvt_pk_bf16_f32 v25, v26, v27
    v_cvt_pk_bf16_f32 v28, v28, v29
    v_mfma_f32_16x16x32_bf16 v[152:155], a[196:199], v[44:47], v[152:155]
    ds_write_b64 v3, v[24:25] offset:0
    v_mfma_f32_16x16x32_bf16 v[120:123], a[200:203], v[32:35], v[120:123]
    v_cvt_pk_bf16_f32 v29, v30, v31
    v_mfma_f32_16x16x32_bf16 v[132:135], a[200:203], v[36:39], v[132:135]
    buffer_load_dwordx4 a[196:199], v6, s[16:19], s54 offen offset:1024
    v_mfma_f32_16x16x32_bf16 v[144:147], a[200:203], v[40:43], v[144:147]
    ds_write_b64 v3, v[28:29] offset:14336
    v_mfma_f32_16x16x32_bf16 v[156:159], a[200:203], v[44:47], v[156:159]
    s_waitcnt vmcnt(8) lgkmcnt(2)
    v_mfma_f32_16x16x32_bf16 v[160:163], a[204:207], v[48:51], v[160:163]
    buffer_load_dwordx4 a[200:203], v6, s[16:19], s54 offen offset:2048
    v_mfma_f32_16x16x32_bf16 v[172:175], a[204:207], v[52:55], v[172:175]
    ds_read_b128 v[32:35], v2 offset:35840
    s_mov_b32 s54, 558720
    v_mfma_f32_16x16x32_bf16 v[184:187], a[204:207], v[56:59], v[184:187]
    ds_read_b128 v[36:39], v2 offset:37888
    v_mfma_f32_16x16x32_bf16 v[24:27], a[252:255], a[240:243], 0
    ds_read_b128 v[40:43], v2 offset:39936
    v_mfma_f32_16x16x32_bf16 v[196:199], a[204:207], v[60:63], v[196:199]
    ds_read_b128 v[44:47], v15 offset:41984
    v_mfma_f32_16x16x32_bf16 v[28:31], a[252:255], a[244:247], 0
    buffer_load_dwordx4 a[204:207], v6, s[16:19], s54 offen offset:0
    v_mfma_f32_16x16x32_bf16 v[164:167], a[208:211], v[48:51], v[164:167]
    ds_read_b64_tr_b16 a[248:249], v4 offset:25600
    v_mfma_f32_16x16x32_bf16 v[176:179], a[208:211], v[52:55], v[176:179]
    ds_read_b64_tr_b16 a[250:251], v4 offset:28800
    v_cvt_pk_bf16_f32 v24, v24, v25
    v_mfma_f32_16x16x32_bf16 v[188:191], a[208:211], v[56:59], v[188:191]
    v_cvt_pk_bf16_f32 v25, v26, v27
    v_cvt_pk_bf16_f32 v28, v28, v29
    v_mfma_f32_16x16x32_bf16 v[200:203], a[208:211], v[60:63], v[200:203]
    ds_write_b64 v3, v[24:25] offset:1024
    v_mfma_f32_16x16x32_bf16 v[168:171], a[212:215], v[48:51], v[168:171]
    v_cvt_pk_bf16_f32 v29, v30, v31
    v_mfma_f32_16x16x32_bf16 v[180:183], a[212:215], v[52:55], v[180:183]
    buffer_load_dwordx4 a[208:211], v6, s[16:19], s54 offen offset:1024
    v_mfma_f32_16x16x32_bf16 v[192:195], a[212:215], v[56:59], v[192:195]
    ds_write_b64 v3, v[28:29] offset:15360
    v_mfma_f32_16x16x32_bf16 v[204:207], a[212:215], v[60:63], v[204:207]
    s_waitcnt vmcnt(8) lgkmcnt(2)
    v_mfma_f32_16x16x32_bf16 v[112:115], a[216:219], v[32:35], v[112:115]
    buffer_load_dwordx4 a[212:215], v6, s[16:19], s54 offen offset:2048
    v_mfma_f32_16x16x32_bf16 v[124:127], a[216:219], v[36:39], v[124:127]
    ds_read_b128 v[48:51], v2 offset:43008
    s_mov_b32 s54, 571136
    v_mfma_f32_16x16x32_bf16 v[136:139], a[216:219], v[40:43], v[136:139]
    ds_read_b128 v[52:55], v2 offset:45056
    v_mfma_f32_16x16x32_bf16 v[24:27], a[248:251], a[240:243], 0
    ds_read_b128 v[56:59], v2 offset:47104
    v_mfma_f32_16x16x32_bf16 v[148:151], a[216:219], v[44:47], v[148:151]
    ds_read_b128 v[60:63], v15 offset:49152
    v_mfma_f32_16x16x32_bf16 v[28:31], a[248:251], a[244:247], 0
    buffer_load_dwordx4 a[216:219], v6, s[16:19], s54 offen offset:0
    v_mfma_f32_16x16x32_bf16 v[116:119], a[220:223], v[32:35], v[116:119]
    ds_read_b64_tr_b16 a[252:253], v4 offset:38400
    v_mfma_f32_16x16x32_bf16 v[128:131], a[220:223], v[36:39], v[128:131]
    ds_read_b64_tr_b16 a[254:255], v4 offset:41600
    v_cvt_pk_bf16_f32 v24, v24, v25
    v_mfma_f32_16x16x32_bf16 v[140:143], a[220:223], v[40:43], v[140:143]
    v_cvt_pk_bf16_f32 v25, v26, v27
    v_cvt_pk_bf16_f32 v28, v28, v29
    v_mfma_f32_16x16x32_bf16 v[152:155], a[220:223], v[44:47], v[152:155]
    ds_write_b64 v3, v[24:25] offset:2048
    v_mfma_f32_16x16x32_bf16 v[120:123], a[224:227], v[32:35], v[120:123]
    v_cvt_pk_bf16_f32 v29, v30, v31
    v_mfma_f32_16x16x32_bf16 v[132:135], a[224:227], v[36:39], v[132:135]
    buffer_load_dwordx4 a[220:223], v6, s[16:19], s54 offen offset:1024
    v_mfma_f32_16x16x32_bf16 v[144:147], a[224:227], v[40:43], v[144:147]
    ds_write_b64 v3, v[28:29] offset:16384
    v_mfma_f32_16x16x32_bf16 v[156:159], a[224:227], v[44:47], v[156:159]
    s_waitcnt vmcnt(8) lgkmcnt(2)
    v_mfma_f32_16x16x32_bf16 v[160:163], a[228:231], v[48:51], v[160:163]
    buffer_load_dwordx4 a[224:227], v6, s[16:19], s54 offen offset:2048
    v_mfma_f32_16x16x32_bf16 v[172:175], a[228:231], v[52:55], v[172:175]
    ds_read_b128 v[32:35], v1 offset:28672
    s_mov_b32 s54, 583552
    v_mfma_f32_16x16x32_bf16 v[184:187], a[228:231], v[56:59], v[184:187]
    ds_read_b128 v[36:39], v1 offset:30720
    v_mfma_f32_16x16x32_bf16 v[24:27], a[252:255], a[240:243], 0
    ds_read_b128 v[40:43], v1 offset:32768
    v_mfma_f32_16x16x32_bf16 v[196:199], a[228:231], v[60:63], v[196:199]
    ds_read_b128 v[44:47], v14 offset:34816
    v_mfma_f32_16x16x32_bf16 v[28:31], a[252:255], a[244:247], 0
    buffer_load_dwordx4 a[228:231], v6, s[16:19], s54 offen offset:0
    v_mfma_f32_16x16x32_bf16 v[164:167], a[232:235], v[48:51], v[164:167]
    ds_read_b64_tr_b16 a[248:249], v5 offset:0
    v_mfma_f32_16x16x32_bf16 v[176:179], a[232:235], v[52:55], v[176:179]
    ds_read_b64_tr_b16 a[250:251], v5 offset:3200
    v_cvt_pk_bf16_f32 v24, v24, v25
    v_mfma_f32_16x16x32_bf16 v[188:191], a[232:235], v[56:59], v[188:191]
    v_cvt_pk_bf16_f32 v25, v26, v27
    v_cvt_pk_bf16_f32 v28, v28, v29
    v_mfma_f32_16x16x32_bf16 v[200:203], a[232:235], v[60:63], v[200:203]
    ds_write_b64 v3, v[24:25] offset:3072
    v_mfma_f32_16x16x32_bf16 v[168:171], a[236:239], v[48:51], v[168:171]
    v_cvt_pk_bf16_f32 v29, v30, v31
    v_mfma_f32_16x16x32_bf16 v[180:183], a[236:239], v[52:55], v[180:183]
    buffer_load_dwordx4 a[232:235], v6, s[16:19], s54 offen offset:1024
    v_mfma_f32_16x16x32_bf16 v[192:195], a[236:239], v[56:59], v[192:195]
    ds_write_b64 v3, v[28:29] offset:17408
    v_mfma_f32_16x16x32_bf16 v[204:207], a[236:239], v[60:63], v[204:207]
    v_pk_add_f32 v[64:65], v[64:65], v[112:113]
    v_pk_add_f32 v[66:67], v[66:67], v[114:115]
    v_pk_add_f32 v[76:77], v[76:77], v[124:125]
    v_pk_add_f32 v[78:79], v[78:79], v[126:127]
    v_pk_add_f32 v[88:89], v[88:89], v[136:137]
    v_pk_add_f32 v[90:91], v[90:91], v[138:139]
    v_pk_add_f32 v[100:101], v[100:101], v[148:149]
    v_pk_add_f32 v[102:103], v[102:103], v[150:151]
    v_pk_add_f32 v[68:69], v[68:69], v[116:117]
    v_pk_add_f32 v[70:71], v[70:71], v[118:119]
    v_pk_add_f32 v[80:81], v[80:81], v[128:129]
    v_pk_add_f32 v[82:83], v[82:83], v[130:131]
    v_pk_add_f32 v[92:93], v[92:93], v[140:141]
    v_pk_add_f32 v[94:95], v[94:95], v[142:143]
    v_pk_add_f32 v[104:105], v[104:105], v[152:153]
    v_pk_add_f32 v[106:107], v[106:107], v[154:155]
    v_pk_add_f32 v[72:73], v[72:73], v[120:121]
    v_pk_add_f32 v[74:75], v[74:75], v[122:123]
    v_pk_add_f32 v[84:85], v[84:85], v[132:133]
    v_pk_add_f32 v[86:87], v[86:87], v[134:135]
    v_pk_add_f32 v[96:97], v[96:97], v[144:145]
    v_pk_add_f32 v[98:99], v[98:99], v[146:147]
    v_pk_add_f32 v[108:109], v[108:109], v[156:157]
    v_pk_add_f32 v[110:111], v[110:111], v[158:159]
    v_pk_add_f32 v[208:209], v[208:209], v[112:113] neg_lo:[0,1] neg_hi:[0,1]
    v_pk_add_f32 v[210:211], v[210:211], v[114:115] neg_lo:[0,1] neg_hi:[0,1]
    v_pk_add_f32 v[220:221], v[220:221], v[124:125] neg_lo:[0,1] neg_hi:[0,1]
    v_pk_add_f32 v[222:223], v[222:223], v[126:127] neg_lo:[0,1] neg_hi:[0,1]
    v_pk_add_f32 v[232:233], v[232:233], v[136:137] neg_lo:[0,1] neg_hi:[0,1]
    v_pk_add_f32 v[234:235], v[234:235], v[138:139] neg_lo:[0,1] neg_hi:[0,1]
    v_pk_add_f32 v[244:245], v[244:245], v[148:149] neg_lo:[0,1] neg_hi:[0,1]
    v_pk_add_f32 v[246:247], v[246:247], v[150:151] neg_lo:[0,1] neg_hi:[0,1]
    v_pk_add_f32 v[212:213], v[212:213], v[116:117] neg_lo:[0,1] neg_hi:[0,1]
    v_pk_add_f32 v[214:215], v[214:215], v[118:119] neg_lo:[0,1] neg_hi:[0,1]
    v_pk_add_f32 v[224:225], v[224:225], v[128:129] neg_lo:[0,1] neg_hi:[0,1]
    v_pk_add_f32 v[226:227], v[226:227], v[130:131] neg_lo:[0,1] neg_hi:[0,1]
    v_pk_add_f32 v[236:237], v[236:237], v[140:141] neg_lo:[0,1] neg_hi:[0,1]
    v_pk_add_f32 v[238:239], v[238:239], v[142:143] neg_lo:[0,1] neg_hi:[0,1]
    v_pk_add_f32 v[248:249], v[248:249], v[152:153] neg_lo:[0,1] neg_hi:[0,1]
    v_pk_add_f32 v[250:251], v[250:251], v[154:155] neg_lo:[0,1] neg_hi:[0,1]
    v_pk_add_f32 v[216:217], v[216:217], v[120:121] neg_lo:[0,1] neg_hi:[0,1]
    v_pk_add_f32 v[218:219], v[218:219], v[122:123] neg_lo:[0,1] neg_hi:[0,1]
    v_pk_add_f32 v[228:229], v[228:229], v[132:133] neg_lo:[0,1] neg_hi:[0,1]
    v_pk_add_f32 v[230:231], v[230:231], v[134:135] neg_lo:[0,1] neg_hi:[0,1]
    v_pk_add_f32 v[240:241], v[240:241], v[144:145] neg_lo:[0,1] neg_hi:[0,1]
    v_pk_add_f32 v[242:243], v[242:243], v[146:147] neg_lo:[0,1] neg_hi:[0,1]
    v_pk_add_f32 v[252:253], v[252:253], v[156:157] neg_lo:[0,1] neg_hi:[0,1]
    v_pk_add_f32 v[254:255], v[254:255], v[158:159] neg_lo:[0,1] neg_hi:[0,1]
    v_pk_add_f32 v[64:65], v[64:65], v[160:161]
    v_pk_add_f32 v[66:67], v[66:67], v[162:163]
    v_pk_add_f32 v[76:77], v[76:77], v[172:173]
    v_pk_add_f32 v[78:79], v[78:79], v[174:175]
    v_pk_add_f32 v[88:89], v[88:89], v[184:185]
    v_pk_add_f32 v[90:91], v[90:91], v[186:187]
    v_pk_add_f32 v[100:101], v[100:101], v[196:197]
    v_pk_add_f32 v[102:103], v[102:103], v[198:199]
    v_pk_add_f32 v[68:69], v[68:69], v[164:165]
    v_pk_add_f32 v[70:71], v[70:71], v[166:167]
    v_pk_add_f32 v[80:81], v[80:81], v[176:177]
    v_pk_add_f32 v[82:83], v[82:83], v[178:179]
    v_pk_add_f32 v[92:93], v[92:93], v[188:189]
    v_pk_add_f32 v[94:95], v[94:95], v[190:191]
    v_pk_add_f32 v[104:105], v[104:105], v[200:201]
    v_pk_add_f32 v[106:107], v[106:107], v[202:203]
    v_pk_add_f32 v[72:73], v[72:73], v[168:169]
    v_pk_add_f32 v[74:75], v[74:75], v[170:171]
    v_pk_add_f32 v[84:85], v[84:85], v[180:181]
    v_pk_add_f32 v[86:87], v[86:87], v[182:183]
    v_pk_add_f32 v[96:97], v[96:97], v[192:193]
    v_pk_add_f32 v[98:99], v[98:99], v[194:195]
    v_pk_add_f32 v[108:109], v[108:109], v[204:205]
    v_pk_add_f32 v[110:111], v[110:111], v[206:207]
    v_pk_add_f32 v[208:209], v[208:209], v[160:161]
    v_pk_add_f32 v[210:211], v[210:211], v[162:163]
    v_pk_add_f32 v[220:221], v[220:221], v[172:173]
    v_pk_add_f32 v[222:223], v[222:223], v[174:175]
    v_pk_add_f32 v[232:233], v[232:233], v[184:185]
    v_pk_add_f32 v[234:235], v[234:235], v[186:187]
    v_pk_add_f32 v[244:245], v[244:245], v[196:197]
    v_pk_add_f32 v[246:247], v[246:247], v[198:199]
    v_pk_add_f32 v[212:213], v[212:213], v[164:165]
    v_pk_add_f32 v[214:215], v[214:215], v[166:167]
    v_pk_add_f32 v[224:225], v[224:225], v[176:177]
    v_pk_add_f32 v[226:227], v[226:227], v[178:179]
    v_pk_add_f32 v[236:237], v[236:237], v[188:189]
    v_pk_add_f32 v[238:239], v[238:239], v[190:191]
    v_pk_add_f32 v[248:249], v[248:249], v[200:201]
    v_pk_add_f32 v[250:251], v[250:251], v[202:203]
    v_pk_add_f32 v[216:217], v[216:217], v[168:169]
    v_pk_add_f32 v[218:219], v[218:219], v[170:171]
    v_pk_add_f32 v[228:229], v[228:229], v[180:181]
    v_pk_add_f32 v[230:231], v[230:231], v[182:183]
    v_pk_add_f32 v[240:241], v[240:241], v[192:193]
    v_pk_add_f32 v[242:243], v[242:243], v[194:195]
    v_pk_add_f32 v[252:253], v[252:253], v[204:205]
    v_pk_add_f32 v[254:255], v[254:255], v[206:207]
    s_nop 0
    s_waitcnt vmcnt(8) lgkmcnt(2)
    v_mfma_f32_16x16x32_bf16 v[64:67], a[192:195], v[32:35], v[64:67]
    buffer_load_dwordx4 a[236:239], v6, s[16:19], s54 offen offset:2048
    v_mfma_f32_16x16x32_bf16 v[76:79], a[192:195], v[36:39], v[76:79]
    ds_read_b128 v[48:51], v1 offset:50176
    s_mov_b32 s54, 595968
    v_mfma_f32_16x16x32_bf16 v[88:91], a[192:195], v[40:43], v[88:91]
    ds_read_b128 v[52:55], v1 offset:52224
    v_mfma_f32_16x16x32_bf16 v[24:27], a[248:251], a[240:243], 0
    ds_read_b128 v[56:59], v1 offset:54272
    v_mfma_f32_16x16x32_bf16 v[100:103], a[192:195], v[44:47], v[100:103]
    ds_read_b128 v[60:63], v14 offset:56320
    v_mfma_f32_16x16x32_bf16 v[28:31], a[248:251], a[244:247], 0
    buffer_load_dwordx4 a[192:195], v6, s[16:19], s54 offen offset:0
    v_mfma_f32_16x16x32_bf16 v[68:71], a[196:199], v[32:35], v[68:71]
    ds_read_b64_tr_b16 a[252:253], v5 offset:12800
    v_mfma_f32_16x16x32_bf16 v[80:83], a[196:199], v[36:39], v[80:83]
    ds_read_b64_tr_b16 a[254:255], v5 offset:16000
    v_cvt_pk_bf16_f32 v24, v24, v25
    v_mfma_f32_16x16x32_bf16 v[92:95], a[196:199], v[40:43], v[92:95]
    v_cvt_pk_bf16_f32 v25, v26, v27
    v_cvt_pk_bf16_f32 v28, v28, v29
    v_mfma_f32_16x16x32_bf16 v[104:107], a[196:199], v[44:47], v[104:107]
    ds_write_b64 v3, v[24:25] offset:4096
    v_mfma_f32_16x16x32_bf16 v[72:75], a[200:203], v[32:35], v[72:75]
    v_cvt_pk_bf16_f32 v29, v30, v31
    v_mfma_f32_16x16x32_bf16 v[84:87], a[200:203], v[36:39], v[84:87]
    buffer_load_dwordx4 a[196:199], v6, s[16:19], s54 offen offset:1024
    v_mfma_f32_16x16x32_bf16 v[96:99], a[200:203], v[40:43], v[96:99]
    ds_write_b64 v3, v[28:29] offset:18432
    v_mfma_f32_16x16x32_bf16 v[108:111], a[200:203], v[44:47], v[108:111]
    s_waitcnt vmcnt(8) lgkmcnt(2)
    v_mfma_f32_16x16x32_bf16 v[208:211], a[204:207], v[48:51], v[208:211]
    buffer_load_dwordx4 a[200:203], v6, s[16:19], s54 offen offset:2048
    v_mfma_f32_16x16x32_bf16 v[220:223], a[204:207], v[52:55], v[220:223]
    ds_read_b128 v[32:35], v2 offset:28672
    s_mov_b32 s54, 608384
    v_mfma_f32_16x16x32_bf16 v[232:235], a[204:207], v[56:59], v[232:235]
    ds_read_b128 v[36:39], v2 offset:30720
    v_mfma_f32_16x16x32_bf16 v[24:27], a[252:255], a[240:243], 0
    ds_read_b128 v[40:43], v2 offset:32768
    v_mfma_f32_16x16x32_bf16 v[244:247], a[204:207], v[60:63], v[244:247]
    ds_read_b128 v[44:47], v15 offset:34816
    v_mfma_f32_16x16x32_bf16 v[28:31], a[252:255], a[244:247], 0
    buffer_load_dwordx4 a[204:207], v6, s[16:19], s54 offen offset:0
    v_mfma_f32_16x16x32_bf16 v[212:215], a[208:211], v[48:51], v[212:215]
    ds_read_b64_tr_b16 a[248:249], v5 offset:25600
    v_mfma_f32_16x16x32_bf16 v[224:227], a[208:211], v[52:55], v[224:227]
    ds_read_b64_tr_b16 a[250:251], v5 offset:28800
    v_cvt_pk_bf16_f32 v24, v24, v25
    v_mfma_f32_16x16x32_bf16 v[236:239], a[208:211], v[56:59], v[236:239]
    v_cvt_pk_bf16_f32 v25, v26, v27
    v_cvt_pk_bf16_f32 v28, v28, v29
    v_mfma_f32_16x16x32_bf16 v[248:251], a[208:211], v[60:63], v[248:251]
    ds_write_b64 v3, v[24:25] offset:5120
    v_mfma_f32_16x16x32_bf16 v[216:219], a[212:215], v[48:51], v[216:219]
    v_cvt_pk_bf16_f32 v29, v30, v31
    v_mfma_f32_16x16x32_bf16 v[228:231], a[212:215], v[52:55], v[228:231]
    buffer_load_dwordx4 a[208:211], v6, s[16:19], s54 offen offset:1024
    v_mfma_f32_16x16x32_bf16 v[240:243], a[212:215], v[56:59], v[240:243]
    ds_write_b64 v3, v[28:29] offset:19456
    v_mfma_f32_16x16x32_bf16 v[252:255], a[212:215], v[60:63], v[252:255]
    s_waitcnt vmcnt(8) lgkmcnt(2)
    v_mfma_f32_16x16x32_bf16 v[64:67], a[216:219], v[32:35], v[64:67]
    buffer_load_dwordx4 a[212:215], v6, s[16:19], s54 offen offset:2048
    v_mfma_f32_16x16x32_bf16 v[76:79], a[216:219], v[36:39], v[76:79]
    ds_read_b128 v[48:51], v2 offset:50176
    s_mov_b32 s54, 620800
    v_mfma_f32_16x16x32_bf16 v[88:91], a[216:219], v[40:43], v[88:91]
    ds_read_b128 v[52:55], v2 offset:52224
    v_mfma_f32_16x16x32_bf16 v[24:27], a[248:251], a[240:243], 0
    ds_read_b128 v[56:59], v2 offset:54272
    v_mfma_f32_16x16x32_bf16 v[100:103], a[216:219], v[44:47], v[100:103]
    ds_read_b128 v[60:63], v15 offset:56320
    v_mfma_f32_16x16x32_bf16 v[28:31], a[248:251], a[244:247], 0
    buffer_load_dwordx4 a[216:219], v6, s[16:19], s54 offen offset:0
    v_mfma_f32_16x16x32_bf16 v[68:71], a[220:223], v[32:35], v[68:71]
    s_nop 0
    v_mfma_f32_16x16x32_bf16 v[80:83], a[220:223], v[36:39], v[80:83]
    s_nop 0
    v_cvt_pk_bf16_f32 v24, v24, v25
    v_mfma_f32_16x16x32_bf16 v[92:95], a[220:223], v[40:43], v[92:95]
    v_cvt_pk_bf16_f32 v25, v26, v27
    v_cvt_pk_bf16_f32 v28, v28, v29
    v_mfma_f32_16x16x32_bf16 v[104:107], a[220:223], v[44:47], v[104:107]
    ds_write_b64 v3, v[24:25] offset:6144
    v_mfma_f32_16x16x32_bf16 v[72:75], a[224:227], v[32:35], v[72:75]
    v_cvt_pk_bf16_f32 v29, v30, v31
    v_mfma_f32_16x16x32_bf16 v[84:87], a[224:227], v[36:39], v[84:87]
    buffer_load_dwordx4 a[220:223], v6, s[16:19], s54 offen offset:1024
    v_mfma_f32_16x16x32_bf16 v[96:99], a[224:227], v[40:43], v[96:99]
    ds_write_b64 v3, v[28:29] offset:20480
    v_mfma_f32_16x16x32_bf16 v[108:111], a[224:227], v[44:47], v[108:111]
    s_waitcnt vmcnt(8) lgkmcnt(2)
    v_mfma_f32_16x16x32_bf16 v[208:211], a[228:231], v[48:51], v[208:211]
    buffer_load_dwordx4 a[224:227], v6, s[16:19], s54 offen offset:2048
    v_accvgpr_read_b32 v16, a0
    v_accvgpr_read_b32 v17, a1
    v_accvgpr_read_b32 v18, a2
    v_accvgpr_read_b32 v19, a3
    v_mfma_f32_16x16x32_bf16 v[220:223], a[228:231], v[52:55], v[220:223]
    s_mov_b32 s54, 633216
    v_accvgpr_read_b32 v20, a12
    v_accvgpr_read_b32 v21, a13
    v_accvgpr_read_b32 v22, a14
    v_accvgpr_read_b32 v23, a15
    v_mfma_f32_16x16x32_bf16 v[232:235], a[228:231], v[56:59], v[232:235]
    s_waitcnt lgkmcnt(0)
    s_barrier
    v_fma_f32 v16, v16, 2.0, -v64
    v_fma_f32 v17, v17, 2.0, -v65
    v_fma_f32 v18, v18, 2.0, -v66
    v_fma_f32 v19, v19, 2.0, -v67
    v_mfma_f32_16x16x32_bf16 v[244:247], a[228:231], v[60:63], v[244:247]
    buffer_load_dwordx4 a[228:231], v6, s[16:19], s54 offen offset:0
    v_accvgpr_write_b32 a0, v16
    v_accvgpr_write_b32 a1, v17
    v_accvgpr_write_b32 a2, v18
    v_accvgpr_write_b32 a3, v19
    v_mfma_f32_16x16x32_bf16 v[212:215], a[232:235], v[48:51], v[212:215]
    ds_read_b128 v[32:35], v1 offset:7168
    v_accvgpr_read_b32 v16, a24
    v_accvgpr_read_b32 v17, a25
    v_accvgpr_read_b32 v18, a26
    v_accvgpr_read_b32 v19, a27
    v_mfma_f32_16x16x32_bf16 v[224:227], a[232:235], v[52:55], v[224:227]
    ds_read_b128 v[36:39], v1 offset:9216
    v_fma_f32 v20, v20, 2.0, -v76
    v_fma_f32 v21, v21, 2.0, -v77
    v_fma_f32 v22, v22, 2.0, -v78
    v_fma_f32 v23, v23, 2.0, -v79
    v_mfma_f32_16x16x32_bf16 v[236:239], a[232:235], v[56:59], v[236:239]
    ds_read_b128 v[40:43], v1 offset:11264
    v_accvgpr_write_b32 a12, v20
    v_accvgpr_write_b32 a13, v21
    v_accvgpr_write_b32 a14, v22
    v_accvgpr_write_b32 a15, v23
    v_mfma_f32_16x16x32_bf16 v[248:251], a[232:235], v[60:63], v[248:251]
    ds_read_b128 v[44:47], v14 offset:13312
    v_accvgpr_read_b32 v20, a36
    v_accvgpr_read_b32 v21, a37
    v_accvgpr_read_b32 v22, a38
    v_accvgpr_read_b32 v23, a39
    v_mfma_f32_16x16x32_bf16 v[216:219], a[236:239], v[48:51], v[216:219]
    buffer_load_dwordx4 a[232:235], v6, s[16:19], s54 offen offset:1024
    v_fma_f32 v16, v16, 2.0, -v88
    v_fma_f32 v17, v17, 2.0, -v89
    v_fma_f32 v18, v18, 2.0, -v90
    v_fma_f32 v19, v19, 2.0, -v91
    v_mfma_f32_16x16x32_bf16 v[228:231], a[236:239], v[52:55], v[228:231]
    ds_read_b64_tr_b16 a[248:249], v4 offset:128
    v_accvgpr_write_b32 a24, v16
    v_accvgpr_write_b32 a25, v17
    v_accvgpr_write_b32 a26, v18
    v_accvgpr_write_b32 a27, v19
    v_mfma_f32_16x16x32_bf16 v[240:243], a[236:239], v[56:59], v[240:243]
    ds_read_b64_tr_b16 a[250:251], v4 offset:3328
    v_accvgpr_read_b32 v16, a4
    v_accvgpr_read_b32 v17, a5
    v_accvgpr_read_b32 v18, a6
    v_accvgpr_read_b32 v19, a7
    v_mfma_f32_16x16x32_bf16 v[252:255], a[236:239], v[60:63], v[252:255]
    v_fma_f32 v20, v20, 2.0, -v100
    v_fma_f32 v21, v21, 2.0, -v101
    v_fma_f32 v22, v22, 2.0, -v102
    v_fma_f32 v23, v23, 2.0, -v103
    s_waitcnt vmcnt(8) lgkmcnt(0)
    v_mfma_f32_16x16x32_bf16 v[112:115], a[192:195], v[32:35], 0
    buffer_load_dwordx4 a[236:239], v6, s[16:19], s54 offen offset:2048
    v_accvgpr_write_b32 a36, v20
    v_accvgpr_write_b32 a37, v21
    v_accvgpr_write_b32 a38, v22
    v_accvgpr_write_b32 a39, v23
    v_mfma_f32_16x16x32_bf16 v[124:127], a[192:195], v[36:39], 0
    ds_read_b128 v[48:51], v1 offset:14336
    s_mov_b32 s54, 645632
    v_accvgpr_read_b32 v20, a16
    v_accvgpr_read_b32 v21, a17
    v_accvgpr_read_b32 v22, a18
    v_accvgpr_read_b32 v23, a19
    v_mfma_f32_16x16x32_bf16 v[136:139], a[192:195], v[40:43], 0
    ds_read_b128 v[52:55], v1 offset:16384
    v_fma_f32 v16, v16, 2.0, -v68
    v_fma_f32 v17, v17, 2.0, -v69
    v_fma_f32 v18, v18, 2.0, -v70
    v_fma_f32 v19, v19, 2.0, -v71
    v_mfma_f32_16x16x32_bf16 v[24:27], a[248:251], a[240:243], 0
    ds_read_b128 v[56:59], v1 offset:18432
    v_accvgpr_write_b32 a4, v16
    v_accvgpr_write_b32 a5, v17
    v_accvgpr_write_b32 a6, v18
    v_accvgpr_write_b32 a7, v19
    v_mfma_f32_16x16x32_bf16 v[148:151], a[192:195], v[44:47], 0
    ds_read_b128 v[60:63], v14 offset:20480
    v_accvgpr_read_b32 v16, a28
    v_accvgpr_read_b32 v17, a29
    v_accvgpr_read_b32 v18, a30
    v_accvgpr_read_b32 v19, a31
    v_mfma_f32_16x16x32_bf16 v[28:31], a[248:251], a[244:247], 0
    buffer_load_dwordx4 a[192:195], v6, s[16:19], s54 offen offset:0
    v_fma_f32 v20, v20, 2.0, -v80
    v_fma_f32 v21, v21, 2.0, -v81
    v_fma_f32 v22, v22, 2.0, -v82
    v_fma_f32 v23, v23, 2.0, -v83
    v_mfma_f32_16x16x32_bf16 v[116:119], a[196:199], v[32:35], 0
    ds_read_b64_tr_b16 a[252:253], v4 offset:12928
    v_accvgpr_write_b32 a16, v20
    v_accvgpr_write_b32 a17, v21
    v_accvgpr_write_b32 a18, v22
    v_mfma_f32_16x16x32_bf16 v[128:131], a[196:199], v[36:39], 0
    ds_read_b64_tr_b16 a[254:255], v4 offset:16128
    v_cvt_pk_bf16_f32 v24, v24, v25
    v_accvgpr_write_b32 a19, v23
    v_accvgpr_read_b32 v20, a40
    v_accvgpr_read_b32 v21, a41
    v_mfma_f32_16x16x32_bf16 v[140:143], a[196:199], v[40:43], 0
    v_cvt_pk_bf16_f32 v25, v26, v27
    v_cvt_pk_bf16_f32 v28, v28, v29
    v_accvgpr_read_b32 v22, a42
    v_accvgpr_read_b32 v23, a43
    v_fma_f32 v16, v16, 2.0, -v92
    v_mfma_f32_16x16x32_bf16 v[152:155], a[196:199], v[44:47], 0
    ds_write_b64 v3, v[24:25] offset:28672
    v_fma_f32 v17, v17, 2.0, -v93
    v_fma_f32 v18, v18, 2.0, -v94
    v_fma_f32 v19, v19, 2.0, -v95
    v_mfma_f32_16x16x32_bf16 v[120:123], a[200:203], v[32:35], 0
    v_cvt_pk_bf16_f32 v29, v30, v31
    v_accvgpr_write_b32 a28, v16
    v_accvgpr_write_b32 a29, v17
    v_accvgpr_write_b32 a30, v18
    v_mfma_f32_16x16x32_bf16 v[132:135], a[200:203], v[36:39], 0
    buffer_load_dwordx4 a[196:199], v6, s[16:19], s54 offen offset:1024
    v_accvgpr_write_b32 a31, v19
    v_accvgpr_read_b32 v16, a8
    v_accvgpr_read_b32 v17, a9
    v_mfma_f32_16x16x32_bf16 v[144:147], a[200:203], v[40:43], 0
    ds_write_b64 v3, v[28:29] offset:43008
    v_accvgpr_read_b32 v18, a10
    v_accvgpr_read_b32 v19, a11
    v_fma_f32 v20, v20, 2.0, -v104
    v_mfma_f32_16x16x32_bf16 v[156:159], a[200:203], v[44:47], 0
    v_fma_f32 v21, v21, 2.0, -v105
    v_fma_f32 v22, v22, 2.0, -v106
    v_fma_f32 v23, v23, 2.0, -v107
    s_waitcnt vmcnt(8) lgkmcnt(2)
    v_mfma_f32_16x16x32_bf16 v[160:163], a[204:207], v[48:51], 0
    buffer_load_dwordx4 a[200:203], v6, s[16:19], s54 offen offset:2048
    v_accvgpr_write_b32 a40, v20
    v_accvgpr_write_b32 a41, v21
    v_accvgpr_write_b32 a42, v22
    v_accvgpr_write_b32 a43, v23
    v_mfma_f32_16x16x32_bf16 v[172:175], a[204:207], v[52:55], 0
    ds_read_b128 v[32:35], v2 offset:7168
    s_mov_b32 s54, 658048
    v_accvgpr_read_b32 v20, a20
    v_accvgpr_read_b32 v21, a21
    v_accvgpr_read_b32 v22, a22
    v_accvgpr_read_b32 v23, a23
    v_mfma_f32_16x16x32_bf16 v[184:187], a[204:207], v[56:59], 0
    ds_read_b128 v[36:39], v2 offset:9216
    v_fma_f32 v16, v16, 2.0, -v72
    v_fma_f32 v17, v17, 2.0, -v73
    v_fma_f32 v18, v18, 2.0, -v74
    v_fma_f32 v19, v19, 2.0, -v75
    v_mfma_f32_16x16x32_bf16 v[24:27], a[252:255], a[240:243], 0
    ds_read_b128 v[40:43], v2 offset:11264
    v_accvgpr_write_b32 a8, v16
    v_accvgpr_write_b32 a9, v17
    v_accvgpr_write_b32 a10, v18
    v_accvgpr_write_b32 a11, v19
    v_mfma_f32_16x16x32_bf16 v[196:199], a[204:207], v[60:63], 0
    ds_read_b128 v[44:47], v15 offset:13312
    v_accvgpr_read_b32 v16, a32
    v_accvgpr_read_b32 v17, a33
    v_accvgpr_read_b32 v18, a34
    v_accvgpr_read_b32 v19, a35
    v_mfma_f32_16x16x32_bf16 v[28:31], a[252:255], a[244:247], 0
    buffer_load_dwordx4 a[204:207], v6, s[16:19], s54 offen offset:0
    v_fma_f32 v20, v20, 2.0, -v84
    v_fma_f32 v21, v21, 2.0, -v85
    v_fma_f32 v22, v22, 2.0, -v86
    v_fma_f32 v23, v23, 2.0, -v87
    v_mfma_f32_16x16x32_bf16 v[164:167], a[208:211], v[48:51], 0
    ds_read_b64_tr_b16 a[248:249], v4 offset:25728
    v_accvgpr_write_b32 a20, v20
    v_accvgpr_write_b32 a21, v21
    v_accvgpr_write_b32 a22, v22
    v_mfma_f32_16x16x32_bf16 v[176:179], a[208:211], v[52:55], 0
    ds_read_b64_tr_b16 a[250:251], v4 offset:28928
    v_cvt_pk_bf16_f32 v24, v24, v25
    v_accvgpr_write_b32 a23, v23
    v_accvgpr_read_b32 v20, a44
    v_accvgpr_read_b32 v21, a45
    v_mfma_f32_16x16x32_bf16 v[188:191], a[208:211], v[56:59], 0
    v_cvt_pk_bf16_f32 v25, v26, v27
    v_cvt_pk_bf16_f32 v28, v28, v29
    v_accvgpr_read_b32 v22, a46
    v_accvgpr_read_b32 v23, a47
    v_fma_f32 v16, v16, 2.0, -v96
    v_mfma_f32_16x16x32_bf16 v[200:203], a[208:211], v[60:63], 0
    ds_write_b64 v3, v[24:25] offset:29696
    v_fma_f32 v17, v17, 2.0, -v97
    v_fma_f32 v18, v18, 2.0, -v98
    v_fma_f32 v19, v19, 2.0, -v99
    v_mfma_f32_16x16x32_bf16 v[168:171], a[212:215], v[48:51], 0
    v_cvt_pk_bf16_f32 v29, v30, v31
    v_accvgpr_write_b32 a32, v16
    v_accvgpr_write_b32 a33, v17
    v_accvgpr_write_b32 a34, v18
    v_mfma_f32_16x16x32_bf16 v[180:183], a[212:215], v[52:55], 0
    buffer_load_dwordx4 a[208:211], v6, s[16:19], s54 offen offset:1024
    v_accvgpr_write_b32 a35, v19
    v_fma_f32 v20, v20, 2.0, -v108
    v_fma_f32 v21, v21, 2.0, -v109
    v_mfma_f32_16x16x32_bf16 v[192:195], a[212:215], v[56:59], 0
    ds_write_b64 v3, v[28:29] offset:44032
    v_fma_f32 v22, v22, 2.0, -v110
    v_fma_f32 v23, v23, 2.0, -v111
    v_accvgpr_write_b32 a44, v20
    v_mfma_f32_16x16x32_bf16 v[204:207], a[212:215], v[60:63], 0
    v_accvgpr_write_b32 a45, v21
    v_accvgpr_write_b32 a46, v22
    v_accvgpr_write_b32 a47, v23
    s_waitcnt vmcnt(8) lgkmcnt(2)
    v_mfma_f32_16x16x32_bf16 v[112:115], a[216:219], v[32:35], v[112:115]
    buffer_load_dwordx4 a[212:215], v6, s[16:19], s54 offen offset:2048
    v_accvgpr_read_b32 v16, a48
    v_accvgpr_read_b32 v17, a49
    v_accvgpr_read_b32 v18, a50
    v_accvgpr_read_b32 v19, a51
    v_mfma_f32_16x16x32_bf16 v[124:127], a[216:219], v[36:39], v[124:127]
    ds_read_b128 v[48:51], v2 offset:14336
    s_mov_b32 s54, 670464
    v_accvgpr_read_b32 v20, a60
    v_accvgpr_read_b32 v21, a61
    v_accvgpr_read_b32 v22, a62
    v_accvgpr_read_b32 v23, a63
    v_mfma_f32_16x16x32_bf16 v[136:139], a[216:219], v[40:43], v[136:139]
    ds_read_b128 v[52:55], v2 offset:16384
    v_fma_f32 v16, v16, 2.0, -v208
    v_fma_f32 v17, v17, 2.0, -v209
    v_fma_f32 v18, v18, 2.0, -v210
    v_fma_f32 v19, v19, 2.0, -v211
    v_mfma_f32_16x16x32_bf16 v[24:27], a[248:251], a[240:243], 0
    ds_read_b128 v[56:59], v2 offset:18432
    v_accvgpr_write_b32 a48, v16
    v_accvgpr_write_b32 a49, v17
    v_accvgpr_write_b32 a50, v18
    v_accvgpr_write_b32 a51, v19
    v_mfma_f32_16x16x32_bf16 v[148:151], a[216:219], v[44:47], v[148:151]
    ds_read_b128 v[60:63], v15 offset:20480
    v_accvgpr_read_b32 v16, a72
    v_accvgpr_read_b32 v17, a73
    v_accvgpr_read_b32 v18, a74
    v_accvgpr_read_b32 v19, a75
    v_mfma_f32_16x16x32_bf16 v[28:31], a[248:251], a[244:247], 0
    buffer_load_dwordx4 a[216:219], v6, s[16:19], s54 offen offset:0
    v_fma_f32 v20, v20, 2.0, -v220
    v_fma_f32 v21, v21, 2.0, -v221
    v_fma_f32 v22, v22, 2.0, -v222
    v_fma_f32 v23, v23, 2.0, -v223
    v_mfma_f32_16x16x32_bf16 v[116:119], a[220:223], v[32:35], v[116:119]
    ds_read_b64_tr_b16 a[252:253], v4 offset:38528
    v_accvgpr_write_b32 a60, v20
    v_accvgpr_write_b32 a61, v21
    v_accvgpr_write_b32 a62, v22
    v_mfma_f32_16x16x32_bf16 v[128:131], a[220:223], v[36:39], v[128:131]
    ds_read_b64_tr_b16 a[254:255], v4 offset:41728
    v_cvt_pk_bf16_f32 v24, v24, v25
    v_accvgpr_write_b32 a63, v23
    v_accvgpr_read_b32 v20, a84
    v_accvgpr_read_b32 v21, a85
    v_mfma_f32_16x16x32_bf16 v[140:143], a[220:223], v[40:43], v[140:143]
    v_cvt_pk_bf16_f32 v25, v26, v27
    v_cvt_pk_bf16_f32 v28, v28, v29
    v_accvgpr_read_b32 v22, a86
    v_accvgpr_read_b32 v23, a87
    v_fma_f32 v16, v16, 2.0, -v232
    v_mfma_f32_16x16x32_bf16 v[152:155], a[220:223], v[44:47], v[152:155]
    ds_write_b64 v3, v[24:25] offset:30720
    v_fma_f32 v17, v17, 2.0, -v233
    v_fma_f32 v18, v18, 2.0, -v234
    v_fma_f32 v19, v19, 2.0, -v235
    v_mfma_f32_16x16x32_bf16 v[120:123], a[224:227], v[32:35], v[120:123]
    v_cvt_pk_bf16_f32 v29, v30, v31
    v_accvgpr_write_b32 a72, v16
    v_accvgpr_write_b32 a73, v17
    v_accvgpr_write_b32 a74, v18
    v_mfma_f32_16x16x32_bf16 v[132:135], a[224:227], v[36:39], v[132:135]
    buffer_load_dwordx4 a[220:223], v6, s[16:19], s54 offen offset:1024
    v_accvgpr_write_b32 a75, v19
    v_accvgpr_read_b32 v16, a52
    v_accvgpr_read_b32 v17, a53
    v_mfma_f32_16x16x32_bf16 v[144:147], a[224:227], v[40:43], v[144:147]
    ds_write_b64 v3, v[28:29] offset:45056
    v_accvgpr_read_b32 v18, a54
    v_accvgpr_read_b32 v19, a55
    v_fma_f32 v20, v20, 2.0, -v244
    v_mfma_f32_16x16x32_bf16 v[156:159], a[224:227], v[44:47], v[156:159]
    v_fma_f32 v21, v21, 2.0, -v245
    v_fma_f32 v22, v22, 2.0, -v246
    v_fma_f32 v23, v23, 2.0, -v247
    s_waitcnt vmcnt(8) lgkmcnt(2)
    v_mfma_f32_16x16x32_bf16 v[160:163], a[228:231], v[48:51], v[160:163]
    buffer_load_dwordx4 a[224:227], v6, s[16:19], s54 offen offset:2048
    v_accvgpr_write_b32 a84, v20
    v_accvgpr_write_b32 a85, v21
    v_accvgpr_write_b32 a86, v22
    v_accvgpr_write_b32 a87, v23
    v_mfma_f32_16x16x32_bf16 v[172:175], a[228:231], v[52:55], v[172:175]
    ds_read_b128 v[32:35], v1 offset:0
    s_mov_b32 s54, 682880
    v_accvgpr_read_b32 v20, a64
    v_accvgpr_read_b32 v21, a65
    v_accvgpr_read_b32 v22, a66
    v_accvgpr_read_b32 v23, a67
    v_mfma_f32_16x16x32_bf16 v[184:187], a[228:231], v[56:59], v[184:187]
    ds_read_b128 v[36:39], v1 offset:2048
    v_fma_f32 v16, v16, 2.0, -v212
    v_fma_f32 v17, v17, 2.0, -v213
    v_fma_f32 v18, v18, 2.0, -v214
    v_fma_f32 v19, v19, 2.0, -v215
    v_mfma_f32_16x16x32_bf16 v[24:27], a[252:255], a[240:243], 0
    ds_read_b128 v[40:43], v1 offset:4096
    v_accvgpr_write_b32 a52, v16
    v_accvgpr_write_b32 a53, v17
    v_accvgpr_write_b32 a54, v18
    v_accvgpr_write_b32 a55, v19
    v_mfma_f32_16x16x32_bf16 v[196:199], a[228:231], v[60:63], v[196:199]
    ds_read_b128 v[44:47], v14 offset:6144
    v_accvgpr_read_b32 v16, a76
    v_accvgpr_read_b32 v17, a77
    v_accvgpr_read_b32 v18, a78
    v_accvgpr_read_b32 v19, a79
    v_mfma_f32_16x16x32_bf16 v[28:31], a[252:255], a[244:247], 0
    buffer_load_dwordx4 a[228:231], v6, s[16:19], s54 offen offset:0
    v_fma_f32 v20, v20, 2.0, -v224
    v_fma_f32 v21, v21, 2.0, -v225
    v_fma_f32 v22, v22, 2.0, -v226
    v_fma_f32 v23, v23, 2.0, -v227
    v_mfma_f32_16x16x32_bf16 v[164:167], a[232:235], v[48:51], v[164:167]
    ds_read_b64_tr_b16 a[248:249], v5 offset:128
    v_accvgpr_write_b32 a64, v20
    v_accvgpr_write_b32 a65, v21
    v_accvgpr_write_b32 a66, v22
    v_mfma_f32_16x16x32_bf16 v[176:179], a[232:235], v[52:55], v[176:179]
    ds_read_b64_tr_b16 a[250:251], v5 offset:3328
    v_cvt_pk_bf16_f32 v24, v24, v25
    v_accvgpr_write_b32 a67, v23
    v_accvgpr_read_b32 v20, a88
    v_accvgpr_read_b32 v21, a89
    v_mfma_f32_16x16x32_bf16 v[188:191], a[232:235], v[56:59], v[188:191]
    v_cvt_pk_bf16_f32 v25, v26, v27
    v_cvt_pk_bf16_f32 v28, v28, v29
    v_accvgpr_read_b32 v22, a90
    v_accvgpr_read_b32 v23, a91
    v_fma_f32 v16, v16, 2.0, -v236
    v_mfma_f32_16x16x32_bf16 v[200:203], a[232:235], v[60:63], v[200:203]
    ds_write_b64 v3, v[24:25] offset:31744
    v_fma_f32 v17, v17, 2.0, -v237
    v_fma_f32 v18, v18, 2.0, -v238
    v_fma_f32 v19, v19, 2.0, -v239
    v_mfma_f32_16x16x32_bf16 v[168:171], a[236:239], v[48:51], v[168:171]
    v_cvt_pk_bf16_f32 v29, v30, v31
    v_accvgpr_write_b32 a76, v16
    v_accvgpr_write_b32 a77, v17
    v_accvgpr_write_b32 a78, v18
    v_mfma_f32_16x16x32_bf16 v[180:183], a[236:239], v[52:55], v[180:183]
    buffer_load_dwordx4 a[232:235], v6, s[16:19], s54 offen offset:1024
    v_accvgpr_write_b32 a79, v19
    v_accvgpr_read_b32 v16, a56
    v_accvgpr_read_b32 v17, a57
    v_mfma_f32_16x16x32_bf16 v[192:195], a[236:239], v[56:59], v[192:195]
    ds_write_b64 v3, v[28:29] offset:46080
    v_accvgpr_read_b32 v18, a58
    v_accvgpr_read_b32 v19, a59
    v_fma_f32 v20, v20, 2.0, -v248
    v_mfma_f32_16x16x32_bf16 v[204:207], a[236:239], v[60:63], v[204:207]
    v_fma_f32 v21, v21, 2.0, -v249
    v_fma_f32 v22, v22, 2.0, -v250
    v_fma_f32 v23, v23, 2.0, -v251
    s_waitcnt vmcnt(8) lgkmcnt(2)
    v_mfma_f32_16x16x32_bf16 v[64:67], a[192:195], v[32:35], v[64:67]
    buffer_load_dwordx4 a[236:239], v6, s[16:19], s54 offen offset:2048
    v_accvgpr_write_b32 a88, v20
    v_accvgpr_write_b32 a89, v21
    v_accvgpr_write_b32 a90, v22
    v_accvgpr_write_b32 a91, v23
    v_mfma_f32_16x16x32_bf16 v[76:79], a[192:195], v[36:39], v[76:79]
    ds_read_b128 v[48:51], v1 offset:21504
    s_mov_b32 s54, 695296
    v_accvgpr_read_b32 v20, a68
    v_accvgpr_read_b32 v21, a69
    v_accvgpr_read_b32 v22, a70
    v_accvgpr_read_b32 v23, a71
    v_mfma_f32_16x16x32_bf16 v[88:91], a[192:195], v[40:43], v[88:91]
    ds_read_b128 v[52:55], v1 offset:23552
    v_fma_f32 v16, v16, 2.0, -v216
    v_fma_f32 v17, v17, 2.0, -v217
    v_fma_f32 v18, v18, 2.0, -v218
    v_fma_f32 v19, v19, 2.0, -v219
    v_mfma_f32_16x16x32_bf16 v[24:27], a[248:251], a[240:243], 0
    ds_read_b128 v[56:59], v1 offset:25600
    v_accvgpr_write_b32 a56, v16
    v_accvgpr_write_b32 a57, v17
    v_accvgpr_write_b32 a58, v18
    v_accvgpr_write_b32 a59, v19
    v_mfma_f32_16x16x32_bf16 v[100:103], a[192:195], v[44:47], v[100:103]
    ds_read_b128 v[60:63], v14 offset:27648
    v_accvgpr_read_b32 v16, a80
    v_accvgpr_read_b32 v17, a81
    v_accvgpr_read_b32 v18, a82
    v_accvgpr_read_b32 v19, a83
    v_mfma_f32_16x16x32_bf16 v[28:31], a[248:251], a[244:247], 0
    buffer_load_dwordx4 a[192:195], v6, s[16:19], s54 offen offset:0
    v_fma_f32 v20, v20, 2.0, -v228
    v_fma_f32 v21, v21, 2.0, -v229
    v_fma_f32 v22, v22, 2.0, -v230
    v_fma_f32 v23, v23, 2.0, -v231
    v_mfma_f32_16x16x32_bf16 v[68:71], a[196:199], v[32:35], v[68:71]
    ds_read_b64_tr_b16 a[252:253], v5 offset:12928
    v_accvgpr_write_b32 a68, v20
    v_accvgpr_write_b32 a69, v21
    v_accvgpr_write_b32 a70, v22
    v_mfma_f32_16x16x32_bf16 v[80:83], a[196:199], v[36:39], v[80:83]
    ds_read_b64_tr_b16 a[254:255], v5 offset:16128
    v_cvt_pk_bf16_f32 v24, v24, v25
    v_accvgpr_write_b32 a71, v23
    v_accvgpr_read_b32 v20, a92
    v_accvgpr_read_b32 v21, a93
    v_mfma_f32_16x16x32_bf16 v[92:95], a[196:199], v[40:43], v[92:95]
    v_cvt_pk_bf16_f32 v25, v26, v27
    v_cvt_pk_bf16_f32 v28, v28, v29
    v_accvgpr_read_b32 v22, a94
    v_accvgpr_read_b32 v23, a95
    v_fma_f32 v16, v16, 2.0, -v240
    v_mfma_f32_16x16x32_bf16 v[104:107], a[196:199], v[44:47], v[104:107]
    ds_write_b64 v3, v[24:25] offset:32768
    v_fma_f32 v17, v17, 2.0, -v241
    v_fma_f32 v18, v18, 2.0, -v242
    v_fma_f32 v19, v19, 2.0, -v243
    v_mfma_f32_16x16x32_bf16 v[72:75], a[200:203], v[32:35], v[72:75]
    v_cvt_pk_bf16_f32 v29, v30, v31
    v_accvgpr_write_b32 a80, v16
    v_accvgpr_write_b32 a81, v17
    v_accvgpr_write_b32 a82, v18
    v_mfma_f32_16x16x32_bf16 v[84:87], a[200:203], v[36:39], v[84:87]
    buffer_load_dwordx4 a[196:199], v6, s[16:19], s54 offen offset:1024
    v_accvgpr_write_b32 a83, v19
    v_fma_f32 v20, v20, 2.0, -v252
    v_fma_f32 v21, v21, 2.0, -v253
    v_mfma_f32_16x16x32_bf16 v[96:99], a[200:203], v[40:43], v[96:99]
    ds_write_b64 v3, v[28:29] offset:47104
    v_fma_f32 v22, v22, 2.0, -v254
    v_fma_f32 v23, v23, 2.0, -v255
    v_accvgpr_write_b32 a92, v20
    v_mfma_f32_16x16x32_bf16 v[108:111], a[200:203], v[44:47], v[108:111]
    v_accvgpr_write_b32 a93, v21
    v_accvgpr_write_b32 a94, v22
    v_accvgpr_write_b32 a95, v23
    s_waitcnt vmcnt(8) lgkmcnt(2)
    v_mfma_f32_16x16x32_bf16 v[208:211], a[204:207], v[48:51], v[208:211]
    buffer_load_dwordx4 a[200:203], v6, s[16:19], s54 offen offset:2048
    v_mfma_f32_16x16x32_bf16 v[220:223], a[204:207], v[52:55], v[220:223]
    ds_read_b128 v[32:35], v2 offset:0
    s_mov_b32 s54, 707712
    v_mfma_f32_16x16x32_bf16 v[232:235], a[204:207], v[56:59], v[232:235]
    ds_read_b128 v[36:39], v2 offset:2048
    v_mfma_f32_16x16x32_bf16 v[24:27], a[252:255], a[240:243], 0
    ds_read_b128 v[40:43], v2 offset:4096
    v_mfma_f32_16x16x32_bf16 v[244:247], a[204:207], v[60:63], v[244:247]
    ds_read_b128 v[44:47], v15 offset:6144
    v_mfma_f32_16x16x32_bf16 v[28:31], a[252:255], a[244:247], 0
    buffer_load_dwordx4 a[204:207], v6, s[16:19], s54 offen offset:0
    v_mfma_f32_16x16x32_bf16 v[212:215], a[208:211], v[48:51], v[212:215]
    ds_read_b64_tr_b16 a[248:249], v5 offset:25728
    v_mfma_f32_16x16x32_bf16 v[224:227], a[208:211], v[52:55], v[224:227]
    ds_read_b64_tr_b16 a[250:251], v5 offset:28928
    v_cvt_pk_bf16_f32 v24, v24, v25
    v_mfma_f32_16x16x32_bf16 v[236:239], a[208:211], v[56:59], v[236:239]
    v_cvt_pk_bf16_f32 v25, v26, v27
    v_cvt_pk_bf16_f32 v28, v28, v29
    v_mfma_f32_16x16x32_bf16 v[248:251], a[208:211], v[60:63], v[248:251]
    ds_write_b64 v3, v[24:25] offset:33792
    v_mfma_f32_16x16x32_bf16 v[216:219], a[212:215], v[48:51], v[216:219]
    v_cvt_pk_bf16_f32 v29, v30, v31
    v_mfma_f32_16x16x32_bf16 v[228:231], a[212:215], v[52:55], v[228:231]
    buffer_load_dwordx4 a[208:211], v6, s[16:19], s54 offen offset:1024
    v_mfma_f32_16x16x32_bf16 v[240:243], a[212:215], v[56:59], v[240:243]
    ds_write_b64 v3, v[28:29] offset:48128
    v_mfma_f32_16x16x32_bf16 v[252:255], a[212:215], v[60:63], v[252:255]
    s_waitcnt vmcnt(8) lgkmcnt(2)
    v_mfma_f32_16x16x32_bf16 v[64:67], a[216:219], v[32:35], v[64:67]
    buffer_load_dwordx4 a[212:215], v6, s[16:19], s54 offen offset:2048
    v_mfma_f32_16x16x32_bf16 v[76:79], a[216:219], v[36:39], v[76:79]
    ds_read_b128 v[48:51], v2 offset:21504
    s_mov_b32 s54, 720128
    v_mfma_f32_16x16x32_bf16 v[88:91], a[216:219], v[40:43], v[88:91]
    ds_read_b128 v[52:55], v2 offset:23552
    v_mfma_f32_16x16x32_bf16 v[24:27], a[248:251], a[240:243], 0
    ds_read_b128 v[56:59], v2 offset:25600
    v_mfma_f32_16x16x32_bf16 v[100:103], a[216:219], v[44:47], v[100:103]
    ds_read_b128 v[60:63], v15 offset:27648
    v_mfma_f32_16x16x32_bf16 v[28:31], a[248:251], a[244:247], 0
    buffer_load_dwordx4 a[216:219], v6, s[16:19], s54 offen offset:0
    v_mfma_f32_16x16x32_bf16 v[68:71], a[220:223], v[32:35], v[68:71]
    s_nop 0
    v_mfma_f32_16x16x32_bf16 v[80:83], a[220:223], v[36:39], v[80:83]
    s_nop 0
    v_cvt_pk_bf16_f32 v24, v24, v25
    v_mfma_f32_16x16x32_bf16 v[92:95], a[220:223], v[40:43], v[92:95]
    v_cvt_pk_bf16_f32 v25, v26, v27
    v_cvt_pk_bf16_f32 v28, v28, v29
    v_mfma_f32_16x16x32_bf16 v[104:107], a[220:223], v[44:47], v[104:107]
    ds_write_b64 v3, v[24:25] offset:34816
    v_mfma_f32_16x16x32_bf16 v[72:75], a[224:227], v[32:35], v[72:75]
    v_cvt_pk_bf16_f32 v29, v30, v31
    v_mfma_f32_16x16x32_bf16 v[84:87], a[224:227], v[36:39], v[84:87]
    buffer_load_dwordx4 a[220:223], v6, s[16:19], s54 offen offset:1024
    v_mfma_f32_16x16x32_bf16 v[96:99], a[224:227], v[40:43], v[96:99]
    ds_write_b64 v3, v[28:29] offset:49152
    v_mfma_f32_16x16x32_bf16 v[108:111], a[224:227], v[44:47], v[108:111]
    s_waitcnt vmcnt(8) lgkmcnt(2)
    v_mfma_f32_16x16x32_bf16 v[208:211], a[228:231], v[48:51], v[208:211]
    buffer_load_dwordx4 a[224:227], v6, s[16:19], s54 offen offset:2048
    v_mfma_f32_16x16x32_bf16 v[220:223], a[228:231], v[52:55], v[220:223]
    s_mov_b32 s54, 732544
    v_mfma_f32_16x16x32_bf16 v[232:235], a[228:231], v[56:59], v[232:235]
    s_waitcnt lgkmcnt(0)
    s_barrier
    v_mfma_f32_16x16x32_bf16 v[244:247], a[228:231], v[60:63], v[244:247]
    buffer_load_dwordx4 a[228:231], v6, s[16:19], s54 offen offset:0
    v_mfma_f32_16x16x32_bf16 v[212:215], a[232:235], v[48:51], v[212:215]
    ds_read_b128 v[32:35], v1 offset:35840
    v_mfma_f32_16x16x32_bf16 v[224:227], a[232:235], v[52:55], v[224:227]
    ds_read_b128 v[36:39], v1 offset:37888
    v_mfma_f32_16x16x32_bf16 v[236:239], a[232:235], v[56:59], v[236:239]
    ds_read_b128 v[40:43], v1 offset:39936
    v_mfma_f32_16x16x32_bf16 v[248:251], a[232:235], v[60:63], v[248:251]
    ds_read_b128 v[44:47], v14 offset:41984
    v_mfma_f32_16x16x32_bf16 v[216:219], a[236:239], v[48:51], v[216:219]
    buffer_load_dwordx4 a[232:235], v6, s[16:19], s54 offen offset:1024
    v_mfma_f32_16x16x32_bf16 v[228:231], a[236:239], v[52:55], v[228:231]
    ds_read_b64_tr_b16 a[248:249], v4 offset:256
    v_mfma_f32_16x16x32_bf16 v[240:243], a[236:239], v[56:59], v[240:243]
    ds_read_b64_tr_b16 a[250:251], v4 offset:3456
    v_mfma_f32_16x16x32_bf16 v[252:255], a[236:239], v[60:63], v[252:255]
    s_waitcnt vmcnt(8) lgkmcnt(0)
    v_mfma_f32_16x16x32_bf16 v[112:115], a[192:195], v[32:35], v[112:115]
    buffer_load_dwordx4 a[236:239], v6, s[16:19], s54 offen offset:2048
    v_mfma_f32_16x16x32_bf16 v[124:127], a[192:195], v[36:39], v[124:127]
    ds_read_b128 v[48:51], v1 offset:43008
    s_mov_b32 s54, 744960
    v_mfma_f32_16x16x32_bf16 v[136:139], a[192:195], v[40:43], v[136:139]
    ds_read_b128 v[52:55], v1 offset:45056
    v_mfma_f32_16x16x32_bf16 v[24:27], a[248:251], a[240:243], 0
    ds_read_b128 v[56:59], v1 offset:47104
    v_mfma_f32_16x16x32_bf16 v[148:151], a[192:195], v[44:47], v[148:151]
    ds_read_b128 v[60:63], v14 offset:49152
    v_mfma_f32_16x16x32_bf16 v[28:31], a[248:251], a[244:247], 0
    buffer_load_dwordx4 a[192:195], v6, s[16:19], s54 offen offset:0
    v_mfma_f32_16x16x32_bf16 v[116:119], a[196:199], v[32:35], v[116:119]
    ds_read_b64_tr_b16 a[252:253], v4 offset:13056
    v_mfma_f32_16x16x32_bf16 v[128:131], a[196:199], v[36:39], v[128:131]
    ds_read_b64_tr_b16 a[254:255], v4 offset:16256
    v_cvt_pk_bf16_f32 v24, v24, v25
    v_mfma_f32_16x16x32_bf16 v[140:143], a[196:199], v[40:43], v[140:143]
    v_cvt_pk_bf16_f32 v25, v26, v27
    v_cvt_pk_bf16_f32 v28, v28, v29
    v_mfma_f32_16x16x32_bf16 v[152:155], a[196:199], v[44:47], v[152:155]
    ds_write_b64 v3, v[24:25] offset:0
    v_mfma_f32_16x16x32_bf16 v[120:123], a[200:203], v[32:35], v[120:123]
    v_cvt_pk_bf16_f32 v29, v30, v31
    v_mfma_f32_16x16x32_bf16 v[132:135], a[200:203], v[36:39], v[132:135]
    buffer_load_dwordx4 a[196:199], v6, s[16:19], s54 offen offset:1024
    v_mfma_f32_16x16x32_bf16 v[144:147], a[200:203], v[40:43], v[144:147]
    ds_write_b64 v3, v[28:29] offset:14336
    v_mfma_f32_16x16x32_bf16 v[156:159], a[200:203], v[44:47], v[156:159]
    s_waitcnt vmcnt(8) lgkmcnt(2)
    v_mfma_f32_16x16x32_bf16 v[160:163], a[204:207], v[48:51], v[160:163]
    buffer_load_dwordx4 a[200:203], v6, s[16:19], s54 offen offset:2048
    v_mfma_f32_16x16x32_bf16 v[172:175], a[204:207], v[52:55], v[172:175]
    ds_read_b128 v[32:35], v2 offset:35840
    s_mov_b32 s54, 757376
    v_mfma_f32_16x16x32_bf16 v[184:187], a[204:207], v[56:59], v[184:187]
    ds_read_b128 v[36:39], v2 offset:37888
    v_mfma_f32_16x16x32_bf16 v[24:27], a[252:255], a[240:243], 0
    ds_read_b128 v[40:43], v2 offset:39936
    v_mfma_f32_16x16x32_bf16 v[196:199], a[204:207], v[60:63], v[196:199]
    ds_read_b128 v[44:47], v15 offset:41984
    v_mfma_f32_16x16x32_bf16 v[28:31], a[252:255], a[244:247], 0
    buffer_load_dwordx4 a[204:207], v6, s[16:19], s54 offen offset:0
    v_mfma_f32_16x16x32_bf16 v[164:167], a[208:211], v[48:51], v[164:167]
    ds_read_b64_tr_b16 a[248:249], v4 offset:25856
    v_mfma_f32_16x16x32_bf16 v[176:179], a[208:211], v[52:55], v[176:179]
    ds_read_b64_tr_b16 a[250:251], v4 offset:29056
    v_cvt_pk_bf16_f32 v24, v24, v25
    v_mfma_f32_16x16x32_bf16 v[188:191], a[208:211], v[56:59], v[188:191]
    v_cvt_pk_bf16_f32 v25, v26, v27
    v_cvt_pk_bf16_f32 v28, v28, v29
    v_mfma_f32_16x16x32_bf16 v[200:203], a[208:211], v[60:63], v[200:203]
    ds_write_b64 v3, v[24:25] offset:1024
    v_mfma_f32_16x16x32_bf16 v[168:171], a[212:215], v[48:51], v[168:171]
    v_cvt_pk_bf16_f32 v29, v30, v31
    v_mfma_f32_16x16x32_bf16 v[180:183], a[212:215], v[52:55], v[180:183]
    buffer_load_dwordx4 a[208:211], v6, s[16:19], s54 offen offset:1024
    v_mfma_f32_16x16x32_bf16 v[192:195], a[212:215], v[56:59], v[192:195]
    ds_write_b64 v3, v[28:29] offset:15360
    v_mfma_f32_16x16x32_bf16 v[204:207], a[212:215], v[60:63], v[204:207]
    s_waitcnt vmcnt(8) lgkmcnt(2)
    v_mfma_f32_16x16x32_bf16 v[112:115], a[216:219], v[32:35], v[112:115]
    buffer_load_dwordx4 a[212:215], v6, s[16:19], s54 offen offset:2048
    v_mfma_f32_16x16x32_bf16 v[124:127], a[216:219], v[36:39], v[124:127]
    ds_read_b128 v[48:51], v2 offset:43008
    s_mov_b32 s54, 769792
    v_mfma_f32_16x16x32_bf16 v[136:139], a[216:219], v[40:43], v[136:139]
    ds_read_b128 v[52:55], v2 offset:45056
    v_mfma_f32_16x16x32_bf16 v[24:27], a[248:251], a[240:243], 0
    ds_read_b128 v[56:59], v2 offset:47104
    v_mfma_f32_16x16x32_bf16 v[148:151], a[216:219], v[44:47], v[148:151]
    ds_read_b128 v[60:63], v15 offset:49152
    v_mfma_f32_16x16x32_bf16 v[28:31], a[248:251], a[244:247], 0
    buffer_load_dwordx4 a[216:219], v6, s[16:19], s54 offen offset:0
    v_mfma_f32_16x16x32_bf16 v[116:119], a[220:223], v[32:35], v[116:119]
    ds_read_b64_tr_b16 a[252:253], v4 offset:38656
    v_mfma_f32_16x16x32_bf16 v[128:131], a[220:223], v[36:39], v[128:131]
    ds_read_b64_tr_b16 a[254:255], v4 offset:41856
    v_cvt_pk_bf16_f32 v24, v24, v25
    v_mfma_f32_16x16x32_bf16 v[140:143], a[220:223], v[40:43], v[140:143]
    v_cvt_pk_bf16_f32 v25, v26, v27
    v_cvt_pk_bf16_f32 v28, v28, v29
    v_mfma_f32_16x16x32_bf16 v[152:155], a[220:223], v[44:47], v[152:155]
    ds_write_b64 v3, v[24:25] offset:2048
    v_mfma_f32_16x16x32_bf16 v[120:123], a[224:227], v[32:35], v[120:123]
    v_cvt_pk_bf16_f32 v29, v30, v31
    v_mfma_f32_16x16x32_bf16 v[132:135], a[224:227], v[36:39], v[132:135]
    buffer_load_dwordx4 a[220:223], v6, s[16:19], s54 offen offset:1024
    v_mfma_f32_16x16x32_bf16 v[144:147], a[224:227], v[40:43], v[144:147]
    ds_write_b64 v3, v[28:29] offset:16384
    v_mfma_f32_16x16x32_bf16 v[156:159], a[224:227], v[44:47], v[156:159]
    s_waitcnt vmcnt(8) lgkmcnt(2)
    v_mfma_f32_16x16x32_bf16 v[160:163], a[228:231], v[48:51], v[160:163]
    buffer_load_dwordx4 a[224:227], v6, s[16:19], s54 offen offset:2048
    v_mfma_f32_16x16x32_bf16 v[172:175], a[228:231], v[52:55], v[172:175]
    ds_read_b128 v[32:35], v1 offset:28672
    s_mov_b32 s54, 782208
    v_mfma_f32_16x16x32_bf16 v[184:187], a[228:231], v[56:59], v[184:187]
    ds_read_b128 v[36:39], v1 offset:30720
    v_mfma_f32_16x16x32_bf16 v[24:27], a[252:255], a[240:243], 0
    ds_read_b128 v[40:43], v1 offset:32768
    v_mfma_f32_16x16x32_bf16 v[196:199], a[228:231], v[60:63], v[196:199]
    ds_read_b128 v[44:47], v14 offset:34816
    v_mfma_f32_16x16x32_bf16 v[28:31], a[252:255], a[244:247], 0
    buffer_load_dwordx4 a[228:231], v6, s[16:19], s54 offen offset:0
    v_mfma_f32_16x16x32_bf16 v[164:167], a[232:235], v[48:51], v[164:167]
    ds_read_b64_tr_b16 a[248:249], v5 offset:256
    v_mfma_f32_16x16x32_bf16 v[176:179], a[232:235], v[52:55], v[176:179]
    ds_read_b64_tr_b16 a[250:251], v5 offset:3456
    v_cvt_pk_bf16_f32 v24, v24, v25
    v_mfma_f32_16x16x32_bf16 v[188:191], a[232:235], v[56:59], v[188:191]
    v_cvt_pk_bf16_f32 v25, v26, v27
    v_cvt_pk_bf16_f32 v28, v28, v29
    v_mfma_f32_16x16x32_bf16 v[200:203], a[232:235], v[60:63], v[200:203]
    ds_write_b64 v3, v[24:25] offset:3072
    v_mfma_f32_16x16x32_bf16 v[168:171], a[236:239], v[48:51], v[168:171]
    v_cvt_pk_bf16_f32 v29, v30, v31
    v_mfma_f32_16x16x32_bf16 v[180:183], a[236:239], v[52:55], v[180:183]
    buffer_load_dwordx4 a[232:235], v6, s[16:19], s54 offen offset:1024
    v_mfma_f32_16x16x32_bf16 v[192:195], a[236:239], v[56:59], v[192:195]
    ds_write_b64 v3, v[28:29] offset:17408
    v_mfma_f32_16x16x32_bf16 v[204:207], a[236:239], v[60:63], v[204:207]
    s_waitcnt vmcnt(8) lgkmcnt(2)
    v_mfma_f32_16x16x32_bf16 v[64:67], a[192:195], v[32:35], v[64:67]
    buffer_load_dwordx4 a[236:239], v6, s[16:19], s54 offen offset:2048
    v_mfma_f32_16x16x32_bf16 v[76:79], a[192:195], v[36:39], v[76:79]
    ds_read_b128 v[48:51], v1 offset:50176
    s_mov_b32 s54, 794624
    v_add_u32 v12, 51200, v7
    v_mfma_f32_16x16x32_bf16 v[88:91], a[192:195], v[40:43], v[88:91]
    ds_read_b128 v[52:55], v1 offset:52224
    v_add_u32 v13, 51200, v8
    v_mfma_f32_16x16x32_bf16 v[24:27], a[248:251], a[240:243], 0
    ds_read_b128 v[56:59], v1 offset:54272
    v_add_u32 v16, 51200, v9
    v_mfma_f32_16x16x32_bf16 v[100:103], a[192:195], v[44:47], v[100:103]
    ds_read_b128 v[60:63], v14 offset:56320
    v_mfma_f32_16x16x32_bf16 v[28:31], a[248:251], a[244:247], 0
    buffer_load_dwordx4 a[192:195], v6, s[16:19], s54 offen offset:0
    v_mfma_f32_16x16x32_bf16 v[68:71], a[196:199], v[32:35], v[68:71]
    ds_read_b64_tr_b16 a[252:253], v5 offset:13056
    v_mfma_f32_16x16x32_bf16 v[80:83], a[196:199], v[36:39], v[80:83]
    ds_read_b64_tr_b16 a[254:255], v5 offset:16256
    v_cvt_pk_bf16_f32 v24, v24, v25
    v_mfma_f32_16x16x32_bf16 v[92:95], a[196:199], v[40:43], v[92:95]
    v_cvt_pk_bf16_f32 v25, v26, v27
    v_cvt_pk_bf16_f32 v28, v28, v29
    v_mfma_f32_16x16x32_bf16 v[104:107], a[196:199], v[44:47], v[104:107]
    ds_write_b64 v3, v[24:25] offset:4096
    v_mfma_f32_16x16x32_bf16 v[72:75], a[200:203], v[32:35], v[72:75]
    v_cvt_pk_bf16_f32 v29, v30, v31
    v_mfma_f32_16x16x32_bf16 v[84:87], a[200:203], v[36:39], v[84:87]
    buffer_load_dwordx4 a[196:199], v6, s[16:19], s54 offen offset:1024
    v_mfma_f32_16x16x32_bf16 v[96:99], a[200:203], v[40:43], v[96:99]
    ds_write_b64 v3, v[28:29] offset:18432
    v_mfma_f32_16x16x32_bf16 v[108:111], a[200:203], v[44:47], v[108:111]
    s_waitcnt vmcnt(8) lgkmcnt(2)
    v_mfma_f32_16x16x32_bf16 v[208:211], a[204:207], v[48:51], v[208:211]
    buffer_load_dwordx4 a[200:203], v6, s[16:19], s54 offen offset:2048
    v_mfma_f32_16x16x32_bf16 v[220:223], a[204:207], v[52:55], v[220:223]
    ds_read_b128 v[32:35], v2 offset:28672
    s_mov_b32 s54, 807040
    v_mfma_f32_16x16x32_bf16 v[232:235], a[204:207], v[56:59], v[232:235]
    ds_read_b128 v[36:39], v2 offset:30720
    v_mfma_f32_16x16x32_bf16 v[24:27], a[252:255], a[240:243], 0
    ds_read_b128 v[40:43], v2 offset:32768
    v_mfma_f32_16x16x32_bf16 v[244:247], a[204:207], v[60:63], v[244:247]
    ds_read_b128 v[44:47], v15 offset:34816
    v_mfma_f32_16x16x32_bf16 v[28:31], a[252:255], a[244:247], 0
    buffer_load_dwordx4 a[204:207], v6, s[16:19], s54 offen offset:0
    v_mfma_f32_16x16x32_bf16 v[212:215], a[208:211], v[48:51], v[212:215]
    ds_read_b64_tr_b16 a[248:249], v5 offset:25856
    v_mfma_f32_16x16x32_bf16 v[224:227], a[208:211], v[52:55], v[224:227]
    ds_read_b64_tr_b16 a[250:251], v5 offset:29056
    v_cvt_pk_bf16_f32 v24, v24, v25
    v_mfma_f32_16x16x32_bf16 v[236:239], a[208:211], v[56:59], v[236:239]
    v_cvt_pk_bf16_f32 v25, v26, v27
    v_cvt_pk_bf16_f32 v28, v28, v29
    v_mfma_f32_16x16x32_bf16 v[248:251], a[208:211], v[60:63], v[248:251]
    ds_write_b64 v3, v[24:25] offset:5120
    v_mfma_f32_16x16x32_bf16 v[216:219], a[212:215], v[48:51], v[216:219]
    v_cvt_pk_bf16_f32 v29, v30, v31
    v_mfma_f32_16x16x32_bf16 v[228:231], a[212:215], v[52:55], v[228:231]
    buffer_load_dwordx4 a[208:211], v6, s[16:19], s54 offen offset:1024
    v_mfma_f32_16x16x32_bf16 v[240:243], a[212:215], v[56:59], v[240:243]
    ds_write_b64 v3, v[28:29] offset:19456
    v_mfma_f32_16x16x32_bf16 v[252:255], a[212:215], v[60:63], v[252:255]
    s_waitcnt vmcnt(8) lgkmcnt(2)
    v_mfma_f32_16x16x32_bf16 v[64:67], a[216:219], v[32:35], v[64:67]
    buffer_load_dwordx4 a[212:215], v6, s[16:19], s54 offen offset:2048
    v_mfma_f32_16x16x32_bf16 v[76:79], a[216:219], v[36:39], v[76:79]
    ds_read_b128 v[48:51], v2 offset:50176
    s_mov_b32 s54, 819456
    v_mfma_f32_16x16x32_bf16 v[88:91], a[216:219], v[40:43], v[88:91]
    ds_read_b128 v[52:55], v2 offset:52224
    v_mfma_f32_16x16x32_bf16 v[24:27], a[248:251], a[240:243], 0
    ds_read_b128 v[56:59], v2 offset:54272
    v_mfma_f32_16x16x32_bf16 v[100:103], a[216:219], v[44:47], v[100:103]
    ds_read_b128 v[60:63], v15 offset:56320
    v_mfma_f32_16x16x32_bf16 v[28:31], a[248:251], a[244:247], 0
    buffer_load_dwordx4 a[216:219], v6, s[16:19], s54 offen offset:0
    v_mfma_f32_16x16x32_bf16 v[68:71], a[220:223], v[32:35], v[68:71]
    s_nop 0
    v_mfma_f32_16x16x32_bf16 v[80:83], a[220:223], v[36:39], v[80:83]
    s_nop 0
    v_cvt_pk_bf16_f32 v24, v24, v25
    v_mfma_f32_16x16x32_bf16 v[92:95], a[220:223], v[40:43], v[92:95]
    v_cvt_pk_bf16_f32 v25, v26, v27
    v_cvt_pk_bf16_f32 v28, v28, v29
    v_mfma_f32_16x16x32_bf16 v[104:107], a[220:223], v[44:47], v[104:107]
    ds_write_b64 v3, v[24:25] offset:6144
    v_mfma_f32_16x16x32_bf16 v[72:75], a[224:227], v[32:35], v[72:75]
    v_cvt_pk_bf16_f32 v29, v30, v31
    v_mfma_f32_16x16x32_bf16 v[84:87], a[224:227], v[36:39], v[84:87]
    buffer_load_dwordx4 a[220:223], v6, s[16:19], s54 offen offset:1024
    v_mfma_f32_16x16x32_bf16 v[96:99], a[224:227], v[40:43], v[96:99]
    ds_write_b64 v3, v[28:29] offset:20480
    v_mfma_f32_16x16x32_bf16 v[108:111], a[224:227], v[44:47], v[108:111]
    s_waitcnt vmcnt(8) lgkmcnt(2)
    v_mfma_f32_16x16x32_bf16 v[208:211], a[228:231], v[48:51], v[208:211]
    buffer_load_dwordx4 a[224:227], v6, s[16:19], s54 offen offset:2048
    v_mfma_f32_16x16x32_bf16 v[220:223], a[228:231], v[52:55], v[220:223]
    s_mov_b32 s54, 831872
    v_mfma_f32_16x16x32_bf16 v[232:235], a[228:231], v[56:59], v[232:235]
    s_waitcnt lgkmcnt(0)
    s_barrier
    v_mfma_f32_16x16x32_bf16 v[244:247], a[228:231], v[60:63], v[244:247]
    buffer_load_dwordx4 a[228:231], v6, s[16:19], s54 offen offset:0
    v_mfma_f32_16x16x32_bf16 v[212:215], a[232:235], v[48:51], v[212:215]
    ds_read_b128 v[32:35], v1 offset:7168
    v_mfma_f32_16x16x32_bf16 v[224:227], a[232:235], v[52:55], v[224:227]
    ds_read_b128 v[36:39], v1 offset:9216
    v_mfma_f32_16x16x32_bf16 v[236:239], a[232:235], v[56:59], v[236:239]
    ds_read_b128 v[40:43], v1 offset:11264
    v_mfma_f32_16x16x32_bf16 v[248:251], a[232:235], v[60:63], v[248:251]
    ds_read_b128 v[44:47], v14 offset:13312
    v_mfma_f32_16x16x32_bf16 v[216:219], a[236:239], v[48:51], v[216:219]
    buffer_load_dwordx4 a[232:235], v6, s[16:19], s54 offen offset:1024
    v_mfma_f32_16x16x32_bf16 v[228:231], a[236:239], v[52:55], v[228:231]
    ds_read_b64_tr_b16 a[248:249], v4 offset:6400
    v_mfma_f32_16x16x32_bf16 v[240:243], a[236:239], v[56:59], v[240:243]
    ds_read_b64_tr_b16 a[250:251], v4 offset:9600
    v_mfma_f32_16x16x32_bf16 v[252:255], a[236:239], v[60:63], v[252:255]
    s_waitcnt vmcnt(8) lgkmcnt(0)
    v_mfma_f32_16x16x32_bf16 v[112:115], a[192:195], v[32:35], v[112:115]
    buffer_load_dwordx4 a[236:239], v6, s[16:19], s54 offen offset:2048
    v_mfma_f32_16x16x32_bf16 v[124:127], a[192:195], v[36:39], v[124:127]
    ds_read_b128 v[48:51], v1 offset:14336
    s_mov_b32 s54, 844288
    v_mfma_f32_16x16x32_bf16 v[136:139], a[192:195], v[40:43], v[136:139]
    ds_read_b128 v[52:55], v1 offset:16384
    v_mfma_f32_16x16x32_bf16 v[24:27], a[248:251], a[240:243], 0
    ds_read_b128 v[56:59], v1 offset:18432
    v_mfma_f32_16x16x32_bf16 v[148:151], a[192:195], v[44:47], v[148:151]
    ds_read_b128 v[60:63], v14 offset:20480
    v_mfma_f32_16x16x32_bf16 v[28:31], a[248:251], a[244:247], 0
    buffer_load_dwordx4 a[192:195], v6, s[16:19], s54 offen offset:0
    v_mfma_f32_16x16x32_bf16 v[116:119], a[196:199], v[32:35], v[116:119]
    ds_read_b64_tr_b16 a[252:253], v4 offset:19200
    v_mfma_f32_16x16x32_bf16 v[128:131], a[196:199], v[36:39], v[128:131]
    ds_read_b64_tr_b16 a[254:255], v4 offset:22400
    v_cvt_pk_bf16_f32 v24, v24, v25
    v_mfma_f32_16x16x32_bf16 v[140:143], a[196:199], v[40:43], v[140:143]
    v_cvt_pk_bf16_f32 v25, v26, v27
    v_cvt_pk_bf16_f32 v28, v28, v29
    v_mfma_f32_16x16x32_bf16 v[152:155], a[196:199], v[44:47], v[152:155]
    ds_write_b64 v3, v[24:25] offset:28672
    v_mfma_f32_16x16x32_bf16 v[120:123], a[200:203], v[32:35], v[120:123]
    v_cvt_pk_bf16_f32 v29, v30, v31
    v_mfma_f32_16x16x32_bf16 v[132:135], a[200:203], v[36:39], v[132:135]
    buffer_load_dwordx4 a[196:199], v6, s[16:19], s54 offen offset:1024
    v_mfma_f32_16x16x32_bf16 v[144:147], a[200:203], v[40:43], v[144:147]
    ds_write_b64 v3, v[28:29] offset:43008
    v_mfma_f32_16x16x32_bf16 v[156:159], a[200:203], v[44:47], v[156:159]
    s_waitcnt vmcnt(8) lgkmcnt(2)
    v_mfma_f32_16x16x32_bf16 v[160:163], a[204:207], v[48:51], v[160:163]
    buffer_load_dwordx4 a[200:203], v6, s[16:19], s54 offen offset:2048
    v_mfma_f32_16x16x32_bf16 v[172:175], a[204:207], v[52:55], v[172:175]
    ds_read_b128 v[32:35], v2 offset:7168
    s_mov_b32 s54, 856704
    v_mfma_f32_16x16x32_bf16 v[184:187], a[204:207], v[56:59], v[184:187]
    ds_read_b128 v[36:39], v2 offset:9216
    v_mfma_f32_16x16x32_bf16 v[24:27], a[252:255], a[240:243], 0
    ds_read_b128 v[40:43], v2 offset:11264
    v_mfma_f32_16x16x32_bf16 v[196:199], a[204:207], v[60:63], v[196:199]
    ds_read_b128 v[44:47], v15 offset:13312
    v_mfma_f32_16x16x32_bf16 v[28:31], a[252:255], a[244:247], 0
    buffer_load_dwordx4 a[204:207], v6, s[16:19], s54 offen offset:0
    v_mfma_f32_16x16x32_bf16 v[164:167], a[208:211], v[48:51], v[164:167]
    ds_read_b64_tr_b16 a[248:249], v4 offset:32000
    v_mfma_f32_16x16x32_bf16 v[176:179], a[208:211], v[52:55], v[176:179]
    ds_read_b64_tr_b16 a[250:251], v4 offset:35200
    v_cvt_pk_bf16_f32 v24, v24, v25
    v_mfma_f32_16x16x32_bf16 v[188:191], a[208:211], v[56:59], v[188:191]
    v_cvt_pk_bf16_f32 v25, v26, v27
    v_cvt_pk_bf16_f32 v28, v28, v29
    v_mfma_f32_16x16x32_bf16 v[200:203], a[208:211], v[60:63], v[200:203]
    ds_write_b64 v3, v[24:25] offset:29696
    v_mfma_f32_16x16x32_bf16 v[168:171], a[212:215], v[48:51], v[168:171]
    v_cvt_pk_bf16_f32 v29, v30, v31
    v_mfma_f32_16x16x32_bf16 v[180:183], a[212:215], v[52:55], v[180:183]
    buffer_load_dwordx4 a[208:211], v6, s[16:19], s54 offen offset:1024
    v_mfma_f32_16x16x32_bf16 v[192:195], a[212:215], v[56:59], v[192:195]
    ds_write_b64 v3, v[28:29] offset:44032
    v_mfma_f32_16x16x32_bf16 v[204:207], a[212:215], v[60:63], v[204:207]
    s_waitcnt vmcnt(8) lgkmcnt(2)
    v_mfma_f32_16x16x32_bf16 v[112:115], a[216:219], v[32:35], v[112:115]
    buffer_load_dwordx4 a[212:215], v6, s[16:19], s54 offen offset:2048
    v_mfma_f32_16x16x32_bf16 v[124:127], a[216:219], v[36:39], v[124:127]
    ds_read_b128 v[48:51], v2 offset:14336
    s_mov_b32 s54, 869120
    v_mfma_f32_16x16x32_bf16 v[136:139], a[216:219], v[40:43], v[136:139]
    ds_read_b128 v[52:55], v2 offset:16384
    v_mfma_f32_16x16x32_bf16 v[24:27], a[248:251], a[240:243], 0
    ds_read_b128 v[56:59], v2 offset:18432
    v_mfma_f32_16x16x32_bf16 v[148:151], a[216:219], v[44:47], v[148:151]
    ds_read_b128 v[60:63], v15 offset:20480
    v_mfma_f32_16x16x32_bf16 v[28:31], a[248:251], a[244:247], 0
    buffer_load_dwordx4 a[216:219], v6, s[16:19], s54 offen offset:0
    v_mfma_f32_16x16x32_bf16 v[116:119], a[220:223], v[32:35], v[116:119]
    ds_read_b64_tr_b16 a[252:253], v4 offset:44800
    v_mfma_f32_16x16x32_bf16 v[128:131], a[220:223], v[36:39], v[128:131]
    ds_read_b64_tr_b16 a[254:255], v4 offset:48000
    v_cvt_pk_bf16_f32 v24, v24, v25
    v_mfma_f32_16x16x32_bf16 v[140:143], a[220:223], v[40:43], v[140:143]
    v_cvt_pk_bf16_f32 v25, v26, v27
    v_cvt_pk_bf16_f32 v28, v28, v29
    v_mfma_f32_16x16x32_bf16 v[152:155], a[220:223], v[44:47], v[152:155]
    ds_write_b64 v3, v[24:25] offset:30720
    v_mfma_f32_16x16x32_bf16 v[120:123], a[224:227], v[32:35], v[120:123]
    v_cvt_pk_bf16_f32 v29, v30, v31
    v_mfma_f32_16x16x32_bf16 v[132:135], a[224:227], v[36:39], v[132:135]
    buffer_load_dwordx4 a[220:223], v6, s[16:19], s54 offen offset:1024
    v_mfma_f32_16x16x32_bf16 v[144:147], a[224:227], v[40:43], v[144:147]
    ds_write_b64 v3, v[28:29] offset:45056
    v_mfma_f32_16x16x32_bf16 v[156:159], a[224:227], v[44:47], v[156:159]
    s_waitcnt vmcnt(8) lgkmcnt(2)
    v_mfma_f32_16x16x32_bf16 v[160:163], a[228:231], v[48:51], v[160:163]
    buffer_load_dwordx4 a[224:227], v6, s[16:19], s54 offen offset:2048
    v_mfma_f32_16x16x32_bf16 v[172:175], a[228:231], v[52:55], v[172:175]
    ds_read_b128 v[32:35], v1 offset:0
    s_mov_b32 s54, 881536
    v_mfma_f32_16x16x32_bf16 v[184:187], a[228:231], v[56:59], v[184:187]
    ds_read_b128 v[36:39], v1 offset:2048
    v_mfma_f32_16x16x32_bf16 v[24:27], a[252:255], a[240:243], 0
    ds_read_b128 v[40:43], v1 offset:4096
    v_mfma_f32_16x16x32_bf16 v[196:199], a[228:231], v[60:63], v[196:199]
    ds_read_b128 v[44:47], v14 offset:6144
    v_mfma_f32_16x16x32_bf16 v[28:31], a[252:255], a[244:247], 0
    buffer_load_dwordx4 a[228:231], v6, s[16:19], s54 offen offset:0
    v_mfma_f32_16x16x32_bf16 v[164:167], a[232:235], v[48:51], v[164:167]
    ds_read_b64_tr_b16 a[248:249], v5 offset:6400
    v_mfma_f32_16x16x32_bf16 v[176:179], a[232:235], v[52:55], v[176:179]
    ds_read_b64_tr_b16 a[250:251], v5 offset:9600
    v_cvt_pk_bf16_f32 v24, v24, v25
    v_mfma_f32_16x16x32_bf16 v[188:191], a[232:235], v[56:59], v[188:191]
    v_cvt_pk_bf16_f32 v25, v26, v27
    v_cvt_pk_bf16_f32 v28, v28, v29
    v_mfma_f32_16x16x32_bf16 v[200:203], a[232:235], v[60:63], v[200:203]
    ds_write_b64 v3, v[24:25] offset:31744
    v_mfma_f32_16x16x32_bf16 v[168:171], a[236:239], v[48:51], v[168:171]
    v_cvt_pk_bf16_f32 v29, v30, v31
    v_mfma_f32_16x16x32_bf16 v[180:183], a[236:239], v[52:55], v[180:183]
    buffer_load_dwordx4 a[232:235], v6, s[16:19], s54 offen offset:1024
    v_mfma_f32_16x16x32_bf16 v[192:195], a[236:239], v[56:59], v[192:195]
    ds_write_b64 v3, v[28:29] offset:46080
    v_mfma_f32_16x16x32_bf16 v[204:207], a[236:239], v[60:63], v[204:207]
    v_pk_add_f32 v[64:65], v[64:65], v[112:113]
    v_pk_add_f32 v[66:67], v[66:67], v[114:115]
    v_pk_add_f32 v[76:77], v[76:77], v[124:125]
    v_pk_add_f32 v[78:79], v[78:79], v[126:127]
    v_pk_add_f32 v[88:89], v[88:89], v[136:137]
    v_pk_add_f32 v[90:91], v[90:91], v[138:139]
    v_pk_add_f32 v[100:101], v[100:101], v[148:149]
    v_pk_add_f32 v[102:103], v[102:103], v[150:151]
    v_pk_add_f32 v[68:69], v[68:69], v[116:117]
    v_pk_add_f32 v[70:71], v[70:71], v[118:119]
    v_pk_add_f32 v[80:81], v[80:81], v[128:129]
    v_pk_add_f32 v[82:83], v[82:83], v[130:131]
    v_pk_add_f32 v[92:93], v[92:93], v[140:141]
    v_pk_add_f32 v[94:95], v[94:95], v[142:143]
    v_pk_add_f32 v[104:105], v[104:105], v[152:153]
    v_pk_add_f32 v[106:107], v[106:107], v[154:155]
    v_pk_add_f32 v[72:73], v[72:73], v[120:121]
    v_pk_add_f32 v[74:75], v[74:75], v[122:123]
    v_pk_add_f32 v[84:85], v[84:85], v[132:133]
    v_pk_add_f32 v[86:87], v[86:87], v[134:135]
    v_pk_add_f32 v[96:97], v[96:97], v[144:145]
    v_pk_add_f32 v[98:99], v[98:99], v[146:147]
    v_pk_add_f32 v[108:109], v[108:109], v[156:157]
    v_pk_add_f32 v[110:111], v[110:111], v[158:159]
    v_pk_add_f32 v[208:209], v[208:209], v[112:113] neg_lo:[0,1] neg_hi:[0,1]
    v_pk_add_f32 v[210:211], v[210:211], v[114:115] neg_lo:[0,1] neg_hi:[0,1]
    v_pk_add_f32 v[220:221], v[220:221], v[124:125] neg_lo:[0,1] neg_hi:[0,1]
    v_pk_add_f32 v[222:223], v[222:223], v[126:127] neg_lo:[0,1] neg_hi:[0,1]
    v_pk_add_f32 v[232:233], v[232:233], v[136:137] neg_lo:[0,1] neg_hi:[0,1]
    v_pk_add_f32 v[234:235], v[234:235], v[138:139] neg_lo:[0,1] neg_hi:[0,1]
    v_pk_add_f32 v[244:245], v[244:245], v[148:149] neg_lo:[0,1] neg_hi:[0,1]
    v_pk_add_f32 v[246:247], v[246:247], v[150:151] neg_lo:[0,1] neg_hi:[0,1]
    v_pk_add_f32 v[212:213], v[212:213], v[116:117] neg_lo:[0,1] neg_hi:[0,1]
    v_pk_add_f32 v[214:215], v[214:215], v[118:119] neg_lo:[0,1] neg_hi:[0,1]
    v_pk_add_f32 v[224:225], v[224:225], v[128:129] neg_lo:[0,1] neg_hi:[0,1]
    v_pk_add_f32 v[226:227], v[226:227], v[130:131] neg_lo:[0,1] neg_hi:[0,1]
    v_pk_add_f32 v[236:237], v[236:237], v[140:141] neg_lo:[0,1] neg_hi:[0,1]
    v_pk_add_f32 v[238:239], v[238:239], v[142:143] neg_lo:[0,1] neg_hi:[0,1]
    v_pk_add_f32 v[248:249], v[248:249], v[152:153] neg_lo:[0,1] neg_hi:[0,1]
    v_pk_add_f32 v[250:251], v[250:251], v[154:155] neg_lo:[0,1] neg_hi:[0,1]
    v_pk_add_f32 v[216:217], v[216:217], v[120:121] neg_lo:[0,1] neg_hi:[0,1]
    v_pk_add_f32 v[218:219], v[218:219], v[122:123] neg_lo:[0,1] neg_hi:[0,1]
    v_pk_add_f32 v[228:229], v[228:229], v[132:133] neg_lo:[0,1] neg_hi:[0,1]
    v_pk_add_f32 v[230:231], v[230:231], v[134:135] neg_lo:[0,1] neg_hi:[0,1]
    v_pk_add_f32 v[240:241], v[240:241], v[144:145] neg_lo:[0,1] neg_hi:[0,1]
    v_pk_add_f32 v[242:243], v[242:243], v[146:147] neg_lo:[0,1] neg_hi:[0,1]
    v_pk_add_f32 v[252:253], v[252:253], v[156:157] neg_lo:[0,1] neg_hi:[0,1]
    v_pk_add_f32 v[254:255], v[254:255], v[158:159] neg_lo:[0,1] neg_hi:[0,1]
    v_pk_add_f32 v[64:65], v[64:65], v[160:161]
    v_pk_add_f32 v[66:67], v[66:67], v[162:163]
    v_pk_add_f32 v[76:77], v[76:77], v[172:173]
    v_pk_add_f32 v[78:79], v[78:79], v[174:175]
    v_pk_add_f32 v[88:89], v[88:89], v[184:185]
    v_pk_add_f32 v[90:91], v[90:91], v[186:187]
    v_pk_add_f32 v[100:101], v[100:101], v[196:197]
    v_pk_add_f32 v[102:103], v[102:103], v[198:199]
    v_pk_add_f32 v[68:69], v[68:69], v[164:165]
    v_pk_add_f32 v[70:71], v[70:71], v[166:167]
    v_pk_add_f32 v[80:81], v[80:81], v[176:177]
    v_pk_add_f32 v[82:83], v[82:83], v[178:179]
    v_pk_add_f32 v[92:93], v[92:93], v[188:189]
    v_pk_add_f32 v[94:95], v[94:95], v[190:191]
    v_pk_add_f32 v[104:105], v[104:105], v[200:201]
    v_pk_add_f32 v[106:107], v[106:107], v[202:203]
    v_pk_add_f32 v[72:73], v[72:73], v[168:169]
    v_pk_add_f32 v[74:75], v[74:75], v[170:171]
    v_pk_add_f32 v[84:85], v[84:85], v[180:181]
    v_pk_add_f32 v[86:87], v[86:87], v[182:183]
    v_pk_add_f32 v[96:97], v[96:97], v[192:193]
    v_pk_add_f32 v[98:99], v[98:99], v[194:195]
    v_pk_add_f32 v[108:109], v[108:109], v[204:205]
    v_pk_add_f32 v[110:111], v[110:111], v[206:207]
    v_pk_add_f32 v[208:209], v[208:209], v[160:161]
    v_pk_add_f32 v[210:211], v[210:211], v[162:163]
    v_pk_add_f32 v[220:221], v[220:221], v[172:173]
    v_pk_add_f32 v[222:223], v[222:223], v[174:175]
    v_pk_add_f32 v[232:233], v[232:233], v[184:185]
    v_pk_add_f32 v[234:235], v[234:235], v[186:187]
    v_pk_add_f32 v[244:245], v[244:245], v[196:197]
    v_pk_add_f32 v[246:247], v[246:247], v[198:199]
    v_pk_add_f32 v[212:213], v[212:213], v[164:165]
    v_pk_add_f32 v[214:215], v[214:215], v[166:167]
    v_pk_add_f32 v[224:225], v[224:225], v[176:177]
    v_pk_add_f32 v[226:227], v[226:227], v[178:179]
    v_pk_add_f32 v[236:237], v[236:237], v[188:189]
    v_pk_add_f32 v[238:239], v[238:239], v[190:191]
    v_pk_add_f32 v[248:249], v[248:249], v[200:201]
    v_pk_add_f32 v[250:251], v[250:251], v[202:203]
    v_pk_add_f32 v[216:217], v[216:217], v[168:169]
    v_pk_add_f32 v[218:219], v[218:219], v[170:171]
    v_pk_add_f32 v[228:229], v[228:229], v[180:181]
    v_pk_add_f32 v[230:231], v[230:231], v[182:183]
    v_pk_add_f32 v[240:241], v[240:241], v[192:193]
    v_pk_add_f32 v[242:243], v[242:243], v[194:195]
    v_pk_add_f32 v[252:253], v[252:253], v[204:205]
    v_pk_add_f32 v[254:255], v[254:255], v[206:207]
    s_nop 0
    s_waitcnt vmcnt(8) lgkmcnt(2)
    v_mfma_f32_16x16x32_bf16 v[64:67], a[192:195], v[32:35], v[64:67]
    buffer_load_dwordx4 a[236:239], v6, s[16:19], s54 offen offset:2048
    v_mfma_f32_16x16x32_bf16 v[76:79], a[192:195], v[36:39], v[76:79]
    ds_read_b128 v[48:51], v1 offset:21504
    s_mov_b32 s54, 893952
    v_mfma_f32_16x16x32_bf16 v[88:91], a[192:195], v[40:43], v[88:91]
    ds_read_b128 v[52:55], v1 offset:23552
    v_mfma_f32_16x16x32_bf16 v[24:27], a[248:251], a[240:243], 0
    ds_read_b128 v[56:59], v1 offset:25600
    v_mfma_f32_16x16x32_bf16 v[100:103], a[192:195], v[44:47], v[100:103]
    ds_read_b128 v[60:63], v14 offset:27648
    v_mfma_f32_16x16x32_bf16 v[28:31], a[248:251], a[244:247], 0
    buffer_load_dwordx4 a[192:195], v6, s[16:19], s54 offen offset:0
    v_mfma_f32_16x16x32_bf16 v[68:71], a[196:199], v[32:35], v[68:71]
    ds_read_b64_tr_b16 a[252:253], v5 offset:19200
    v_mfma_f32_16x16x32_bf16 v[80:83], a[196:199], v[36:39], v[80:83]
    ds_read_b64_tr_b16 a[254:255], v5 offset:22400
    v_cvt_pk_bf16_f32 v24, v24, v25
    v_mfma_f32_16x16x32_bf16 v[92:95], a[196:199], v[40:43], v[92:95]
    v_cvt_pk_bf16_f32 v25, v26, v27
    v_cvt_pk_bf16_f32 v28, v28, v29
    v_mfma_f32_16x16x32_bf16 v[104:107], a[196:199], v[44:47], v[104:107]
    ds_write_b64 v3, v[24:25] offset:32768
    v_mfma_f32_16x16x32_bf16 v[72:75], a[200:203], v[32:35], v[72:75]
    v_cvt_pk_bf16_f32 v29, v30, v31
    v_mfma_f32_16x16x32_bf16 v[84:87], a[200:203], v[36:39], v[84:87]
    buffer_load_dwordx4 a[196:199], v6, s[16:19], s54 offen offset:1024
    v_mfma_f32_16x16x32_bf16 v[96:99], a[200:203], v[40:43], v[96:99]
    ds_write_b64 v3, v[28:29] offset:47104
    v_mfma_f32_16x16x32_bf16 v[108:111], a[200:203], v[44:47], v[108:111]
    s_waitcnt vmcnt(8) lgkmcnt(2)
    v_mfma_f32_16x16x32_bf16 v[208:211], a[204:207], v[48:51], v[208:211]
    buffer_load_dwordx4 a[200:203], v6, s[16:19], s54 offen offset:2048
    v_mfma_f32_16x16x32_bf16 v[220:223], a[204:207], v[52:55], v[220:223]
    ds_read_b128 v[32:35], v2 offset:0
    s_mov_b32 s54, 906368
    v_mfma_f32_16x16x32_bf16 v[232:235], a[204:207], v[56:59], v[232:235]
    ds_read_b128 v[36:39], v2 offset:2048
    v_mfma_f32_16x16x32_bf16 v[24:27], a[252:255], a[240:243], 0
    ds_read_b128 v[40:43], v2 offset:4096
    v_mfma_f32_16x16x32_bf16 v[244:247], a[204:207], v[60:63], v[244:247]
    ds_read_b128 v[44:47], v15 offset:6144
    v_mfma_f32_16x16x32_bf16 v[28:31], a[252:255], a[244:247], 0
    buffer_load_dwordx4 a[204:207], v6, s[16:19], s54 offen offset:0
    v_mfma_f32_16x16x32_bf16 v[212:215], a[208:211], v[48:51], v[212:215]
    ds_read_b64_tr_b16 a[248:249], v5 offset:32000
    v_mfma_f32_16x16x32_bf16 v[224:227], a[208:211], v[52:55], v[224:227]
    ds_read_b64_tr_b16 a[250:251], v5 offset:35200
    v_cvt_pk_bf16_f32 v24, v24, v25
    v_mfma_f32_16x16x32_bf16 v[236:239], a[208:211], v[56:59], v[236:239]
    v_cvt_pk_bf16_f32 v25, v26, v27
    v_cvt_pk_bf16_f32 v28, v28, v29
    v_mfma_f32_16x16x32_bf16 v[248:251], a[208:211], v[60:63], v[248:251]
    ds_write_b64 v3, v[24:25] offset:33792
    v_mfma_f32_16x16x32_bf16 v[216:219], a[212:215], v[48:51], v[216:219]
    v_cvt_pk_bf16_f32 v29, v30, v31
    v_mfma_f32_16x16x32_bf16 v[228:231], a[212:215], v[52:55], v[228:231]
    buffer_load_dwordx4 a[208:211], v6, s[16:19], s54 offen offset:1024
    v_mfma_f32_16x16x32_bf16 v[240:243], a[212:215], v[56:59], v[240:243]
    ds_write_b64 v3, v[28:29] offset:48128
    v_mfma_f32_16x16x32_bf16 v[252:255], a[212:215], v[60:63], v[252:255]
    s_waitcnt vmcnt(8) lgkmcnt(2)
    v_mfma_f32_16x16x32_bf16 v[64:67], a[216:219], v[32:35], v[64:67]
    buffer_load_dwordx4 a[212:215], v6, s[16:19], s54 offen offset:2048
    v_mfma_f32_16x16x32_bf16 v[76:79], a[216:219], v[36:39], v[76:79]
    ds_read_b128 v[48:51], v2 offset:21504
    s_mov_b32 s54, 918784
    v_mfma_f32_16x16x32_bf16 v[88:91], a[216:219], v[40:43], v[88:91]
    ds_read_b128 v[52:55], v2 offset:23552
    v_mfma_f32_16x16x32_bf16 v[24:27], a[248:251], a[240:243], 0
    ds_read_b128 v[56:59], v2 offset:25600
    v_mfma_f32_16x16x32_bf16 v[100:103], a[216:219], v[44:47], v[100:103]
    ds_read_b128 v[60:63], v15 offset:27648
    v_mfma_f32_16x16x32_bf16 v[28:31], a[248:251], a[244:247], 0
    buffer_load_dwordx4 a[216:219], v6, s[16:19], s54 offen offset:0
    v_mfma_f32_16x16x32_bf16 v[68:71], a[220:223], v[32:35], v[68:71]
    s_nop 0
    v_mfma_f32_16x16x32_bf16 v[80:83], a[220:223], v[36:39], v[80:83]
    s_nop 0
    v_cvt_pk_bf16_f32 v24, v24, v25
    v_mfma_f32_16x16x32_bf16 v[92:95], a[220:223], v[40:43], v[92:95]
    v_cvt_pk_bf16_f32 v25, v26, v27
    v_cvt_pk_bf16_f32 v28, v28, v29
    v_mfma_f32_16x16x32_bf16 v[104:107], a[220:223], v[44:47], v[104:107]
    ds_write_b64 v3, v[24:25] offset:34816
    v_mfma_f32_16x16x32_bf16 v[72:75], a[224:227], v[32:35], v[72:75]
    v_cvt_pk_bf16_f32 v29, v30, v31
    v_mfma_f32_16x16x32_bf16 v[84:87], a[224:227], v[36:39], v[84:87]
    buffer_load_dwordx4 a[220:223], v6, s[16:19], s54 offen offset:1024
    v_mfma_f32_16x16x32_bf16 v[96:99], a[224:227], v[40:43], v[96:99]
    ds_write_b64 v3, v[28:29] offset:49152
    v_mfma_f32_16x16x32_bf16 v[108:111], a[224:227], v[44:47], v[108:111]
    s_waitcnt vmcnt(8) lgkmcnt(2)
    v_mfma_f32_16x16x32_bf16 v[208:211], a[228:231], v[48:51], v[208:211]
    buffer_load_dwordx4 a[224:227], v6, s[16:19], s54 offen offset:2048
    v_mfma_f32_16x16x32_bf16 v[220:223], a[228:231], v[52:55], v[220:223]
    s_mov_b32 s54, 931200
    v_mfma_f32_16x16x32_bf16 v[232:235], a[228:231], v[56:59], v[232:235]
    s_waitcnt lgkmcnt(0)
    s_barrier
    v_mfma_f32_16x16x32_bf16 v[244:247], a[228:231], v[60:63], v[244:247]
    buffer_load_dwordx4 a[228:231], v6, s[16:19], s54 offen offset:0
    v_mfma_f32_16x16x32_bf16 v[212:215], a[232:235], v[48:51], v[212:215]
    ds_read_b128 v[32:35], v1 offset:35840
    v_mfma_f32_16x16x32_bf16 v[224:227], a[232:235], v[52:55], v[224:227]
    ds_read_b128 v[36:39], v1 offset:37888
    v_mfma_f32_16x16x32_bf16 v[236:239], a[232:235], v[56:59], v[236:239]
    ds_read_b128 v[40:43], v1 offset:39936
    v_mfma_f32_16x16x32_bf16 v[248:251], a[232:235], v[60:63], v[248:251]
    ds_read_b128 v[44:47], v14 offset:41984
    v_mfma_f32_16x16x32_bf16 v[216:219], a[236:239], v[48:51], v[216:219]
    buffer_load_dwordx4 a[232:235], v6, s[16:19], s54 offen offset:1024
    v_mfma_f32_16x16x32_bf16 v[228:231], a[236:239], v[52:55], v[228:231]
    ds_read_b64_tr_b16 a[248:249], v4 offset:6528
    v_mfma_f32_16x16x32_bf16 v[240:243], a[236:239], v[56:59], v[240:243]
    ds_read_b64_tr_b16 a[250:251], v4 offset:9728
    v_mfma_f32_16x16x32_bf16 v[252:255], a[236:239], v[60:63], v[252:255]
    s_waitcnt vmcnt(8) lgkmcnt(0)
    v_mfma_f32_16x16x32_bf16 v[112:115], a[192:195], v[32:35], 0
    buffer_load_dwordx4 a[236:239], v6, s[16:19], s54 offen offset:2048
    v_mfma_f32_16x16x32_bf16 v[124:127], a[192:195], v[36:39], 0
    ds_read_b128 v[48:51], v1 offset:43008
    s_mov_b32 s54, 943616
    v_cvt_pk_bf16_f32 v64, v64, v65
    v_cvt_pk_bf16_f32 v65, v66, v67
    v_mfma_f32_16x16x32_bf16 v[136:139], a[192:195], v[40:43], 0
    ds_read_b128 v[52:55], v1 offset:45056
    v_cvt_pk_bf16_f32 v66, v68, v69
    v_cvt_pk_bf16_f32 v67, v70, v71
    v_mfma_f32_16x16x32_bf16 v[24:27], a[248:251], a[240:243], 0
    ds_read_b128 v[56:59], v1 offset:47104
    v_cvt_pk_bf16_f32 v68, v72, v73
    v_cvt_pk_bf16_f32 v69, v74, v75
    v_mfma_f32_16x16x32_bf16 v[148:151], a[192:195], v[44:47], 0
    ds_read_b128 v[60:63], v14 offset:49152
    ds_write_b128 v7, v[64:67] offset:0
    ds_write_b64 v8, v[68:69] offset:0
    v_mfma_f32_16x16x32_bf16 v[28:31], a[248:251], a[244:247], 0
    buffer_load_dwordx4 a[192:195], v6, s[16:19], s54 offen offset:0
    v_cvt_pk_bf16_f32 v76, v76, v77
    v_cvt_pk_bf16_f32 v77, v78, v79
    v_mfma_f32_16x16x32_bf16 v[116:119], a[196:199], v[32:35], 0
    ds_read_b64_tr_b16 a[252:253], v4 offset:19328
    v_cvt_pk_bf16_f32 v78, v80, v81
    v_cvt_pk_bf16_f32 v79, v82, v83
    v_mfma_f32_16x16x32_bf16 v[128:131], a[196:199], v[36:39], 0
    ds_read_b64_tr_b16 a[254:255], v4 offset:22528
    v_cvt_pk_bf16_f32 v24, v24, v25
    v_cvt_pk_bf16_f32 v80, v84, v85
    v_cvt_pk_bf16_f32 v81, v86, v87
    v_mfma_f32_16x16x32_bf16 v[140:143], a[196:199], v[40:43], 0
    v_cvt_pk_bf16_f32 v25, v26, v27
    v_cvt_pk_bf16_f32 v28, v28, v29
    ds_write_b128 v7, v[76:79] offset:25600
    ds_write_b64 v8, v[80:81] offset:25600
    v_mfma_f32_16x16x32_bf16 v[152:155], a[196:199], v[44:47], 0
    ds_write_b64 v3, v[24:25] offset:0
    v_cvt_pk_bf16_f32 v88, v88, v89
    v_cvt_pk_bf16_f32 v89, v90, v91
    v_mfma_f32_16x16x32_bf16 v[120:123], a[200:203], v[32:35], 0
    v_cvt_pk_bf16_f32 v29, v30, v31
    v_cvt_pk_bf16_f32 v90, v92, v93
    v_cvt_pk_bf16_f32 v91, v94, v95
    v_mfma_f32_16x16x32_bf16 v[132:135], a[200:203], v[36:39], 0
    buffer_load_dwordx4 a[196:199], v6, s[16:19], s54 offen offset:1024
    v_cvt_pk_bf16_f32 v92, v96, v97
    v_cvt_pk_bf16_f32 v93, v98, v99
    v_mfma_f32_16x16x32_bf16 v[144:147], a[200:203], v[40:43], 0
    ds_write_b64 v3, v[28:29] offset:14336
    ds_write_b128 v12, v[88:91] offset:0
    ds_write_b64 v13, v[92:93] offset:0
    v_mfma_f32_16x16x32_bf16 v[156:159], a[200:203], v[44:47], 0
    v_cvt_pk_bf16_f32 v100, v100, v101
    v_cvt_pk_bf16_f32 v101, v102, v103
    s_waitcnt vmcnt(8) lgkmcnt(6)
    v_mfma_f32_16x16x32_bf16 v[160:163], a[204:207], v[48:51], 0
    buffer_load_dwordx4 a[200:203], v6, s[16:19], s54 offen offset:2048
    v_mfma_f32_16x16x32_bf16 v[172:175], a[204:207], v[52:55], 0
    ds_read_b128 v[32:35], v2 offset:35840
    s_mov_b32 s54, 956032
    v_cvt_pk_bf16_f32 v102, v104, v105
    v_cvt_pk_bf16_f32 v103, v106, v107
    v_cvt_pk_bf16_f32 v104, v108, v109
    v_mfma_f32_16x16x32_bf16 v[184:187], a[204:207], v[56:59], 0
    ds_read_b128 v[36:39], v2 offset:37888
    v_cvt_pk_bf16_f32 v105, v110, v111
    ds_write_b128 v12, v[100:103] offset:25600
    v_mfma_f32_16x16x32_bf16 v[24:27], a[252:255], a[240:243], 0
    ds_read_b128 v[40:43], v2 offset:39936
    ds_write_b64 v13, v[104:105] offset:25600
    v_accvgpr_read_b32 v64, a0
    v_mfma_f32_16x16x32_bf16 v[196:199], a[204:207], v[60:63], 0
    ds_read_b128 v[44:47], v15 offset:41984
    v_accvgpr_read_b32 v65, a1
    v_accvgpr_read_b32 v66, a2
    v_mfma_f32_16x16x32_bf16 v[28:31], a[252:255], a[244:247], 0
    buffer_load_dwordx4 a[204:207], v6, s[16:19], s54 offen offset:0
    v_accvgpr_read_b32 v67, a3
    v_accvgpr_read_b32 v68, a4
    v_mfma_f32_16x16x32_bf16 v[164:167], a[208:211], v[48:51], 0
    ds_read_b64_tr_b16 a[248:249], v4 offset:32128
    v_accvgpr_read_b32 v69, a5
    v_accvgpr_read_b32 v70, a6
    v_mfma_f32_16x16x32_bf16 v[176:179], a[208:211], v[52:55], 0
    ds_read_b64_tr_b16 a[250:251], v4 offset:35328
    v_cvt_pk_bf16_f32 v24, v24, v25
    v_accvgpr_read_b32 v71, a7
    v_accvgpr_read_b32 v72, a8
    v_mfma_f32_16x16x32_bf16 v[188:191], a[208:211], v[56:59], 0
    v_cvt_pk_bf16_f32 v25, v26, v27
    v_cvt_pk_bf16_f32 v28, v28, v29
    v_accvgpr_read_b32 v73, a9
    v_accvgpr_read_b32 v74, a10
    v_mfma_f32_16x16x32_bf16 v[200:203], a[208:211], v[60:63], 0
    ds_write_b64 v3, v[24:25] offset:1024
    v_accvgpr_read_b32 v75, a11
    v_accvgpr_read_b32 v76, a12
    v_mfma_f32_16x16x32_bf16 v[168:171], a[212:215], v[48:51], 0
    v_cvt_pk_bf16_f32 v29, v30, v31
    v_accvgpr_read_b32 v77, a13
    v_accvgpr_read_b32 v78, a14
    v_mfma_f32_16x16x32_bf16 v[180:183], a[212:215], v[52:55], 0
    buffer_load_dwordx4 a[208:211], v6, s[16:19], s54 offen offset:1024
    v_accvgpr_read_b32 v79, a15
    v_accvgpr_read_b32 v80, a16
    v_mfma_f32_16x16x32_bf16 v[192:195], a[212:215], v[56:59], 0
    ds_write_b64 v3, v[28:29] offset:15360
    v_accvgpr_read_b32 v81, a17
    v_accvgpr_read_b32 v82, a18
    v_mfma_f32_16x16x32_bf16 v[204:207], a[212:215], v[60:63], 0
    v_accvgpr_read_b32 v83, a19
    v_accvgpr_read_b32 v84, a20
    s_waitcnt vmcnt(8) lgkmcnt(2)
    v_mfma_f32_16x16x32_bf16 v[112:115], a[216:219], v[32:35], v[112:115]
    buffer_load_dwordx4 a[212:215], v6, s[16:19], s54 offen offset:2048
    v_accvgpr_read_b32 v85, a21
    v_accvgpr_read_b32 v86, a22
    v_accvgpr_read_b32 v87, a23
    v_accvgpr_read_b32 v88, a24
    v_mfma_f32_16x16x32_bf16 v[124:127], a[216:219], v[36:39], v[124:127]
    ds_read_b128 v[48:51], v2 offset:43008
    s_mov_b32 s54, 968448
    v_accvgpr_read_b32 v89, a25
    v_accvgpr_read_b32 v90, a26
    v_accvgpr_read_b32 v91, a27
    v_accvgpr_read_b32 v92, a28
    v_mfma_f32_16x16x32_bf16 v[136:139], a[216:219], v[40:43], v[136:139]
    ds_read_b128 v[52:55], v2 offset:45056
    v_accvgpr_read_b32 v93, a29
    v_accvgpr_read_b32 v94, a30
    v_accvgpr_read_b32 v95, a31
    v_accvgpr_read_b32 v96, a32
    v_mfma_f32_16x16x32_bf16 v[24:27], a[248:251], a[240:243], 0
    ds_read_b128 v[56:59], v2 offset:47104
    v_accvgpr_read_b32 v97, a33
    v_accvgpr_read_b32 v98, a34
    v_accvgpr_read_b32 v99, a35
    v_accvgpr_read_b32 v100, a36
    v_mfma_f32_16x16x32_bf16 v[148:151], a[216:219], v[44:47], v[148:151]
    ds_read_b128 v[60:63], v15 offset:49152
    v_accvgpr_read_b32 v101, a37
    v_accvgpr_read_b32 v102, a38
    v_accvgpr_read_b32 v103, a39
    v_accvgpr_read_b32 v104, a40
    v_mfma_f32_16x16x32_bf16 v[28:31], a[248:251], a[244:247], 0
    buffer_load_dwordx4 a[216:219], v6, s[16:19], s54 offen offset:0
    v_accvgpr_read_b32 v105, a41
    v_accvgpr_read_b32 v106, a42
    v_accvgpr_read_b32 v107, a43
    v_accvgpr_read_b32 v108, a44
    v_mfma_f32_16x16x32_bf16 v[116:119], a[220:223], v[32:35], v[116:119]
    ds_read_b64_tr_b16 a[252:253], v4 offset:44928
    v_accvgpr_read_b32 v109, a45
    v_accvgpr_read_b32 v110, a46
    v_accvgpr_read_b32 v111, a47
    v_cvt_pk_bf16_f32 v208, -v208, -v209
    v_mfma_f32_16x16x32_bf16 v[128:131], a[220:223], v[36:39], v[128:131]
    ds_read_b64_tr_b16 a[254:255], v4 offset:48128
    v_cvt_pk_bf16_f32 v24, v24, v25
    v_cvt_pk_bf16_f32 v209, -v210, -v211
    v_cvt_pk_bf16_f32 v210, -v212, -v213
    v_cvt_pk_bf16_f32 v211, -v214, -v215
    v_cvt_pk_bf16_f32 v212, -v216, -v217
    v_mfma_f32_16x16x32_bf16 v[140:143], a[220:223], v[40:43], v[140:143]
    v_cvt_pk_bf16_f32 v25, v26, v27
    v_cvt_pk_bf16_f32 v28, v28, v29
    v_cvt_pk_bf16_f32 v213, -v218, -v219
    ds_write_b128 v7, v[208:211] offset:384
    ds_write_b64 v8, v[212:213] offset:384
    v_cvt_pk_bf16_f32 v220, -v220, -v221
    v_mfma_f32_16x16x32_bf16 v[152:155], a[220:223], v[44:47], v[152:155]
    ds_write_b64 v3, v[24:25] offset:2048
    v_cvt_pk_bf16_f32 v221, -v222, -v223
    v_cvt_pk_bf16_f32 v222, -v224, -v225
    v_cvt_pk_bf16_f32 v223, -v226, -v227
    v_cvt_pk_bf16_f32 v224, -v228, -v229
    v_mfma_f32_16x16x32_bf16 v[120:123], a[224:227], v[32:35], v[120:123]
    v_cvt_pk_bf16_f32 v29, v30, v31
    v_cvt_pk_bf16_f32 v225, -v230, -v231
    ds_write_b128 v7, v[220:223] offset:25984
    ds_write_b64 v8, v[224:225] offset:25984
    v_cvt_pk_bf16_f32 v232, -v232, -v233
    v_mfma_f32_16x16x32_bf16 v[132:135], a[224:227], v[36:39], v[132:135]
    buffer_load_dwordx4 a[220:223], v6, s[16:19], s54 offen offset:1024
    v_cvt_pk_bf16_f32 v233, -v234, -v235
    v_cvt_pk_bf16_f32 v234, -v236, -v237
    v_cvt_pk_bf16_f32 v235, -v238, -v239
    v_mfma_f32_16x16x32_bf16 v[144:147], a[224:227], v[40:43], v[144:147]
    ds_write_b64 v3, v[28:29] offset:16384
    v_cvt_pk_bf16_f32 v236, -v240, -v241
    v_cvt_pk_bf16_f32 v237, -v242, -v243
    ds_write_b128 v12, v[232:235] offset:384
    v_mfma_f32_16x16x32_bf16 v[156:159], a[224:227], v[44:47], v[156:159]
    ds_write_b64 v13, v[236:237] offset:384
    v_cvt_pk_bf16_f32 v244, -v244, -v245
    v_cvt_pk_bf16_f32 v245, -v246, -v247
    s_waitcnt vmcnt(8) lgkmcnt(8)
    v_mfma_f32_16x16x32_bf16 v[160:163], a[228:231], v[48:51], v[160:163]
    buffer_load_dwordx4 a[224:227], v6, s[16:19], s54 offen offset:2048
    v_mfma_f32_16x16x32_bf16 v[172:175], a[228:231], v[52:55], v[172:175]
    ds_read_b128 v[32:35], v1 offset:28672
    s_mov_b32 s54, 980864
    v_cvt_pk_bf16_f32 v246, -v248, -v249
    v_cvt_pk_bf16_f32 v247, -v250, -v251
    v_cvt_pk_bf16_f32 v248, -v252, -v253
    v_mfma_f32_16x16x32_bf16 v[184:187], a[228:231], v[56:59], v[184:187]
    ds_read_b128 v[36:39], v1 offset:30720
    v_cvt_pk_bf16_f32 v249, -v254, -v255
    ds_write_b128 v12, v[244:247] offset:25984
    v_mfma_f32_16x16x32_bf16 v[24:27], a[252:255], a[240:243], 0
    ds_read_b128 v[40:43], v1 offset:32768
    ds_write_b64 v13, v[248:249] offset:25984
    v_accvgpr_read_b32 v208, a48
    v_mfma_f32_16x16x32_bf16 v[196:199], a[228:231], v[60:63], v[196:199]
    ds_read_b128 v[44:47], v14 offset:34816
    v_accvgpr_read_b32 v209, a49
    v_accvgpr_read_b32 v210, a50
    v_mfma_f32_16x16x32_bf16 v[28:31], a[252:255], a[244:247], 0
    buffer_load_dwordx4 a[228:231], v6, s[16:19], s54 offen offset:0
    v_accvgpr_read_b32 v211, a51
    v_accvgpr_read_b32 v212, a52
    v_mfma_f32_16x16x32_bf16 v[164:167], a[232:235], v[48:51], v[164:167]
    ds_read_b64_tr_b16 a[248:249], v5 offset:6528
    v_accvgpr_read_b32 v213, a53
    v_accvgpr_read_b32 v214, a54
    v_mfma_f32_16x16x32_bf16 v[176:179], a[232:235], v[52:55], v[176:179]
    ds_read_b64_tr_b16 a[250:251], v5 offset:9728
    v_cvt_pk_bf16_f32 v24, v24, v25
    v_accvgpr_read_b32 v215, a55
    v_accvgpr_read_b32 v216, a56
    v_mfma_f32_16x16x32_bf16 v[188:191], a[232:235], v[56:59], v[188:191]
    v_cvt_pk_bf16_f32 v25, v26, v27
    v_cvt_pk_bf16_f32 v28, v28, v29
    v_accvgpr_read_b32 v217, a57
    v_accvgpr_read_b32 v218, a58
    v_mfma_f32_16x16x32_bf16 v[200:203], a[232:235], v[60:63], v[200:203]
    ds_write_b64 v3, v[24:25] offset:3072
    v_accvgpr_read_b32 v219, a59
    v_accvgpr_read_b32 v220, a60
    v_mfma_f32_16x16x32_bf16 v[168:171], a[236:239], v[48:51], v[168:171]
    v_cvt_pk_bf16_f32 v29, v30, v31
    v_accvgpr_read_b32 v221, a61
    v_accvgpr_read_b32 v222, a62
    v_mfma_f32_16x16x32_bf16 v[180:183], a[236:239], v[52:55], v[180:183]
    buffer_load_dwordx4 a[232:235], v6, s[16:19], s54 offen offset:1024
    v_accvgpr_read_b32 v223, a63
    v_accvgpr_read_b32 v224, a64
    v_mfma_f32_16x16x32_bf16 v[192:195], a[236:239], v[56:59], v[192:195]
    ds_write_b64 v3, v[28:29] offset:17408
    v_accvgpr_read_b32 v225, a65
    v_accvgpr_read_b32 v226, a66
    v_mfma_f32_16x16x32_bf16 v[204:207], a[236:239], v[60:63], v[204:207]
    v_accvgpr_read_b32 v227, a67
    v_accvgpr_read_b32 v228, a68
    s_waitcnt vmcnt(8) lgkmcnt(2)
    v_mfma_f32_16x16x32_bf16 v[64:67], a[192:195], v[32:35], v[64:67]
    buffer_load_dwordx4 a[236:239], v6, s[16:19], s54 offen offset:2048
    v_mfma_f32_16x16x32_bf16 v[76:79], a[192:195], v[36:39], v[76:79]
    ds_read_b128 v[48:51], v1 offset:50176
    s_mov_b32 s54, 993280
    v_accvgpr_read_b32 v229, a69
    v_accvgpr_read_b32 v230, a70
    v_accvgpr_read_b32 v231, a71
    v_mfma_f32_16x16x32_bf16 v[88:91], a[192:195], v[40:43], v[88:91]
    ds_read_b128 v[52:55], v1 offset:52224
    v_accvgpr_read_b32 v232, a72
    v_accvgpr_read_b32 v233, a73
    v_mfma_f32_16x16x32_bf16 v[24:27], a[248:251], a[240:243], 0
    ds_read_b128 v[56:59], v1 offset:54272
    v_accvgpr_read_b32 v234, a74
    v_accvgpr_read_b32 v235, a75
    v_mfma_f32_16x16x32_bf16 v[100:103], a[192:195], v[44:47], v[100:103]
    ds_read_b128 v[60:63], v14 offset:56320
    v_accvgpr_read_b32 v236, a76
    v_accvgpr_read_b32 v237, a77
    v_mfma_f32_16x16x32_bf16 v[28:31], a[248:251], a[244:247], 0
    buffer_load_dwordx4 a[192:195], v6, s[16:19], s54 offen offset:0
    v_accvgpr_read_b32 v238, a78
    v_accvgpr_read_b32 v239, a79
    v_mfma_f32_16x16x32_bf16 v[68:71], a[196:199], v[32:35], v[68:71]
    ds_read_b64_tr_b16 a[252:253], v5 offset:19328
    v_accvgpr_read_b32 v240, a80
    v_accvgpr_read_b32 v241, a81
    v_mfma_f32_16x16x32_bf16 v[80:83], a[196:199], v[36:39], v[80:83]
    ds_read_b64_tr_b16 a[254:255], v5 offset:22528
    v_cvt_pk_bf16_f32 v24, v24, v25
    v_accvgpr_read_b32 v242, a82
    v_accvgpr_read_b32 v243, a83
    v_mfma_f32_16x16x32_bf16 v[92:95], a[196:199], v[40:43], v[92:95]
    v_cvt_pk_bf16_f32 v25, v26, v27
    v_cvt_pk_bf16_f32 v28, v28, v29
    v_accvgpr_read_b32 v244, a84
    v_accvgpr_read_b32 v245, a85
    v_mfma_f32_16x16x32_bf16 v[104:107], a[196:199], v[44:47], v[104:107]
    ds_write_b64 v3, v[24:25] offset:4096
    v_accvgpr_read_b32 v246, a86
    v_accvgpr_read_b32 v247, a87
    v_mfma_f32_16x16x32_bf16 v[72:75], a[200:203], v[32:35], v[72:75]
    v_cvt_pk_bf16_f32 v29, v30, v31
    v_accvgpr_read_b32 v248, a88
    v_accvgpr_read_b32 v249, a89
    v_mfma_f32_16x16x32_bf16 v[84:87], a[200:203], v[36:39], v[84:87]
    buffer_load_dwordx4 a[196:199], v6, s[16:19], s54 offen offset:1024
    v_accvgpr_read_b32 v250, a90
    v_accvgpr_read_b32 v251, a91
    v_mfma_f32_16x16x32_bf16 v[96:99], a[200:203], v[40:43], v[96:99]
    ds_write_b64 v3, v[28:29] offset:18432
    v_accvgpr_read_b32 v252, a92
    v_accvgpr_read_b32 v253, a93
    v_mfma_f32_16x16x32_bf16 v[108:111], a[200:203], v[44:47], v[108:111]
    v_accvgpr_read_b32 v254, a94
    v_accvgpr_read_b32 v255, a95
    s_waitcnt vmcnt(8) lgkmcnt(2)
    v_mfma_f32_16x16x32_bf16 v[208:211], a[204:207], v[48:51], v[208:211]
    buffer_load_dwordx4 a[200:203], v6, s[16:19], s54 offen offset:2048
    v_mfma_f32_16x16x32_bf16 v[220:223], a[204:207], v[52:55], v[220:223]
    ds_read_b128 v[32:35], v2 offset:28672
    s_mov_b32 s54, 1005696
    v_mfma_f32_16x16x32_bf16 v[232:235], a[204:207], v[56:59], v[232:235]
    ds_read_b128 v[36:39], v2 offset:30720
    v_mfma_f32_16x16x32_bf16 v[24:27], a[252:255], a[240:243], 0
    ds_read_b128 v[40:43], v2 offset:32768
    v_mfma_f32_16x16x32_bf16 v[244:247], a[204:207], v[60:63], v[244:247]
    ds_read_b128 v[44:47], v15 offset:34816
    v_mfma_f32_16x16x32_bf16 v[28:31], a[252:255], a[244:247], 0
    buffer_load_dwordx4 a[204:207], v6, s[16:19], s54 offen offset:0
    v_mfma_f32_16x16x32_bf16 v[212:215], a[208:211], v[48:51], v[212:215]
    ds_read_b64_tr_b16 a[248:249], v5 offset:32128
    v_mfma_f32_16x16x32_bf16 v[224:227], a[208:211], v[52:55], v[224:227]
    ds_read_b64_tr_b16 a[250:251], v5 offset:35328
    v_cvt_pk_bf16_f32 v24, v24, v25
    v_mfma_f32_16x16x32_bf16 v[236:239], a[208:211], v[56:59], v[236:239]
    v_cvt_pk_bf16_f32 v25, v26, v27
    v_cvt_pk_bf16_f32 v28, v28, v29
    v_mfma_f32_16x16x32_bf16 v[248:251], a[208:211], v[60:63], v[248:251]
    ds_write_b64 v3, v[24:25] offset:5120
    v_mfma_f32_16x16x32_bf16 v[216:219], a[212:215], v[48:51], v[216:219]
    v_cvt_pk_bf16_f32 v29, v30, v31
    v_mfma_f32_16x16x32_bf16 v[228:231], a[212:215], v[52:55], v[228:231]
    buffer_load_dwordx4 a[208:211], v6, s[16:19], s54 offen offset:1024
    v_mfma_f32_16x16x32_bf16 v[240:243], a[212:215], v[56:59], v[240:243]
    ds_write_b64 v3, v[28:29] offset:19456
    v_mfma_f32_16x16x32_bf16 v[252:255], a[212:215], v[60:63], v[252:255]
    s_waitcnt vmcnt(8) lgkmcnt(2)
    v_mfma_f32_16x16x32_bf16 v[64:67], a[216:219], v[32:35], v[64:67]
    buffer_load_dwordx4 a[212:215], v6, s[16:19], s54 offen offset:2048
    v_mfma_f32_16x16x32_bf16 v[76:79], a[216:219], v[36:39], v[76:79]
    ds_read_b128 v[48:51], v2 offset:50176
    s_mov_b32 s54, 1018112
    v_mfma_f32_16x16x32_bf16 v[88:91], a[216:219], v[40:43], v[88:91]
    ds_read_b128 v[52:55], v2 offset:52224
    v_mfma_f32_16x16x32_bf16 v[24:27], a[248:251], a[240:243], 0
    ds_read_b128 v[56:59], v2 offset:54272
    v_mfma_f32_16x16x32_bf16 v[100:103], a[216:219], v[44:47], v[100:103]
    ds_read_b128 v[60:63], v15 offset:56320
    v_mfma_f32_16x16x32_bf16 v[28:31], a[248:251], a[244:247], 0
    buffer_load_dwordx4 a[216:219], v6, s[16:19], s54 offen offset:0
    v_mfma_f32_16x16x32_bf16 v[68:71], a[220:223], v[32:35], v[68:71]
    s_nop 0
    v_mfma_f32_16x16x32_bf16 v[80:83], a[220:223], v[36:39], v[80:83]
    s_nop 0
    v_cvt_pk_bf16_f32 v24, v24, v25
    v_mfma_f32_16x16x32_bf16 v[92:95], a[220:223], v[40:43], v[92:95]
    v_cvt_pk_bf16_f32 v25, v26, v27
    v_cvt_pk_bf16_f32 v28, v28, v29
    v_mfma_f32_16x16x32_bf16 v[104:107], a[220:223], v[44:47], v[104:107]
    ds_write_b64 v3, v[24:25] offset:6144
    v_mfma_f32_16x16x32_bf16 v[72:75], a[224:227], v[32:35], v[72:75]
    v_cvt_pk_bf16_f32 v29, v30, v31
    v_mfma_f32_16x16x32_bf16 v[84:87], a[224:227], v[36:39], v[84:87]
    buffer_load_dwordx4 a[220:223], v6, s[16:19], s54 offen offset:1024
    v_mfma_f32_16x16x32_bf16 v[96:99], a[224:227], v[40:43], v[96:99]
    ds_write_b64 v3, v[28:29] offset:20480
    v_mfma_f32_16x16x32_bf16 v[108:111], a[224:227], v[44:47], v[108:111]
    s_waitcnt vmcnt(8) lgkmcnt(2)
    v_mfma_f32_16x16x32_bf16 v[208:211], a[228:231], v[48:51], v[208:211]
    buffer_load_dwordx4 a[224:227], v6, s[16:19], s54 offen offset:2048
    v_mfma_f32_16x16x32_bf16 v[220:223], a[228:231], v[52:55], v[220:223]
    s_mov_b32 s54, 1030528
    v_mfma_f32_16x16x32_bf16 v[232:235], a[228:231], v[56:59], v[232:235]
    s_waitcnt lgkmcnt(0)
    s_barrier
    v_mfma_f32_16x16x32_bf16 v[244:247], a[228:231], v[60:63], v[244:247]
    buffer_load_dwordx4 a[228:231], v6, s[16:19], s54 offen offset:0
    v_mfma_f32_16x16x32_bf16 v[212:215], a[232:235], v[48:51], v[212:215]
    ds_read_b128 v[32:35], v1 offset:7168
    v_mfma_f32_16x16x32_bf16 v[224:227], a[232:235], v[52:55], v[224:227]
    ds_read_b128 v[36:39], v1 offset:9216
    v_mfma_f32_16x16x32_bf16 v[236:239], a[232:235], v[56:59], v[236:239]
    ds_read_b128 v[40:43], v1 offset:11264
    v_mfma_f32_16x16x32_bf16 v[248:251], a[232:235], v[60:63], v[248:251]
    ds_read_b128 v[44:47], v14 offset:13312
    v_mfma_f32_16x16x32_bf16 v[216:219], a[236:239], v[48:51], v[216:219]
    buffer_load_dwordx4 a[232:235], v6, s[16:19], s54 offen offset:1024
    v_mfma_f32_16x16x32_bf16 v[228:231], a[236:239], v[52:55], v[228:231]
    ds_read_b64_tr_b16 a[248:249], v4 offset:6656
    v_mfma_f32_16x16x32_bf16 v[240:243], a[236:239], v[56:59], v[240:243]
    ds_read_b64_tr_b16 a[250:251], v4 offset:9856
    v_mfma_f32_16x16x32_bf16 v[252:255], a[236:239], v[60:63], v[252:255]
    s_waitcnt vmcnt(8) lgkmcnt(0)
    v_mfma_f32_16x16x32_bf16 v[112:115], a[192:195], v[32:35], v[112:115]
    buffer_load_dwordx4 a[236:239], v6, s[16:19], s54 offen offset:2048
    v_mfma_f32_16x16x32_bf16 v[124:127], a[192:195], v[36:39], v[124:127]
    ds_read_b128 v[48:51], v1 offset:14336
    s_mov_b32 s54, 1042944
    ds_read_b128 a[96:99], v9 offset:0
    v_mfma_f32_16x16x32_bf16 v[136:139], a[192:195], v[40:43], v[136:139]
    ds_read_b128 v[52:55], v1 offset:16384
    ds_read_b128 a[100:103], v9 offset:3136
    v_mfma_f32_16x16x32_bf16 v[24:27], a[248:251], a[240:243], 0
    ds_read_b128 v[56:59], v1 offset:18432
    v_mfma_f32_16x16x32_bf16 v[148:151], a[192:195], v[44:47], v[148:151]
    ds_read_b128 v[60:63], v14 offset:20480
    v_mfma_f32_16x16x32_bf16 v[28:31], a[248:251], a[244:247], 0
    buffer_load_dwordx4 a[192:195], v6, s[16:19], s54 offen offset:0
    v_mfma_f32_16x16x32_bf16 v[116:119], a[196:199], v[32:35], v[116:119]
    ds_read_b64_tr_b16 a[252:253], v4 offset:19456
    v_mfma_f32_16x16x32_bf16 v[128:131], a[196:199], v[36:39], v[128:131]
    ds_read_b64_tr_b16 a[254:255], v4 offset:22656
    v_cvt_pk_bf16_f32 v24, v24, v25
    v_mfma_f32_16x16x32_bf16 v[140:143], a[196:199], v[40:43], v[140:143]
    v_cvt_pk_bf16_f32 v25, v26, v27
    v_cvt_pk_bf16_f32 v28, v28, v29
    v_mfma_f32_16x16x32_bf16 v[152:155], a[196:199], v[44:47], v[152:155]
    ds_write_b64 v3, v[24:25] offset:28672
    v_mfma_f32_16x16x32_bf16 v[120:123], a[200:203], v[32:35], v[120:123]
    v_cvt_pk_bf16_f32 v29, v30, v31
    v_mfma_f32_16x16x32_bf16 v[132:135], a[200:203], v[36:39], v[132:135]
    buffer_load_dwordx4 a[196:199], v6, s[16:19], s54 offen offset:1024
    v_mfma_f32_16x16x32_bf16 v[144:147], a[200:203], v[40:43], v[144:147]
    ds_write_b64 v3, v[28:29] offset:43008
    v_mfma_f32_16x16x32_bf16 v[156:159], a[200:203], v[44:47], v[156:159]
    s_waitcnt vmcnt(8) lgkmcnt(2)
    v_mfma_f32_16x16x32_bf16 v[160:163], a[204:207], v[48:51], v[160:163]
    buffer_load_dwordx4 a[200:203], v6, s[16:19], s54 offen offset:2048
    v_mfma_f32_16x16x32_bf16 v[172:175], a[204:207], v[52:55], v[172:175]
    ds_read_b128 v[32:35], v2 offset:7168
    s_mov_b32 s54, 1055360
    s_mov_b32 s35, 0
    v_mfma_f32_16x16x32_bf16 v[184:187], a[204:207], v[56:59], v[184:187]
    ds_read_b128 v[36:39], v2 offset:9216
    v_mfma_f32_16x16x32_bf16 v[24:27], a[252:255], a[240:243], 0
    ds_read_b128 v[40:43], v2 offset:11264
    buffer_store_dwordx4 a[96:99], v10, s[20:23], s35 offen sc0 sc1
    v_mfma_f32_16x16x32_bf16 v[196:199], a[204:207], v[60:63], v[196:199]
    ds_read_b128 v[44:47], v15 offset:13312
    s_add_u32 s35, s35, s45
    v_mfma_f32_16x16x32_bf16 v[28:31], a[252:255], a[244:247], 0
    buffer_load_dwordx4 a[204:207], v6, s[16:19], s54 offen offset:0
    v_mfma_f32_16x16x32_bf16 v[164:167], a[208:211], v[48:51], v[164:167]
    ds_read_b64_tr_b16 a[248:249], v4 offset:32256
    buffer_store_dwordx4 a[100:103], v10, s[20:23], s35 offen sc0 sc1
    v_mfma_f32_16x16x32_bf16 v[176:179], a[208:211], v[52:55], v[176:179]
    ds_read_b64_tr_b16 a[250:251], v4 offset:35456
    v_cvt_pk_bf16_f32 v24, v24, v25
    ds_read_b128 a[104:107], v9 offset:12800
    v_mfma_f32_16x16x32_bf16 v[188:191], a[208:211], v[56:59], v[188:191]
    v_cvt_pk_bf16_f32 v25, v26, v27
    v_cvt_pk_bf16_f32 v28, v28, v29
    v_mfma_f32_16x16x32_bf16 v[200:203], a[208:211], v[60:63], v[200:203]
    ds_write_b64 v3, v[24:25] offset:29696
    v_mfma_f32_16x16x32_bf16 v[168:171], a[212:215], v[48:51], v[168:171]
    v_cvt_pk_bf16_f32 v29, v30, v31
    v_mfma_f32_16x16x32_bf16 v[180:183], a[212:215], v[52:55], v[180:183]
    buffer_load_dwordx4 a[208:211], v6, s[16:19], s54 offen offset:1024
    v_mfma_f32_16x16x32_bf16 v[192:195], a[212:215], v[56:59], v[192:195]
    ds_write_b64 v3, v[28:29] offset:44032
    v_mfma_f32_16x16x32_bf16 v[204:207], a[212:215], v[60:63], v[204:207]
    s_waitcnt vmcnt(10) lgkmcnt(3)
    v_mfma_f32_16x16x32_bf16 v[112:115], a[216:219], v[32:35], v[112:115]
    buffer_load_dwordx4 a[212:215], v6, s[16:19], s54 offen offset:2048
    v_mfma_f32_16x16x32_bf16 v[124:127], a[216:219], v[36:39], v[124:127]
    ds_read_b128 v[48:51], v2 offset:14336
    s_mov_b32 s54, 1067776
    s_mov_b32 s35, 172032
    v_mfma_f32_16x16x32_bf16 v[136:139], a[216:219], v[40:43], v[136:139]
    ds_read_b128 v[52:55], v2 offset:16384
    s_waitcnt lgkmcnt(4)
    v_mfma_f32_16x16x32_bf16 v[24:27], a[248:251], a[240:243], 0
    ds_read_b128 v[56:59], v2 offset:18432
    buffer_store_dwordx4 a[104:107], v10, s[20:23], s35 offen sc0 sc1
    v_mfma_f32_16x16x32_bf16 v[148:151], a[216:219], v[44:47], v[148:151]
    ds_read_b128 v[60:63], v15 offset:20480
    ds_read_b128 a[108:111], v9 offset:15936
    v_mfma_f32_16x16x32_bf16 v[28:31], a[248:251], a[244:247], 0
    buffer_load_dwordx4 a[216:219], v6, s[16:19], s54 offen offset:0
    ds_read_b128 a[112:115], v9 offset:25600
    v_mfma_f32_16x16x32_bf16 v[116:119], a[220:223], v[32:35], v[116:119]
    ds_read_b64_tr_b16 a[252:253], v4 offset:45056
    v_mfma_f32_16x16x32_bf16 v[128:131], a[220:223], v[36:39], v[128:131]
    ds_read_b64_tr_b16 a[254:255], v4 offset:48256
    v_cvt_pk_bf16_f32 v24, v24, v25
    v_mfma_f32_16x16x32_bf16 v[140:143], a[220:223], v[40:43], v[140:143]
    v_cvt_pk_bf16_f32 v25, v26, v27
    v_cvt_pk_bf16_f32 v28, v28, v29
    v_mfma_f32_16x16x32_bf16 v[152:155], a[220:223], v[44:47], v[152:155]
    ds_write_b64 v3, v[24:25] offset:30720
    v_mfma_f32_16x16x32_bf16 v[120:123], a[224:227], v[32:35], v[120:123]
    v_cvt_pk_bf16_f32 v29, v30, v31
    v_mfma_f32_16x16x32_bf16 v[132:135], a[224:227], v[36:39], v[132:135]
    buffer_load_dwordx4 a[220:223], v6, s[16:19], s54 offen offset:1024
    v_mfma_f32_16x16x32_bf16 v[144:147], a[224:227], v[40:43], v[144:147]
    ds_write_b64 v3, v[28:29] offset:45056
    v_mfma_f32_16x16x32_bf16 v[156:159], a[224:227], v[44:47], v[156:159]
    s_waitcnt vmcnt(11) lgkmcnt(2)
    v_mfma_f32_16x16x32_bf16 v[160:163], a[228:231], v[48:51], v[160:163]
    buffer_load_dwordx4 a[224:227], v6, s[16:19], s54 offen offset:2048
    v_mfma_f32_16x16x32_bf16 v[172:175], a[228:231], v[52:55], v[172:175]
    ds_read_b128 v[32:35], v1 offset:0
    s_mov_b32 s54, 1080192
    s_add_u32 s35, s35, s45
    v_mfma_f32_16x16x32_bf16 v[184:187], a[228:231], v[56:59], v[184:187]
    ds_read_b128 v[36:39], v1 offset:2048
    v_mfma_f32_16x16x32_bf16 v[24:27], a[252:255], a[240:243], 0
    ds_read_b128 v[40:43], v1 offset:4096
    buffer_store_dwordx4 a[108:111], v10, s[20:23], s35 offen sc0 sc1
    v_mfma_f32_16x16x32_bf16 v[196:199], a[228:231], v[60:63], v[196:199]
    ds_read_b128 v[44:47], v14 offset:6144
    s_mov_b32 s35, 344064
    v_mfma_f32_16x16x32_bf16 v[28:31], a[252:255], a[244:247], 0
    buffer_load_dwordx4 a[228:231], v6, s[16:19], s54 offen offset:0
    v_mfma_f32_16x16x32_bf16 v[164:167], a[232:235], v[48:51], v[164:167]
    ds_read_b64_tr_b16 a[248:249], v5 offset:6656
    buffer_store_dwordx4 a[112:115], v10, s[20:23], s35 offen sc0 sc1
    v_mfma_f32_16x16x32_bf16 v[176:179], a[232:235], v[52:55], v[176:179]
    ds_read_b64_tr_b16 a[250:251], v5 offset:9856
    v_cvt_pk_bf16_f32 v24, v24, v25
    ds_read_b128 a[116:119], v9 offset:28736
    v_mfma_f32_16x16x32_bf16 v[188:191], a[232:235], v[56:59], v[188:191]
    v_cvt_pk_bf16_f32 v25, v26, v27
    v_cvt_pk_bf16_f32 v28, v28, v29
    v_mfma_f32_16x16x32_bf16 v[200:203], a[232:235], v[60:63], v[200:203]
    ds_write_b64 v3, v[24:25] offset:31744
    v_mfma_f32_16x16x32_bf16 v[168:171], a[236:239], v[48:51], v[168:171]
    v_cvt_pk_bf16_f32 v29, v30, v31
    v_mfma_f32_16x16x32_bf16 v[180:183], a[236:239], v[52:55], v[180:183]
    buffer_load_dwordx4 a[232:235], v6, s[16:19], s54 offen offset:1024
    v_mfma_f32_16x16x32_bf16 v[192:195], a[236:239], v[56:59], v[192:195]
    ds_write_b64 v3, v[28:29] offset:46080
    v_mfma_f32_16x16x32_bf16 v[204:207], a[236:239], v[60:63], v[204:207]
    s_waitcnt vmcnt(13) lgkmcnt(3)
    v_mfma_f32_16x16x32_bf16 v[64:67], a[192:195], v[32:35], v[64:67]
    buffer_load_dwordx4 a[236:239], v6, s[16:19], s54 offen offset:2048
    v_mfma_f32_16x16x32_bf16 v[76:79], a[192:195], v[36:39], v[76:79]
    ds_read_b128 v[48:51], v1 offset:21504
    s_mov_b32 s54, 1092608
    s_add_u32 s35, s35, s45
    v_mfma_f32_16x16x32_bf16 v[88:91], a[192:195], v[40:43], v[88:91]
    ds_read_b128 v[52:55], v1 offset:23552
    s_waitcnt lgkmcnt(4)
    v_mfma_f32_16x16x32_bf16 v[24:27], a[248:251], a[240:243], 0
    ds_read_b128 v[56:59], v1 offset:25600
    buffer_store_dwordx4 a[116:119], v10, s[20:23], s35 offen sc0 sc1
    v_mfma_f32_16x16x32_bf16 v[100:103], a[192:195], v[44:47], v[100:103]
    ds_read_b128 v[60:63], v14 offset:27648
    ds_read_b128 a[120:123], v9 offset:38400
    v_mfma_f32_16x16x32_bf16 v[28:31], a[248:251], a[244:247], 0
    buffer_load_dwordx4 a[192:195], v6, s[16:19], s54 offen offset:0
    v_mfma_f32_16x16x32_bf16 v[68:71], a[196:199], v[32:35], v[68:71]
    ds_read_b64_tr_b16 a[252:253], v5 offset:19456
    v_mfma_f32_16x16x32_bf16 v[80:83], a[196:199], v[36:39], v[80:83]
    ds_read_b64_tr_b16 a[254:255], v5 offset:22656
    v_cvt_pk_bf16_f32 v24, v24, v25
    v_mfma_f32_16x16x32_bf16 v[92:95], a[196:199], v[40:43], v[92:95]
    v_cvt_pk_bf16_f32 v25, v26, v27
    v_cvt_pk_bf16_f32 v28, v28, v29
    v_mfma_f32_16x16x32_bf16 v[104:107], a[196:199], v[44:47], v[104:107]
    ds_write_b64 v3, v[24:25] offset:32768
    v_mfma_f32_16x16x32_bf16 v[72:75], a[200:203], v[32:35], v[72:75]
    v_cvt_pk_bf16_f32 v29, v30, v31
    v_mfma_f32_16x16x32_bf16 v[84:87], a[200:203], v[36:39], v[84:87]
    buffer_load_dwordx4 a[196:199], v6, s[16:19], s54 offen offset:1024
    v_mfma_f32_16x16x32_bf16 v[96:99], a[200:203], v[40:43], v[96:99]
    ds_write_b64 v3, v[28:29] offset:47104
    v_mfma_f32_16x16x32_bf16 v[108:111], a[200:203], v[44:47], v[108:111]
    s_waitcnt vmcnt(12) lgkmcnt(2)
    v_mfma_f32_16x16x32_bf16 v[208:211], a[204:207], v[48:51], v[208:211]
    buffer_load_dwordx4 a[200:203], v6, s[16:19], s54 offen offset:2048
    v_mfma_f32_16x16x32_bf16 v[220:223], a[204:207], v[52:55], v[220:223]
    ds_read_b128 v[32:35], v2 offset:0
    s_mov_b32 s54, 1105024
    s_mov_b32 s35, 516096
    v_mfma_f32_16x16x32_bf16 v[232:235], a[204:207], v[56:59], v[232:235]
    ds_read_b128 v[36:39], v2 offset:2048
    v_mfma_f32_16x16x32_bf16 v[24:27], a[252:255], a[240:243], 0
    ds_read_b128 v[40:43], v2 offset:4096
    buffer_store_dwordx4 a[120:123], v10, s[20:23], s35 offen sc0 sc1
    v_mfma_f32_16x16x32_bf16 v[244:247], a[204:207], v[60:63], v[244:247]
    ds_read_b128 v[44:47], v15 offset:6144
    ds_read_b128 a[124:127], v9 offset:41536
    v_mfma_f32_16x16x32_bf16 v[28:31], a[252:255], a[244:247], 0
    buffer_load_dwordx4 a[204:207], v6, s[16:19], s54 offen offset:0
    ds_read_b128 a[128:131], v16 offset:0
    v_mfma_f32_16x16x32_bf16 v[212:215], a[208:211], v[48:51], v[212:215]
    ds_read_b64_tr_b16 a[248:249], v5 offset:32256
    v_mfma_f32_16x16x32_bf16 v[224:227], a[208:211], v[52:55], v[224:227]
    ds_read_b64_tr_b16 a[250:251], v5 offset:35456
    v_cvt_pk_bf16_f32 v24, v24, v25
    v_mfma_f32_16x16x32_bf16 v[236:239], a[208:211], v[56:59], v[236:239]
    v_cvt_pk_bf16_f32 v25, v26, v27
    v_cvt_pk_bf16_f32 v28, v28, v29
    v_mfma_f32_16x16x32_bf16 v[248:251], a[208:211], v[60:63], v[248:251]
    ds_write_b64 v3, v[24:25] offset:33792
    v_mfma_f32_16x16x32_bf16 v[216:219], a[212:215], v[48:51], v[216:219]
    v_cvt_pk_bf16_f32 v29, v30, v31
    v_mfma_f32_16x16x32_bf16 v[228:231], a[212:215], v[52:55], v[228:231]
    buffer_load_dwordx4 a[208:211], v6, s[16:19], s54 offen offset:1024
    v_mfma_f32_16x16x32_bf16 v[240:243], a[212:215], v[56:59], v[240:243]
    ds_write_b64 v3, v[28:29] offset:48128
    v_mfma_f32_16x16x32_bf16 v[252:255], a[212:215], v[60:63], v[252:255]
    s_waitcnt vmcnt(12) lgkmcnt(2)
    v_mfma_f32_16x16x32_bf16 v[64:67], a[216:219], v[32:35], v[64:67]
    buffer_load_dwordx4 a[212:215], v6, s[16:19], s54 offen offset:2048
    v_mfma_f32_16x16x32_bf16 v[76:79], a[216:219], v[36:39], v[76:79]
    ds_read_b128 v[48:51], v2 offset:21504
    s_mov_b32 s54, 1117440
    s_add_u32 s35, s35, s45
    v_mfma_f32_16x16x32_bf16 v[88:91], a[216:219], v[40:43], v[88:91]
    ds_read_b128 v[52:55], v2 offset:23552
    v_mfma_f32_16x16x32_bf16 v[24:27], a[248:251], a[240:243], 0
    ds_read_b128 v[56:59], v2 offset:25600
    buffer_store_dwordx4 a[124:127], v10, s[20:23], s35 offen sc0 sc1
    v_mfma_f32_16x16x32_bf16 v[100:103], a[216:219], v[44:47], v[100:103]
    ds_read_b128 v[60:63], v15 offset:27648
    s_mov_b32 s35, 688128
    v_mfma_f32_16x16x32_bf16 v[28:31], a[248:251], a[244:247], 0
    buffer_load_dwordx4 a[216:219], v6, s[16:19], s54 offen offset:0
    v_mfma_f32_16x16x32_bf16 v[68:71], a[220:223], v[32:35], v[68:71]
    s_nop 0
    buffer_store_dwordx4 a[128:131], v10, s[20:23], s35 offen sc0 sc1
    v_mfma_f32_16x16x32_bf16 v[80:83], a[220:223], v[36:39], v[80:83]
    s_nop 0
    v_cvt_pk_bf16_f32 v24, v24, v25
    ds_read_b128 a[132:135], v16 offset:3136
    v_mfma_f32_16x16x32_bf16 v[92:95], a[220:223], v[40:43], v[92:95]
    v_cvt_pk_bf16_f32 v25, v26, v27
    v_cvt_pk_bf16_f32 v28, v28, v29
    v_mfma_f32_16x16x32_bf16 v[104:107], a[220:223], v[44:47], v[104:107]
    ds_write_b64 v3, v[24:25] offset:34816
    v_mfma_f32_16x16x32_bf16 v[72:75], a[224:227], v[32:35], v[72:75]
    v_cvt_pk_bf16_f32 v29, v30, v31
    v_mfma_f32_16x16x32_bf16 v[84:87], a[224:227], v[36:39], v[84:87]
    buffer_load_dwordx4 a[220:223], v6, s[16:19], s54 offen offset:1024
    v_mfma_f32_16x16x32_bf16 v[96:99], a[224:227], v[40:43], v[96:99]
    ds_write_b64 v3, v[28:29] offset:49152
    v_mfma_f32_16x16x32_bf16 v[108:111], a[224:227], v[44:47], v[108:111]
    s_waitcnt vmcnt(12) lgkmcnt(3)
    v_mfma_f32_16x16x32_bf16 v[208:211], a[228:231], v[48:51], v[208:211]
    buffer_load_dwordx4 a[224:227], v6, s[16:19], s54 offen offset:2048
    v_mfma_f32_16x16x32_bf16 v[220:223], a[228:231], v[52:55], v[220:223]
    s_mov_b32 s54, 1129856
    s_add_u32 s35, s35, s45
    v_mfma_f32_16x16x32_bf16 v[232:235], a[228:231], v[56:59], v[232:235]
    s_waitcnt lgkmcnt(0)
    s_barrier
    v_mfma_f32_16x16x32_bf16 v[244:247], a[228:231], v[60:63], v[244:247]
    buffer_load_dwordx4 a[228:231], v6, s[16:19], s54 offen offset:0
    buffer_store_dwordx4 a[132:135], v10, s[20:23], s35 offen sc0 sc1
    v_mfma_f32_16x16x32_bf16 v[212:215], a[232:235], v[48:51], v[212:215]
    ds_read_b128 v[32:35], v1 offset:35840
    ds_read_b128 a[136:139], v16 offset:12800
    v_mfma_f32_16x16x32_bf16 v[224:227], a[232:235], v[52:55], v[224:227]
    ds_read_b128 v[36:39], v1 offset:37888
    ds_read_b128 a[140:143], v16 offset:15936
    v_mfma_f32_16x16x32_bf16 v[236:239], a[232:235], v[56:59], v[236:239]
    ds_read_b128 v[40:43], v1 offset:39936
    v_mfma_f32_16x16x32_bf16 v[248:251], a[232:235], v[60:63], v[248:251]
    ds_read_b128 v[44:47], v14 offset:41984
    v_mfma_f32_16x16x32_bf16 v[216:219], a[236:239], v[48:51], v[216:219]
    buffer_load_dwordx4 a[232:235], v6, s[16:19], s54 offen offset:1024
    v_mfma_f32_16x16x32_bf16 v[228:231], a[236:239], v[52:55], v[228:231]
    v_mfma_f32_16x16x32_bf16 v[240:243], a[236:239], v[56:59], v[240:243]
    v_mfma_f32_16x16x32_bf16 v[252:255], a[236:239], v[60:63], v[252:255]
    s_waitcnt vmcnt(12) lgkmcnt(0)
    v_mfma_f32_16x16x32_bf16 v[112:115], a[192:195], v[32:35], v[112:115]
    buffer_load_dwordx4 a[236:239], v6, s[16:19], s54 offen offset:2048
    v_mfma_f32_16x16x32_bf16 v[124:127], a[192:195], v[36:39], v[124:127]
    ds_read_b128 v[48:51], v1 offset:43008
    s_mov_b32 s54, 1142272
    s_mov_b32 s35, 860160
    v_mfma_f32_16x16x32_bf16 v[136:139], a[192:195], v[40:43], v[136:139]
    ds_read_b128 v[52:55], v1 offset:45056
    v_mfma_f32_16x16x32_bf16 v[148:151], a[192:195], v[44:47], v[148:151]
    ds_read_b128 v[60:63], v14 offset:49152
    buffer_store_dwordx4 a[136:139], v10, s[20:23], s35 offen sc0 sc1
    v_mfma_f32_16x16x32_bf16 v[116:119], a[196:199], v[32:35], v[116:119]
    ds_read_b128 v[56:59], v1 offset:47104
    s_add_u32 s35, s35, s45
    v_mfma_f32_16x16x32_bf16 v[128:131], a[196:199], v[36:39], v[128:131]
    buffer_load_dwordx4 a[192:195], v6, s[16:19], s54 offen offset:0
    v_mfma_f32_16x16x32_bf16 v[140:143], a[196:199], v[40:43], v[140:143]
    buffer_store_dwordx4 a[140:143], v10, s[20:23], s35 offen sc0 sc1
    v_mfma_f32_16x16x32_bf16 v[152:155], a[196:199], v[44:47], v[152:155]
    ds_read_b128 a[144:147], v16 offset:25600
    v_mfma_f32_16x16x32_bf16 v[120:123], a[200:203], v[32:35], v[120:123]
    v_mfma_f32_16x16x32_bf16 v[132:135], a[200:203], v[36:39], v[132:135]
    buffer_load_dwordx4 a[196:199], v6, s[16:19], s54 offen offset:1024
    v_mfma_f32_16x16x32_bf16 v[144:147], a[200:203], v[40:43], v[144:147]
    v_mfma_f32_16x16x32_bf16 v[156:159], a[200:203], v[44:47], v[156:159]
    s_waitcnt vmcnt(13) lgkmcnt(1)
    v_mfma_f32_16x16x32_bf16 v[160:163], a[204:207], v[48:51], v[160:163]
    buffer_load_dwordx4 a[200:203], v6, s[16:19], s54 offen offset:2048
    v_mfma_f32_16x16x32_bf16 v[172:175], a[204:207], v[52:55], v[172:175]
    ds_read_b128 v[32:35], v2 offset:35840
    s_mov_b32 s54, 1154688
    s_mov_b32 s35, 1032192
    v_mfma_f32_16x16x32_bf16 v[184:187], a[204:207], v[56:59], v[184:187]
    ds_read_b128 v[36:39], v2 offset:37888
    s_waitcnt lgkmcnt(2)
    v_mfma_f32_16x16x32_bf16 v[196:199], a[204:207], v[60:63], v[196:199]
    ds_read_b128 v[44:47], v15 offset:41984
    buffer_store_dwordx4 a[144:147], v10, s[20:23], s35 offen sc0 sc1
    v_mfma_f32_16x16x32_bf16 v[164:167], a[208:211], v[48:51], v[164:167]
    ds_read_b128 v[40:43], v2 offset:39936
    ds_read_b128 a[148:151], v16 offset:28736
    v_mfma_f32_16x16x32_bf16 v[176:179], a[208:211], v[52:55], v[176:179]
    buffer_load_dwordx4 a[204:207], v6, s[16:19], s54 offen offset:0
    v_mfma_f32_16x16x32_bf16 v[188:191], a[208:211], v[56:59], v[188:191]
    v_mfma_f32_16x16x32_bf16 v[200:203], a[208:211], v[60:63], v[200:203]
    v_mfma_f32_16x16x32_bf16 v[168:171], a[212:215], v[48:51], v[168:171]
    v_mfma_f32_16x16x32_bf16 v[180:183], a[212:215], v[52:55], v[180:183]
    buffer_load_dwordx4 a[208:211], v6, s[16:19], s54 offen offset:1024
    v_mfma_f32_16x16x32_bf16 v[192:195], a[212:215], v[56:59], v[192:195]
    v_mfma_f32_16x16x32_bf16 v[204:207], a[212:215], v[60:63], v[204:207]
    s_waitcnt vmcnt(12) lgkmcnt(1)
    v_mfma_f32_16x16x32_bf16 v[112:115], a[216:219], v[32:35], v[112:115]
    buffer_load_dwordx4 a[212:215], v6, s[16:19], s54 offen offset:2048
    v_mfma_f32_16x16x32_bf16 v[124:127], a[216:219], v[36:39], v[124:127]
    ds_read_b128 v[48:51], v2 offset:43008
    s_mov_b32 s54, 1167104
    s_add_u32 s35, s35, s45
    v_mfma_f32_16x16x32_bf16 v[136:139], a[216:219], v[40:43], v[136:139]
    ds_read_b128 v[52:55], v2 offset:45056
    s_waitcnt lgkmcnt(2)
    v_mfma_f32_16x16x32_bf16 v[148:151], a[216:219], v[44:47], v[148:151]
    ds_read_b128 v[60:63], v15 offset:49152
    buffer_store_dwordx4 a[148:151], v10, s[20:23], s35 offen sc0 sc1
    v_mfma_f32_16x16x32_bf16 v[116:119], a[220:223], v[32:35], v[116:119]
    ds_read_b128 v[56:59], v2 offset:47104
    v_mfma_f32_16x16x32_bf16 v[128:131], a[220:223], v[36:39], v[128:131]
    buffer_load_dwordx4 a[216:219], v6, s[16:19], s54 offen offset:0
    v_mfma_f32_16x16x32_bf16 v[140:143], a[220:223], v[40:43], v[140:143]
    v_mfma_f32_16x16x32_bf16 v[152:155], a[220:223], v[44:47], v[152:155]
    v_mfma_f32_16x16x32_bf16 v[120:123], a[224:227], v[32:35], v[120:123]
    v_mfma_f32_16x16x32_bf16 v[132:135], a[224:227], v[36:39], v[132:135]
    buffer_load_dwordx4 a[220:223], v6, s[16:19], s54 offen offset:1024
    v_mfma_f32_16x16x32_bf16 v[144:147], a[224:227], v[40:43], v[144:147]
    v_mfma_f32_16x16x32_bf16 v[156:159], a[224:227], v[44:47], v[156:159]
    s_waitcnt vmcnt(12) lgkmcnt(0)
    v_mfma_f32_16x16x32_bf16 v[160:163], a[228:231], v[48:51], v[160:163]
    buffer_load_dwordx4 a[224:227], v6, s[16:19], s54 offen offset:2048
    v_mfma_f32_16x16x32_bf16 v[172:175], a[228:231], v[52:55], v[172:175]
    ds_read_b128 v[32:35], v1 offset:28672
    s_mov_b32 s54, 1179520
    v_mfma_f32_16x16x32_bf16 v[184:187], a[228:231], v[56:59], v[184:187]
    ds_read_b128 v[36:39], v1 offset:30720
    v_mfma_f32_16x16x32_bf16 v[196:199], a[228:231], v[60:63], v[196:199]
    ds_read_b128 v[44:47], v2 offset:30720
    v_mfma_f32_16x16x32_bf16 v[164:167], a[232:235], v[48:51], v[164:167]
    ds_read_b128 v[40:43], v2 offset:28672
    v_mfma_f32_16x16x32_bf16 v[176:179], a[232:235], v[52:55], v[176:179]
    buffer_load_dwordx4 a[228:231], v6, s[16:19], s54 offen offset:0
    v_mfma_f32_16x16x32_bf16 v[188:191], a[232:235], v[56:59], v[188:191]
    v_mfma_f32_16x16x32_bf16 v[200:203], a[232:235], v[60:63], v[200:203]
    v_mfma_f32_16x16x32_bf16 v[168:171], a[236:239], v[48:51], v[168:171]
    v_mfma_f32_16x16x32_bf16 v[180:183], a[236:239], v[52:55], v[180:183]
    buffer_load_dwordx4 a[232:235], v6, s[16:19], s54 offen offset:1024
    v_mfma_f32_16x16x32_bf16 v[192:195], a[236:239], v[56:59], v[192:195]
    v_mfma_f32_16x16x32_bf16 v[204:207], a[236:239], v[60:63], v[204:207]
    buffer_load_dwordx4 a[236:239], v6, s[16:19], s54 offen offset:2048
    v_pk_add_f32 v[64:65], v[64:65], v[112:113]
    v_pk_add_f32 v[66:67], v[66:67], v[114:115]
    v_pk_add_f32 v[76:77], v[76:77], v[124:125]
    v_pk_add_f32 v[78:79], v[78:79], v[126:127]
    v_pk_add_f32 v[88:89], v[88:89], v[136:137]
    v_pk_add_f32 v[90:91], v[90:91], v[138:139]
    v_pk_add_f32 v[100:101], v[100:101], v[148:149]
    v_pk_add_f32 v[102:103], v[102:103], v[150:151]
    v_pk_add_f32 v[68:69], v[68:69], v[116:117]
    v_pk_add_f32 v[70:71], v[70:71], v[118:119]
    v_pk_add_f32 v[80:81], v[80:81], v[128:129]
    v_pk_add_f32 v[82:83], v[82:83], v[130:131]
    v_pk_add_f32 v[92:93], v[92:93], v[140:141]
    v_pk_add_f32 v[94:95], v[94:95], v[142:143]
    v_pk_add_f32 v[104:105], v[104:105], v[152:153]
    v_pk_add_f32 v[106:107], v[106:107], v[154:155]
    v_pk_add_f32 v[72:73], v[72:73], v[120:121]
    v_pk_add_f32 v[74:75], v[74:75], v[122:123]
    v_pk_add_f32 v[84:85], v[84:85], v[132:133]
    v_pk_add_f32 v[86:87], v[86:87], v[134:135]
    v_pk_add_f32 v[96:97], v[96:97], v[144:145]
    v_pk_add_f32 v[98:99], v[98:99], v[146:147]
    v_pk_add_f32 v[108:109], v[108:109], v[156:157]
    v_pk_add_f32 v[110:111], v[110:111], v[158:159]
    v_pk_add_f32 v[208:209], v[208:209], v[112:113] neg_lo:[0,1] neg_hi:[0,1]
    v_pk_add_f32 v[210:211], v[210:211], v[114:115] neg_lo:[0,1] neg_hi:[0,1]
    v_pk_add_f32 v[220:221], v[220:221], v[124:125] neg_lo:[0,1] neg_hi:[0,1]
    v_pk_add_f32 v[222:223], v[222:223], v[126:127] neg_lo:[0,1] neg_hi:[0,1]
    v_pk_add_f32 v[232:233], v[232:233], v[136:137] neg_lo:[0,1] neg_hi:[0,1]
    v_pk_add_f32 v[234:235], v[234:235], v[138:139] neg_lo:[0,1] neg_hi:[0,1]
    v_pk_add_f32 v[244:245], v[244:245], v[148:149] neg_lo:[0,1] neg_hi:[0,1]
    v_pk_add_f32 v[246:247], v[246:247], v[150:151] neg_lo:[0,1] neg_hi:[0,1]
    v_pk_add_f32 v[212:213], v[212:213], v[116:117] neg_lo:[0,1] neg_hi:[0,1]
    v_pk_add_f32 v[214:215], v[214:215], v[118:119] neg_lo:[0,1] neg_hi:[0,1]
    v_pk_add_f32 v[224:225], v[224:225], v[128:129] neg_lo:[0,1] neg_hi:[0,1]
    v_pk_add_f32 v[226:227], v[226:227], v[130:131] neg_lo:[0,1] neg_hi:[0,1]
    v_pk_add_f32 v[236:237], v[236:237], v[140:141] neg_lo:[0,1] neg_hi:[0,1]
    v_pk_add_f32 v[238:239], v[238:239], v[142:143] neg_lo:[0,1] neg_hi:[0,1]
    v_pk_add_f32 v[248:249], v[248:249], v[152:153] neg_lo:[0,1] neg_hi:[0,1]
    v_pk_add_f32 v[250:251], v[250:251], v[154:155] neg_lo:[0,1] neg_hi:[0,1]
    v_pk_add_f32 v[216:217], v[216:217], v[120:121] neg_lo:[0,1] neg_hi:[0,1]
    v_pk_add_f32 v[218:219], v[218:219], v[122:123] neg_lo:[0,1] neg_hi:[0,1]
    v_pk_add_f32 v[228:229], v[228:229], v[132:133] neg_lo:[0,1] neg_hi:[0,1]
    v_pk_add_f32 v[230:231], v[230:231], v[134:135] neg_lo:[0,1] neg_hi:[0,1]
    v_pk_add_f32 v[240:241], v[240:241], v[144:145] neg_lo:[0,1] neg_hi:[0,1]
    v_pk_add_f32 v[242:243], v[242:243], v[146:147] neg_lo:[0,1] neg_hi:[0,1]
    v_pk_add_f32 v[252:253], v[252:253], v[156:157] neg_lo:[0,1] neg_hi:[0,1]
    v_pk_add_f32 v[254:255], v[254:255], v[158:159] neg_lo:[0,1] neg_hi:[0,1]
    v_pk_add_f32 v[64:65], v[64:65], v[160:161]
    v_pk_add_f32 v[66:67], v[66:67], v[162:163]
    v_pk_add_f32 v[76:77], v[76:77], v[172:173]
    v_pk_add_f32 v[78:79], v[78:79], v[174:175]
    v_pk_add_f32 v[88:89], v[88:89], v[184:185]
    v_pk_add_f32 v[90:91], v[90:91], v[186:187]
    v_pk_add_f32 v[100:101], v[100:101], v[196:197]
    v_pk_add_f32 v[102:103], v[102:103], v[198:199]
    v_pk_add_f32 v[68:69], v[68:69], v[164:165]
    v_pk_add_f32 v[70:71], v[70:71], v[166:167]
    v_pk_add_f32 v[80:81], v[80:81], v[176:177]
    v_pk_add_f32 v[82:83], v[82:83], v[178:179]
    v_pk_add_f32 v[92:93], v[92:93], v[188:189]
    v_pk_add_f32 v[94:95], v[94:95], v[190:191]
    v_pk_add_f32 v[104:105], v[104:105], v[200:201]
    v_pk_add_f32 v[106:107], v[106:107], v[202:203]
    v_pk_add_f32 v[72:73], v[72:73], v[168:169]
    v_pk_add_f32 v[74:75], v[74:75], v[170:171]
    v_pk_add_f32 v[84:85], v[84:85], v[180:181]
    v_pk_add_f32 v[86:87], v[86:87], v[182:183]
    v_pk_add_f32 v[96:97], v[96:97], v[192:193]
    v_pk_add_f32 v[98:99], v[98:99], v[194:195]
    v_pk_add_f32 v[108:109], v[108:109], v[204:205]
    v_pk_add_f32 v[110:111], v[110:111], v[206:207]
    v_pk_add_f32 v[208:209], v[208:209], v[160:161]
    v_pk_add_f32 v[210:211], v[210:211], v[162:163]
    v_pk_add_f32 v[220:221], v[220:221], v[172:173]
    v_pk_add_f32 v[222:223], v[222:223], v[174:175]
    v_pk_add_f32 v[232:233], v[232:233], v[184:185]
    v_pk_add_f32 v[234:235], v[234:235], v[186:187]
    v_pk_add_f32 v[244:245], v[244:245], v[196:197]
    v_pk_add_f32 v[246:247], v[246:247], v[198:199]
    v_pk_add_f32 v[212:213], v[212:213], v[164:165]
    v_pk_add_f32 v[214:215], v[214:215], v[166:167]
    v_pk_add_f32 v[224:225], v[224:225], v[176:177]
    v_pk_add_f32 v[226:227], v[226:227], v[178:179]
    v_pk_add_f32 v[236:237], v[236:237], v[188:189]
    v_pk_add_f32 v[238:239], v[238:239], v[190:191]
    v_pk_add_f32 v[248:249], v[248:249], v[200:201]
    v_pk_add_f32 v[250:251], v[250:251], v[202:203]
    v_pk_add_f32 v[216:217], v[216:217], v[168:169]
    v_pk_add_f32 v[218:219], v[218:219], v[170:171]
    v_pk_add_f32 v[228:229], v[228:229], v[180:181]
    v_pk_add_f32 v[230:231], v[230:231], v[182:183]
    v_pk_add_f32 v[240:241], v[240:241], v[192:193]
    v_pk_add_f32 v[242:243], v[242:243], v[194:195]
    v_pk_add_f32 v[252:253], v[252:253], v[204:205]
    v_pk_add_f32 v[254:255], v[254:255], v[206:207]
    s_nop 0
    s_waitcnt vmcnt(11) lgkmcnt(3)
    v_mfma_f32_16x16x32_bf16 v[64:67], a[192:195], v[32:35], v[64:67]
    ds_read_b128 v[48:51], v1 offset:50176
    v_mfma_f32_16x16x32_bf16 v[68:71], a[196:199], v[32:35], v[68:71]
    v_mfma_f32_16x16x32_bf16 v[72:75], a[200:203], v[32:35], v[72:75]
    s_waitcnt lgkmcnt(3)
    v_mfma_f32_16x16x32_bf16 v[76:79], a[192:195], v[36:39], v[76:79]
    ds_read_b128 v[52:55], v1 offset:52224
    v_mfma_f32_16x16x32_bf16 v[80:83], a[196:199], v[36:39], v[80:83]
    v_mfma_f32_16x16x32_bf16 v[84:87], a[200:203], v[36:39], v[84:87]
    s_waitcnt vmcnt(3) lgkmcnt(2)
    v_mfma_f32_16x16x32_bf16 v[64:67], a[216:219], v[40:43], v[64:67]
    ds_read_b128 v[56:59], v2 offset:50176
    v_mfma_f32_16x16x32_bf16 v[68:71], a[220:223], v[40:43], v[68:71]
    v_mfma_f32_16x16x32_bf16 v[72:75], a[224:227], v[40:43], v[72:75]
    v_mfma_f32_16x16x32_bf16 v[76:79], a[216:219], v[44:47], v[76:79]
    ds_read_b128 v[60:63], v2 offset:52224
    v_mfma_f32_16x16x32_bf16 v[80:83], a[220:223], v[44:47], v[80:83]
    v_mfma_f32_16x16x32_bf16 v[84:87], a[224:227], v[44:47], v[84:87]
    s_waitcnt lgkmcnt(3)
    v_mfma_f32_16x16x32_bf16 v[208:211], a[204:207], v[48:51], v[208:211]
    ds_read_b128 v[32:35], v1 offset:32768
    v_mfma_f32_16x16x32_bf16 v[212:215], a[208:211], v[48:51], v[212:215]
    v_mfma_f32_16x16x32_bf16 v[216:219], a[212:215], v[48:51], v[216:219]
    v_cvt_pk_bf16_f32 v64, v64, v65
    v_cvt_pk_bf16_f32 v65, v66, v67
    v_cvt_pk_bf16_f32 v66, v68, v69
    s_waitcnt lgkmcnt(3)
    v_mfma_f32_16x16x32_bf16 v[220:223], a[204:207], v[52:55], v[220:223]
    ds_read_b128 v[36:39], v14 offset:34816
    v_cvt_pk_bf16_f32 v67, v70, v71
    v_cvt_pk_bf16_f32 v68, v72, v73
    v_mfma_f32_16x16x32_bf16 v[224:227], a[208:211], v[52:55], v[224:227]
    v_cvt_pk_bf16_f32 v69, v74, v75
    ds_write_b128 v7, v[64:67] offset:6400
    v_mfma_f32_16x16x32_bf16 v[228:231], a[212:215], v[52:55], v[228:231]
    ds_write_b64 v8, v[68:69] offset:6400
    v_cvt_pk_bf16_f32 v76, v76, v77
    s_waitcnt vmcnt(0) lgkmcnt(5)
    v_mfma_f32_16x16x32_bf16 v[208:211], a[228:231], v[56:59], v[208:211]
    ds_read_b128 v[40:43], v2 offset:32768
    v_cvt_pk_bf16_f32 v77, v78, v79
    v_cvt_pk_bf16_f32 v78, v80, v81
    v_mfma_f32_16x16x32_bf16 v[212:215], a[232:235], v[56:59], v[212:215]
    v_cvt_pk_bf16_f32 v79, v82, v83
    v_cvt_pk_bf16_f32 v80, v84, v85
    v_cvt_pk_bf16_f32 v81, v86, v87
    v_mfma_f32_16x16x32_bf16 v[216:219], a[236:239], v[56:59], v[216:219]
    ds_write_b128 v7, v[76:79] offset:32000
    ds_write_b64 v8, v[80:81] offset:32000
    s_waitcnt lgkmcnt(7)
    v_mfma_f32_16x16x32_bf16 v[220:223], a[228:231], v[60:63], v[220:223]
    ds_read_b128 v[44:47], v15 offset:34816
    v_mfma_f32_16x16x32_bf16 v[224:227], a[232:235], v[60:63], v[224:227]
    v_mfma_f32_16x16x32_bf16 v[228:231], a[236:239], v[60:63], v[228:231]
    s_waitcnt lgkmcnt(7)
    v_mfma_f32_16x16x32_bf16 v[88:91], a[192:195], v[32:35], v[88:91]
    ds_read_b128 v[48:51], v1 offset:54272
    v_mfma_f32_16x16x32_bf16 v[92:95], a[196:199], v[32:35], v[92:95]
    v_mfma_f32_16x16x32_bf16 v[96:99], a[200:203], v[32:35], v[96:99]
    v_cvt_pk_bf16_f32 v208, -v208, -v209
    v_cvt_pk_bf16_f32 v209, -v210, -v211
    v_cvt_pk_bf16_f32 v210, -v212, -v213
    s_waitcnt lgkmcnt(7)
    v_mfma_f32_16x16x32_bf16 v[100:103], a[192:195], v[36:39], v[100:103]
    ds_read_b128 v[52:55], v14 offset:56320
    v_cvt_pk_bf16_f32 v211, -v214, -v215
    v_cvt_pk_bf16_f32 v212, -v216, -v217
    v_mfma_f32_16x16x32_bf16 v[104:107], a[196:199], v[36:39], v[104:107]
    v_cvt_pk_bf16_f32 v213, -v218, -v219
    ds_write_b128 v7, v[208:211] offset:6784
    v_mfma_f32_16x16x32_bf16 v[108:111], a[200:203], v[36:39], v[108:111]
    ds_write_b64 v8, v[212:213] offset:6784
    v_cvt_pk_bf16_f32 v220, -v220, -v221
    s_waitcnt lgkmcnt(7)
    v_mfma_f32_16x16x32_bf16 v[88:91], a[216:219], v[40:43], v[88:91]
    ds_read_b128 v[56:59], v2 offset:54272
    v_cvt_pk_bf16_f32 v221, -v222, -v223
    v_cvt_pk_bf16_f32 v222, -v224, -v225
    v_mfma_f32_16x16x32_bf16 v[92:95], a[220:223], v[40:43], v[92:95]
    v_cvt_pk_bf16_f32 v223, -v226, -v227
    v_cvt_pk_bf16_f32 v224, -v228, -v229
    v_cvt_pk_bf16_f32 v225, -v230, -v231
    v_mfma_f32_16x16x32_bf16 v[96:99], a[224:227], v[40:43], v[96:99]
    ds_write_b128 v7, v[220:223] offset:32384
    ds_write_b64 v8, v[224:225] offset:32384
    s_waitcnt lgkmcnt(7)
    v_mfma_f32_16x16x32_bf16 v[100:103], a[216:219], v[44:47], v[100:103]
    ds_read_b128 v[60:63], v15 offset:56320
    s_waitcnt lgkmcnt(0)
    s_barrier
    v_mfma_f32_16x16x32_bf16 v[104:107], a[220:223], v[44:47], v[104:107]
    ds_read_b128 a[0:3], v9 offset:6400
    ds_read_b128 a[4:7], v9 offset:9536
    ds_read_b128 a[8:11], v9 offset:19200
    v_mfma_f32_16x16x32_bf16 v[108:111], a[224:227], v[44:47], v[108:111]
    ds_read_b128 a[12:15], v9 offset:22336
    ds_read_b128 a[16:19], v9 offset:32000
    ds_read_b128 a[20:23], v9 offset:35136
    v_mfma_f32_16x16x32_bf16 v[232:235], a[204:207], v[48:51], v[232:235]
    ds_read_b128 a[24:27], v9 offset:44800
    ds_read_b128 a[28:31], v9 offset:47936
    s_mov_b32 s35, 86016
    s_waitcnt lgkmcnt(7)
    buffer_store_dwordx4 a[0:3], v10, s[20:23], s35 offen sc0 sc1
    v_mfma_f32_16x16x32_bf16 v[236:239], a[208:211], v[48:51], v[236:239]
    s_add_u32 s35, s35, s45
    s_waitcnt lgkmcnt(6)
    buffer_store_dwordx4 a[4:7], v10, s[20:23], s35 offen sc0 sc1
    s_mov_b32 s35, 258048
    s_waitcnt lgkmcnt(5)
    buffer_store_dwordx4 a[8:11], v10, s[20:23], s35 offen sc0 sc1
    v_mfma_f32_16x16x32_bf16 v[240:243], a[212:215], v[48:51], v[240:243]
    v_cvt_pk_bf16_f32 v88, v88, v89
    v_cvt_pk_bf16_f32 v89, v90, v91
    v_cvt_pk_bf16_f32 v90, v92, v93
    v_mfma_f32_16x16x32_bf16 v[244:247], a[204:207], v[52:55], v[244:247]
    v_cvt_pk_bf16_f32 v91, v94, v95
    v_cvt_pk_bf16_f32 v92, v96, v97
    v_cvt_pk_bf16_f32 v93, v98, v99
    v_mfma_f32_16x16x32_bf16 v[248:251], a[208:211], v[52:55], v[248:251]
    ds_write_b128 v12, v[88:91] offset:6400
    ds_write_b64 v13, v[92:93] offset:6400
    v_mfma_f32_16x16x32_bf16 v[252:255], a[212:215], v[52:55], v[252:255]
    v_cvt_pk_bf16_f32 v100, v100, v101
    v_cvt_pk_bf16_f32 v101, v102, v103
    v_cvt_pk_bf16_f32 v102, v104, v105
    v_mfma_f32_16x16x32_bf16 v[232:235], a[228:231], v[56:59], v[232:235]
    v_cvt_pk_bf16_f32 v103, v106, v107
    v_cvt_pk_bf16_f32 v104, v108, v109
    v_cvt_pk_bf16_f32 v105, v110, v111
    v_mfma_f32_16x16x32_bf16 v[236:239], a[232:235], v[56:59], v[236:239]
    ds_write_b128 v12, v[100:103] offset:32000
    ds_write_b64 v13, v[104:105] offset:32000
    v_mfma_f32_16x16x32_bf16 v[240:243], a[236:239], v[56:59], v[240:243]
    s_add_u32 s35, s35, s45
    s_waitcnt lgkmcnt(8)
    buffer_store_dwordx4 a[12:15], v10, s[20:23], s35 offen sc0 sc1
    s_mov_b32 s35, 430080
    s_waitcnt lgkmcnt(7)
    buffer_store_dwordx4 a[16:19], v10, s[20:23], s35 offen sc0 sc1
    v_mfma_f32_16x16x32_bf16 v[244:247], a[228:231], v[60:63], v[244:247]
    s_add_u32 s35, s35, s45
    s_waitcnt lgkmcnt(6)
    buffer_store_dwordx4 a[20:23], v10, s[20:23], s35 offen sc0 sc1
    s_mov_b32 s35, 602112
    s_waitcnt lgkmcnt(5)
    buffer_store_dwordx4 a[24:27], v10, s[20:23], s35 offen sc0 sc1
    v_mfma_f32_16x16x32_bf16 v[248:251], a[232:235], v[60:63], v[248:251]
    s_add_u32 s35, s35, s45
    s_waitcnt lgkmcnt(4)
    buffer_store_dwordx4 a[28:31], v10, s[20:23], s35 offen sc0 sc1
    v_mfma_f32_16x16x32_bf16 v[252:255], a[236:239], v[60:63], v[252:255]
    s_nop 7
    v_cvt_pk_bf16_f32 v232, -v232, -v233
    v_cvt_pk_bf16_f32 v233, -v234, -v235
    v_cvt_pk_bf16_f32 v234, -v236, -v237
    v_cvt_pk_bf16_f32 v235, -v238, -v239
    v_cvt_pk_bf16_f32 v236, -v240, -v241
    v_cvt_pk_bf16_f32 v237, -v242, -v243
    ds_write_b128 v12, v[232:235] offset:6784
    ds_write_b64 v13, v[236:237] offset:6784
    v_cvt_pk_bf16_f32 v244, -v244, -v245
    v_cvt_pk_bf16_f32 v245, -v246, -v247
    v_cvt_pk_bf16_f32 v246, -v248, -v249
    v_cvt_pk_bf16_f32 v247, -v250, -v251
    v_cvt_pk_bf16_f32 v248, -v252, -v253
    v_cvt_pk_bf16_f32 v249, -v254, -v255
    ds_write_b128 v12, v[244:247] offset:32384
    ds_write_b64 v13, v[248:249] offset:32384
    s_waitcnt lgkmcnt(0)
    s_barrier
    ds_read_b128 a[32:35], v16 offset:6400
    ds_read_b128 a[36:39], v16 offset:9536
    ds_read_b128 a[40:43], v16 offset:19200
    ds_read_b128 a[44:47], v16 offset:22336
    ds_read_b128 a[48:51], v16 offset:32000
    ds_read_b128 a[52:55], v16 offset:35136
    s_mov_b32 s35, 774144
    s_waitcnt lgkmcnt(5)
    buffer_store_dwordx4 a[32:35], v10, s[20:23], s35 offen sc0 sc1
    s_add_u32 s35, s35, s45
    s_waitcnt lgkmcnt(4)
    buffer_store_dwordx4 a[36:39], v10, s[20:23], s35 offen sc0 sc1
    s_mov_b32 s35, 946176
    s_waitcnt lgkmcnt(3)
    buffer_store_dwordx4 a[40:43], v10, s[20:23], s35 offen sc0 sc1
    s_add_u32 s35, s35, s45
    s_waitcnt lgkmcnt(2)
    buffer_store_dwordx4 a[44:47], v10, s[20:23], s35 offen sc0 sc1
    s_mov_b32 s35, 1118208
    s_waitcnt lgkmcnt(1)
    buffer_store_dwordx4 a[48:51], v10, s[20:23], s35 offen sc0 sc1
    s_add_u32 s35, s35, s45
    s_waitcnt lgkmcnt(0)
    buffer_store_dwordx4 a[52:55], v10, s[20:23], s35 offen sc0 sc1
L_fin:
L_end:
    s_endpgm
.section .rodata,"a"
.p2align 6
.amdhsa_kernel standalone__detection_seg_fpn_lateral__vision_kernel
  .amdhsa_next_free_vgpr 512
  .amdhsa_next_free_sgpr 102
  .amdhsa_accum_offset 256
  .amdhsa_group_segment_fixed_size 0
  .amdhsa_kernarg_size 56
  .amdhsa_user_sgpr_count 2
  .amdhsa_user_sgpr_kernarg_segment_ptr 1
  .amdhsa_system_sgpr_workgroup_id_x 1
.end_amdhsa_kernel
```
